```python
import torch

def _softmax(x, axis=-1):
    return torch.softmax(x, dim=axis)
def _gelu(x):
    return torch.nn.functional.gelu(x, approximate="tanh")
def _silu(x):
    return torch.nn.functional.silu(x)
def _sigmoid(x):
    return torch.sigmoid(x)
def _layernorm(x, axis=-1, eps=1e-5):
    m = x.mean(dim=axis, keepdim=True)
    v = x.var(dim=axis, keepdim=True, unbiased=False)
    return (x - m) / torch.sqrt(v + eps)
def _scatter_add(tgt, idx, src, axis=0):
    return tgt.clone().index_add_(axis, idx, src)
def _segment_sum(src, seg, n):
    out = torch.zeros((n,) + src.shape[1:], dtype=src.dtype)
    return out.index_add_(0, seg, src)
def _pad(x, pw):
    flat = tuple(v for pair in reversed(pw) for v in pair)
    return torch.nn.functional.pad(x, flat)

kernel_name = 'parallel_sum__linear_attn_block__mixer_s_mlp__prompt'

def setup_inputs():

    _w = (lambda a: (lambda t: t.to(torch.bfloat16) if t.is_floating_point() else t)(torch.as_tensor(a)))
    def _A_setup():
        B, S, D = 1, 2048, 512
        return {
            "x": _w((lambda *s: torch.randn(*s, dtype=torch.bfloat16) * 0.05)(B, S, D)),
            "wqkv": _w((lambda *s: torch.randn(*s, dtype=torch.bfloat16) * 0.4)(D, 3 * D)),
            "wo": _w((lambda *s: torch.randn(*s, dtype=torch.bfloat16) * 0.1)(D, D)),
        }
    _A_in = _A_setup()

    def _B_setup():
        B, S, D, F = 1, 2048, 512, 1792
        return {
            "x":  _w((lambda *s: torch.randn(*s, dtype=torch.bfloat16) * 0.05)(B, S, D)),
            "w1": _w((lambda *s: torch.randn(*s, dtype=torch.bfloat16) * 0.8)(D, D) * (D ** -0.5)),
            "w2": _w((lambda *s: torch.randn(*s, dtype=torch.bfloat16) * 0.8)(D, D) * (D ** -0.5)),
            "w3": _w((lambda *s: torch.randn(*s, dtype=torch.bfloat16) * 0.8)(D, F) * (D ** -0.5)),
            "w4": _w((lambda *s: torch.randn(*s, dtype=torch.bfloat16) * 0.8)(F, D) * (F ** -0.5)),
        }
    _B_in = _B_setup()

    return {
        "A_x": _A_in["x"],
        "A_wqkv": _A_in["wqkv"],
        "A_wo": _A_in["wo"],
        "B_x": _B_in["x"],
        "B_w1": _B_in["w1"],
        "B_w2": _B_in["w2"],
        "B_w3": _B_in["w3"],
        "B_w4": _B_in["w4"],
    }

def reference(A_x, A_wqkv, A_wo, B_x, B_w1, B_w2, B_w3, B_w4):
    def _A_ref(x, wqkv, wo):
        B, S, D = x.shape
        H = 32; Dh = D // H
        qkv = (lambda x, *d: x.permute(*d))((x @ wqkv).reshape(B, S, 3, H, Dh), 2, 0, 3, 1, 4)
        q, k, v = qkv[0], qkv[1], qkv[2]
        phi = lambda t: torch.where(t > 0, t + 1, torch.exp(t)) + 1e-6
        pq, pk = phi(q), phi(k)
        kv = torch.einsum("bhsd,bhse->bhde", pk, v)
        z = torch.einsum("bhsd->bhd", pk)
        num = torch.einsum("bhqd,bhde->bhqe", pq, kv)
        den = torch.einsum("bhqd,bhd->bhq", pq, z)[..., None] + 1e-6
        o = num / den
        return (lambda x, *d: x.permute(*d))(o, 0, 2, 1, 3).reshape(B, S, D) @ wo

    def _B_ref(x, w1, w2, w3, w4):
        B, S, D = x.shape
        h = _gelu(_layernorm(x, axis=-1) @ w1)
        c = D // 4
        g0 = _pad(h[:, :, 0*c:1*c], ((0, 0), (1, 0), (0, 0)))[:, :S, :]
        g1 = _pad(h[:, :, 1*c:2*c], ((0, 0), (0, 1), (0, 0)))[:, 1:, :]
        g2 = _pad(h[:, :, 2*c:3*c], ((0, 0), (2, 0), (0, 0)))[:, :S, :]
        g3 = _pad(h[:, :, 3*c:   ], ((0, 0), (0, 2), (0, 0)))[:, 2:, :]
        hs = torch.concatenate([g0, g1, g2, g3], axis=-1) @ w2
        x1 = x + hs
        h2 = _gelu(_layernorm(x1, axis=-1) @ w3) @ w4
        return x1 + h2

    x = A_x
    xn = _layernorm(x, axis=-1)
    return x + _A_ref(xn, A_wqkv, A_wo) + _B_ref(xn, B_w1, B_w2, B_w3, B_w4)
```

```asm
; @launch grid=(256,1,1) block=(512,1,1) lds=163840
.amdgcn_target "amdgcn-amd-amdhsa--gfx950"
.text
.globl parallel_sum__linear_attn_block__mixer_s_mlp__prompt_kernel
.p2align 8
.type parallel_sum__linear_attn_block__mixer_s_mlp__prompt_kernel,@function
parallel_sum__linear_attn_block__mixer_s_mlp__prompt_kernel:
    s_cmp_ge_u32 s2, 256
    s_cbranch_scc1 L_end
    s_load_dwordx16 s[4:19], s[0:1], 0
    s_load_dwordx4 s[20:23], s[0:1], 64
    s_load_dwordx2 s[24:25], s[0:1], 80
    s_and_b32 s68, s2, 3
    s_lshr_b32 s73, s2, 5
    s_lshl_b32 s73, s73, 2
    s_or_b32 s68, s68, s73
    s_lshr_b32 s69, s2, 2
    s_and_b32 s69, s69, 7
    v_lshrrev_b32 v1, 6, v0
    v_and_b32 v0, 63, v0
    v_readfirstlane_b32 s74, v1
    s_mov_b32 s30, 2097152
    s_mov_b32 s31, 0x20000
    s_and_b32 s70, s74, 3
    s_and_b32 s71, s74, 1
    s_lshr_b32 s72, s70, 1
    s_lshr_b32 s89, s68, 2
    s_add_u32 s89, s89, s68
    s_add_u32 s89, s89, s69
    s_and_b32 s89, s89, 3
    s_lshr_b32 s3, s68, 2
    s_add_u32 s3, s3, s69
    s_and_b32 s3, s3, 3
    s_cmp_lt_u32 s74, 4
    s_cbranch_scc1 L_compute
    s_cmp_eq_u32 s70, 1
    s_cbranch_scc1 L_back
    s_cmp_eq_u32 s70, 2
    s_cbranch_scc1 L_back
    s_cmp_eq_u32 s70, 0
    s_cbranch_scc1 L_sync
    v_lshrrev_b32 v40, 3, v0
    v_and_b32 v41, 7, v0
    v_lshrrev_b32 v42, 4, v0
    v_and_b32 v42, 1, v42
    v_lshlrev_b32 v42, 2, v42
    v_xor_b32 v41, v41, v42
    v_lshlrev_b32 v43, 4, v41
    v_xor_b32 v44, 32, v43
    s_lshl_b32 s73, s69, 7
    v_mul_u32_u24 v45, 1024, v40
    v_add_u32 v45, s73, v45
    v_add_u32 v4, v45, v43
    v_add_u32 v5, v45, v44
    v_add_u32 v5, 7168, v5
    v_add_u32 v6, v45, v43
    v_add_u32 v6, 14336, v6
    v_add_u32 v7, v45, v44
    v_add_u32 v7, 21504, v7
    s_mov_b32 s42, 524288
    s_mov_b32 s43, 0x20000
    s_add_u32 s76, s89, 0
    s_and_b32 s76, s76, 3
    s_lshl_b32 s92, s76, 17
    s_mul_i32 s96, s76, 393216
    s_add_u32 s76, s89, 1
    s_and_b32 s76, s76, 3
    s_lshl_b32 s93, s76, 17
    s_mul_i32 s97, s76, 393216
    s_add_u32 s76, s89, 2
    s_and_b32 s76, s76, 3
    s_lshl_b32 s94, s76, 17
    s_mul_i32 s98, s76, 393216
    s_add_u32 s76, s89, 3
    s_and_b32 s76, s76, 3
    s_lshl_b32 s95, s76, 17
    s_mul_i32 s99, s76, 393216
    s_waitcnt lgkmcnt(0)
    s_mov_b32 s40, s12
    s_and_b32 s41, s13, 0xffff
    s_mov_b32 m0, 65536
    s_add_u32 s75, s92, 0
    s_nop 0
    buffer_load_dwordx4 v4, s[40:43], s75 offen offset:0 lds
    buffer_load_dwordx4 v5, s[40:43], s75 offen offset:1024 lds
    buffer_load_dwordx4 v6, s[40:43], s75 offen offset:2048 lds
    buffer_load_dwordx4 v7, s[40:43], s75 offen offset:3072 lds
    s_mov_b32 m0, 69632
    s_add_u32 s75, s92, 32768
    buffer_load_dwordx4 v4, s[40:43], s75 offen offset:0 lds
    buffer_load_dwordx4 v5, s[40:43], s75 offen offset:1024 lds
    buffer_load_dwordx4 v6, s[40:43], s75 offen offset:2048 lds
    buffer_load_dwordx4 v7, s[40:43], s75 offen offset:3072 lds
    s_mov_b32 m0, 73728
    s_add_u32 s75, s92, 65536
    buffer_load_dwordx4 v4, s[40:43], s75 offen offset:0 lds
    buffer_load_dwordx4 v5, s[40:43], s75 offen offset:1024 lds
    buffer_load_dwordx4 v6, s[40:43], s75 offen offset:2048 lds
    buffer_load_dwordx4 v7, s[40:43], s75 offen offset:3072 lds
    s_mov_b32 m0, 77824
    s_add_u32 s75, s92, 98304
    buffer_load_dwordx4 v4, s[40:43], s75 offen offset:0 lds
    buffer_load_dwordx4 v5, s[40:43], s75 offen offset:1024 lds
    buffer_load_dwordx4 v6, s[40:43], s75 offen offset:2048 lds
    buffer_load_dwordx4 v7, s[40:43], s75 offen offset:3072 lds
    s_mov_b32 m0, 81920
    s_add_u32 s75, s93, 0
    s_nop 0
    buffer_load_dwordx4 v4, s[40:43], s75 offen offset:0 lds
    buffer_load_dwordx4 v5, s[40:43], s75 offen offset:1024 lds
    buffer_load_dwordx4 v6, s[40:43], s75 offen offset:2048 lds
    buffer_load_dwordx4 v7, s[40:43], s75 offen offset:3072 lds
    s_mov_b32 m0, 86016
    s_add_u32 s75, s93, 32768
    buffer_load_dwordx4 v4, s[40:43], s75 offen offset:0 lds
    buffer_load_dwordx4 v5, s[40:43], s75 offen offset:1024 lds
    buffer_load_dwordx4 v6, s[40:43], s75 offen offset:2048 lds
    buffer_load_dwordx4 v7, s[40:43], s75 offen offset:3072 lds
    s_mov_b32 m0, 90112
    s_add_u32 s75, s93, 65536
    buffer_load_dwordx4 v4, s[40:43], s75 offen offset:0 lds
    buffer_load_dwordx4 v5, s[40:43], s75 offen offset:1024 lds
    buffer_load_dwordx4 v6, s[40:43], s75 offen offset:2048 lds
    buffer_load_dwordx4 v7, s[40:43], s75 offen offset:3072 lds
    s_mov_b32 m0, 94208
    s_add_u32 s75, s93, 98304
    buffer_load_dwordx4 v4, s[40:43], s75 offen offset:0 lds
    buffer_load_dwordx4 v5, s[40:43], s75 offen offset:1024 lds
    buffer_load_dwordx4 v6, s[40:43], s75 offen offset:2048 lds
    buffer_load_dwordx4 v7, s[40:43], s75 offen offset:3072 lds
    s_branch L_loader
L_back:
    v_lshrrev_b32 v2, 4, v0
    v_and_b32 v3, 15, v0
    v_xor_b32 v3, v3, v2
    v_lshlrev_b32 v3, 4, v3
    s_lshl_b32 s73, s68, 1
    s_add_u32 s73, s73, s72
    s_lshl_b32 s73, s73, 15
    v_lshl_add_u32 v2, v2, 10, s73
    v_add_u32 v2, v2, v3
    v_xor_b32 v3, 64, v2
    v_add_u32 v3, 3072, v3
    v_xor_b32 v4, 128, v2
    v_add_u32 v4, 6144, v4
    v_xor_b32 v5, 192, v2
    v_add_u32 v5, 9216, v5
    s_lshl_b32 s79, s72, 13
    s_mov_b32 s86, s89
    s_waitcnt lgkmcnt(0)
    s_mov_b32 s28, s4
    s_and_b32 s29, s5, 0xffff
    s_add_u32 m0, s79, 0
    s_lshl_b32 s75, s86, 8
    buffer_load_dwordx4 v2, s[28:31], s75 offen offset:0 lds
    buffer_load_dwordx4 v3, s[28:31], s75 offen offset:1024 lds
    buffer_load_dwordx4 v4, s[28:31], s75 offen offset:2048 lds
    buffer_load_dwordx4 v5, s[28:31], s75 offen offset:3072 lds
    s_add_u32 m0, s79, 4096
    s_lshl_b32 s75, s86, 8
    s_add_u32 s75, s75, 16384
    buffer_load_dwordx4 v2, s[28:31], s75 offen offset:0 lds
    buffer_load_dwordx4 v3, s[28:31], s75 offen offset:1024 lds
    buffer_load_dwordx4 v4, s[28:31], s75 offen offset:2048 lds
    buffer_load_dwordx4 v5, s[28:31], s75 offen offset:3072 lds
    s_add_u32 s86, s86, 1
    s_and_b32 s86, s86, 3
    s_mov_b32 s80, 0x358637bd
    s_mov_b32 s81, 0x358637bd
    s_mov_b32 s82, 0x3f803f80
    s_mov_b32 s40, s12
    s_and_b32 s41, s13, 0xffff
    s_mov_b32 s42, 524288
    s_mov_b32 s43, 0x20000
    s_mov_b32 s32, s6
    s_and_b32 s33, s7, 0xffff
    s_mov_b32 s34, 1572864
    s_mov_b32 s35, 0x20000
    s_mov_b32 s36, s8
    s_and_b32 s37, s9, 0xffff
    s_mov_b32 s38, 524288
    s_mov_b32 s39, 0x20000
    s_mov_b32 s44, s14
    s_and_b32 s45, s15, 0xffff
    s_mov_b32 s46, 524288
    s_mov_b32 s47, 0x20000
    s_mov_b32 s48, s16
    s_and_b32 s49, s17, 0xffff
    s_mov_b32 s50, 1835008
    s_mov_b32 s51, 0x20000
    s_mov_b32 s52, s18
    s_and_b32 s53, s19, 0xffff
    s_mov_b32 s54, 1835008
    s_mov_b32 s55, 0x20000
    s_mov_b32 s56, s20
    s_and_b32 s57, s21, 0xffff
    s_mov_b32 s58, 2097152
    s_mov_b32 s59, 0x20000
    s_mov_b32 s60, s24
    s_and_b32 s61, s25, 0xffff
    s_mov_b32 s62, 18874368
    s_mov_b32 s63, 0x20000
    s_mov_b32 s64, s22
    s_and_b32 s65, s23, 0xffff
    s_mov_b32 s66, 256
    s_mov_b32 s67, 0x20000
    s_add_u32 m0, s79, 16384
    s_lshl_b32 s75, s86, 8
    buffer_load_dwordx4 v2, s[28:31], s75 offen offset:0 lds
    buffer_load_dwordx4 v3, s[28:31], s75 offen offset:1024 lds
    buffer_load_dwordx4 v4, s[28:31], s75 offen offset:2048 lds
    buffer_load_dwordx4 v5, s[28:31], s75 offen offset:3072 lds
    s_add_u32 m0, s79, 20480
    s_lshl_b32 s75, s86, 8
    s_add_u32 s75, s75, 16384
    buffer_load_dwordx4 v2, s[28:31], s75 offen offset:0 lds
    buffer_load_dwordx4 v3, s[28:31], s75 offen offset:1024 lds
    buffer_load_dwordx4 v4, s[28:31], s75 offen offset:2048 lds
    buffer_load_dwordx4 v5, s[28:31], s75 offen offset:3072 lds
    s_add_u32 s86, s86, 1
    s_and_b32 s86, s86, 3
    v_mov_b32 v54, 2147483648
    v_lshlrev_b32 v55, 7, v0
    v_mov_b32 v29, 1
    v_lshrrev_b32 v40, 5, v0
    v_and_b32 v41, 31, v0
    v_lshlrev_b32 v32, 10, v40
    v_lshl_add_u32 v32, v41, 4, v32
    s_lshl_b32 s87, s68, 16
    s_lshl_b32 s88, s69, 18
    s_add_u32 s88, s88, 14680064
    s_lshl_b32 s85, s69, 12
    s_add_u32 s85, s85, 13631488
    s_lshl_b32 s73, s2, 1
    s_add_u32 s73, s73, s72
    s_mul_i32 s73, s73, 3072
    s_add_u32 s73, s73, 1024
    v_cmp_gt_u32 vcc, 16, v0
    s_nop 1
    v_cndmask_b32 v47, v54, v55, vcc
    buffer_load_dword v6, v47, s[32:35], s73 offen
    v_lshrrev_b32 v48, 4, v0
    v_and_b32 v49, 15, v0
    v_or_b32 v40, 0, v48
    v_xor_b32 v40, v40, v49
    v_lshlrev_b32 v40, 4, v40
    v_lshl_add_u32 v40, v49, 8, v40
    v_add_u32 v50, s79, v40
    v_or_b32 v40, 4, v48
    v_xor_b32 v40, v40, v49
    v_lshlrev_b32 v40, 4, v40
    v_lshl_add_u32 v40, v49, 8, v40
    v_add_u32 v51, s79, v40
    v_or_b32 v40, 8, v48
    v_xor_b32 v40, v40, v49
    v_lshlrev_b32 v40, 4, v40
    v_lshl_add_u32 v40, v49, 8, v40
    v_add_u32 v52, s79, v40
    v_or_b32 v40, 12, v48
    v_xor_b32 v40, v40, v49
    v_lshlrev_b32 v40, 4, v40
    v_lshl_add_u32 v40, v49, 8, v40
    v_add_u32 v53, s79, v40
    v_mov_b32 v144, s82
    v_mov_b32 v145, s82
    v_mov_b32 v146, s82
    v_mov_b32 v147, s82
    v_and_b32 v40, 3, v0
    v_lshrrev_b32 v42, 2, v49
    v_cmp_eq_u32 s[14:15], 1, v40
    v_cmp_eq_u32 s[16:17], 2, v40
    v_cmp_eq_u32 s[12:13], 3, v40
    v_cmp_eq_u32 s[10:11], v42, v48
    s_lshl_b32 s73, s72, 5
    v_add_u32 v148, s73, v49
    v_lshlrev_b32 v149, 4, v148
    v_lshlrev_b32 v148, 2, v148
    v_add_u32 v149, 147456, v149
    v_add_u32 v148, 149504, v148
    s_waitcnt vmcnt(9)
    ds_read_b128 v[64:67], v50 offset:0
    ds_read_b128 v[80:83], v50 offset:4096
    ds_read_b128 v[68:71], v51 offset:0
    ds_read_b128 v[84:87], v51 offset:4096
    ds_read_b128 v[72:75], v52 offset:0
    ds_read_b128 v[88:91], v52 offset:4096
    ds_read_b128 v[76:79], v53 offset:0
    ds_read_b128 v[92:95], v53 offset:4096
    s_setprio 3
    s_waitcnt lgkmcnt(6)
    v_mfma_f32_16x16x32_bf16 v[136:139], v[64:67], v[64:67], 0
    v_mfma_f32_16x16x32_bf16 v[128:131], v[144:147], v[64:67], 0
    v_mfma_f32_16x16x32_bf16 v[140:143], v[80:83], v[80:83], 0
    v_mfma_f32_16x16x32_bf16 v[132:135], v[144:147], v[80:83], 0
    s_waitcnt lgkmcnt(4)
    v_mfma_f32_16x16x32_bf16 v[136:139], v[68:71], v[68:71], v[136:139]
    v_mfma_f32_16x16x32_bf16 v[128:131], v[144:147], v[68:71], v[128:131]
    v_mfma_f32_16x16x32_bf16 v[140:143], v[84:87], v[84:87], v[140:143]
    v_mfma_f32_16x16x32_bf16 v[132:135], v[144:147], v[84:87], v[132:135]
    s_waitcnt lgkmcnt(2)
    v_mfma_f32_16x16x32_bf16 v[136:139], v[72:75], v[72:75], v[136:139]
    v_mfma_f32_16x16x32_bf16 v[128:131], v[144:147], v[72:75], v[128:131]
    v_mfma_f32_16x16x32_bf16 v[140:143], v[88:91], v[88:91], v[140:143]
    v_mfma_f32_16x16x32_bf16 v[132:135], v[144:147], v[88:91], v[132:135]
    s_waitcnt lgkmcnt(0)
    v_mfma_f32_16x16x32_bf16 v[136:139], v[76:79], v[76:79], v[136:139]
    v_mfma_f32_16x16x32_bf16 v[128:131], v[144:147], v[76:79], v[128:131]
    v_mfma_f32_16x16x32_bf16 v[140:143], v[92:95], v[92:95], v[140:143]
    v_mfma_f32_16x16x32_bf16 v[132:135], v[144:147], v[92:95], v[132:135]
    s_setprio 0
    s_barrier
    s_add_u32 m0, s79, 32768
    s_lshl_b32 s75, s86, 8
    buffer_load_dwordx4 v2, s[28:31], s75 offen offset:0 lds
    buffer_load_dwordx4 v3, s[28:31], s75 offen offset:1024 lds
    buffer_load_dwordx4 v4, s[28:31], s75 offen offset:2048 lds
    buffer_load_dwordx4 v5, s[28:31], s75 offen offset:3072 lds
    s_add_u32 m0, s79, 36864
    s_lshl_b32 s75, s86, 8
    s_add_u32 s75, s75, 16384
    buffer_load_dwordx4 v2, s[28:31], s75 offen offset:0 lds
    buffer_load_dwordx4 v3, s[28:31], s75 offen offset:1024 lds
    buffer_load_dwordx4 v4, s[28:31], s75 offen offset:2048 lds
    buffer_load_dwordx4 v5, s[28:31], s75 offen offset:3072 lds
    s_add_u32 s86, s86, 1
    s_and_b32 s86, s86, 3
    s_add_u32 m0, s79, 49152
    s_lshl_b32 s75, s86, 8
    buffer_load_dwordx4 v2, s[28:31], s75 offen offset:0 lds
    buffer_load_dwordx4 v3, s[28:31], s75 offen offset:1024 lds
    buffer_load_dwordx4 v4, s[28:31], s75 offen offset:2048 lds
    buffer_load_dwordx4 v5, s[28:31], s75 offen offset:3072 lds
    s_add_u32 m0, s79, 53248
    s_lshl_b32 s75, s86, 8
    s_add_u32 s75, s75, 16384
    buffer_load_dwordx4 v2, s[28:31], s75 offen offset:0 lds
    buffer_load_dwordx4 v3, s[28:31], s75 offen offset:1024 lds
    buffer_load_dwordx4 v4, s[28:31], s75 offen offset:2048 lds
    buffer_load_dwordx4 v5, s[28:31], s75 offen offset:3072 lds
    s_waitcnt vmcnt(17)
    ds_read_b128 v[96:99], v50 offset:16384
    ds_read_b128 v[112:115], v50 offset:20480
    ds_read_b128 v[100:103], v51 offset:16384
    ds_read_b128 v[116:119], v51 offset:20480
    ds_read_b128 v[104:107], v52 offset:16384
    ds_read_b128 v[120:123], v52 offset:20480
    ds_read_b128 v[108:111], v53 offset:16384
    ds_read_b128 v[124:127], v53 offset:20480
    s_barrier
    s_setprio 3
    s_waitcnt lgkmcnt(6)
    v_mfma_f32_16x16x32_bf16 v[136:139], v[96:99], v[96:99], v[136:139]
    v_mfma_f32_16x16x32_bf16 v[128:131], v[144:147], v[96:99], v[128:131]
    v_mfma_f32_16x16x32_bf16 v[140:143], v[112:115], v[112:115], v[140:143]
    v_mfma_f32_16x16x32_bf16 v[132:135], v[144:147], v[112:115], v[132:135]
    s_waitcnt lgkmcnt(4)
    v_mfma_f32_16x16x32_bf16 v[136:139], v[100:103], v[100:103], v[136:139]
    v_mfma_f32_16x16x32_bf16 v[128:131], v[144:147], v[100:103], v[128:131]
    v_mfma_f32_16x16x32_bf16 v[140:143], v[116:119], v[116:119], v[140:143]
    v_mfma_f32_16x16x32_bf16 v[132:135], v[144:147], v[116:119], v[132:135]
    s_waitcnt lgkmcnt(2)
    v_mfma_f32_16x16x32_bf16 v[136:139], v[104:107], v[104:107], v[136:139]
    v_mfma_f32_16x16x32_bf16 v[128:131], v[144:147], v[104:107], v[128:131]
    v_mfma_f32_16x16x32_bf16 v[140:143], v[120:123], v[120:123], v[140:143]
    v_mfma_f32_16x16x32_bf16 v[132:135], v[144:147], v[120:123], v[132:135]
    s_waitcnt lgkmcnt(0)
    v_mfma_f32_16x16x32_bf16 v[136:139], v[108:111], v[108:111], v[136:139]
    v_mfma_f32_16x16x32_bf16 v[128:131], v[144:147], v[108:111], v[128:131]
    v_mfma_f32_16x16x32_bf16 v[140:143], v[124:127], v[124:127], v[140:143]
    v_mfma_f32_16x16x32_bf16 v[132:135], v[144:147], v[124:127], v[132:135]
    s_setprio 0
    s_waitcnt vmcnt(8)
    ds_read_b128 v[64:67], v50 offset:32768
    ds_read_b128 v[80:83], v50 offset:36864
    ds_read_b128 v[68:71], v51 offset:32768
    ds_read_b128 v[84:87], v51 offset:36864
    ds_read_b128 v[72:75], v52 offset:32768
    ds_read_b128 v[88:91], v52 offset:36864
    ds_read_b128 v[76:79], v53 offset:32768
    ds_read_b128 v[92:95], v53 offset:36864
    s_barrier
    s_setprio 3
    s_waitcnt lgkmcnt(6)
    v_mfma_f32_16x16x32_bf16 v[136:139], v[64:67], v[64:67], v[136:139]
    v_mfma_f32_16x16x32_bf16 v[128:131], v[144:147], v[64:67], v[128:131]
    v_mfma_f32_16x16x32_bf16 v[140:143], v[80:83], v[80:83], v[140:143]
    v_mfma_f32_16x16x32_bf16 v[132:135], v[144:147], v[80:83], v[132:135]
    s_waitcnt lgkmcnt(4)
    v_mfma_f32_16x16x32_bf16 v[136:139], v[68:71], v[68:71], v[136:139]
    v_mfma_f32_16x16x32_bf16 v[128:131], v[144:147], v[68:71], v[128:131]
    v_mfma_f32_16x16x32_bf16 v[140:143], v[84:87], v[84:87], v[140:143]
    v_mfma_f32_16x16x32_bf16 v[132:135], v[144:147], v[84:87], v[132:135]
    s_waitcnt lgkmcnt(2)
    v_mfma_f32_16x16x32_bf16 v[136:139], v[72:75], v[72:75], v[136:139]
    v_mfma_f32_16x16x32_bf16 v[128:131], v[144:147], v[72:75], v[128:131]
    v_mfma_f32_16x16x32_bf16 v[140:143], v[88:91], v[88:91], v[140:143]
    v_mfma_f32_16x16x32_bf16 v[132:135], v[144:147], v[88:91], v[132:135]
    s_waitcnt lgkmcnt(0)
    v_mfma_f32_16x16x32_bf16 v[136:139], v[76:79], v[76:79], v[136:139]
    v_mfma_f32_16x16x32_bf16 v[128:131], v[144:147], v[76:79], v[128:131]
    v_mfma_f32_16x16x32_bf16 v[140:143], v[92:95], v[92:95], v[140:143]
    v_mfma_f32_16x16x32_bf16 v[132:135], v[144:147], v[92:95], v[132:135]
    s_setprio 0
    s_lshl_b32 s73, s2, 1
    s_add_u32 s73, s73, s72
    s_mul_i32 s73, s73, 1024
    v_cmp_gt_u32 vcc, 8, v0
    s_nop 1
    v_cndmask_b32 v47, v54, v55, vcc
    buffer_load_dword v7, v47, s[44:47], s73 offen
    s_lshl_b32 s73, s2, 1
    s_add_u32 s73, s73, s72
    s_mul_i32 s73, s73, 3072
    v_cmp_gt_u32 vcc, 8, v0
    s_nop 1
    v_cndmask_b32 v47, v54, v55, vcc
    buffer_load_dword v7, v47, s[32:35], s73 offen
    s_waitcnt vmcnt(2)
    ds_read_b128 v[96:99], v50 offset:49152
    ds_read_b128 v[112:115], v50 offset:53248
    ds_read_b128 v[100:103], v51 offset:49152
    ds_read_b128 v[116:119], v51 offset:53248
    ds_read_b128 v[104:107], v52 offset:49152
    ds_read_b128 v[120:123], v52 offset:53248
    ds_read_b128 v[108:111], v53 offset:49152
    ds_read_b128 v[124:127], v53 offset:53248
    s_barrier
    s_setprio 3
    s_waitcnt lgkmcnt(6)
    v_mfma_f32_16x16x32_bf16 v[136:139], v[96:99], v[96:99], v[136:139]
    v_mfma_f32_16x16x32_bf16 v[128:131], v[144:147], v[96:99], v[128:131]
    v_mfma_f32_16x16x32_bf16 v[140:143], v[112:115], v[112:115], v[140:143]
    v_mfma_f32_16x16x32_bf16 v[132:135], v[144:147], v[112:115], v[132:135]
    s_waitcnt lgkmcnt(4)
    v_mfma_f32_16x16x32_bf16 v[136:139], v[100:103], v[100:103], v[136:139]
    v_mfma_f32_16x16x32_bf16 v[128:131], v[144:147], v[100:103], v[128:131]
    v_mfma_f32_16x16x32_bf16 v[140:143], v[116:119], v[116:119], v[140:143]
    v_mfma_f32_16x16x32_bf16 v[132:135], v[144:147], v[116:119], v[132:135]
    s_waitcnt lgkmcnt(2)
    v_mfma_f32_16x16x32_bf16 v[136:139], v[104:107], v[104:107], v[136:139]
    v_mfma_f32_16x16x32_bf16 v[128:131], v[144:147], v[104:107], v[128:131]
    v_mfma_f32_16x16x32_bf16 v[140:143], v[120:123], v[120:123], v[140:143]
    v_mfma_f32_16x16x32_bf16 v[132:135], v[144:147], v[120:123], v[132:135]
    s_waitcnt lgkmcnt(0)
    v_mfma_f32_16x16x32_bf16 v[136:139], v[108:111], v[108:111], v[136:139]
    v_mfma_f32_16x16x32_bf16 v[128:131], v[144:147], v[108:111], v[128:131]
    v_mfma_f32_16x16x32_bf16 v[140:143], v[124:127], v[124:127], v[140:143]
    v_mfma_f32_16x16x32_bf16 v[132:135], v[144:147], v[124:127], v[132:135]
    s_setprio 0
    s_setprio 3
    s_mov_b32 s73, 0x3b000000
    s_mov_b32 s75, 0x3727c5ac
    s_nop 0
    v_cndmask_b32 v37, v136, v137, s[14:15]
    s_nop 0
    v_cndmask_b32 v56, v140, v141, s[14:15]
    v_mul_f32 v64, 0xbb000000, v128
    v_mul_f32 v72, 0xbb000000, v132
    v_cndmask_b32 v37, v37, v138, s[16:17]
    v_cndmask_b32 v56, v56, v142, s[16:17]
    v_mul_f32 v36, v64, v64
    v_mul_f32 v38, v72, v72
    v_cndmask_b32 v37, v37, v139, s[12:13]
    v_cndmask_b32 v56, v56, v143, s[12:13]
    v_fma_f32 v37, v37, s73, -v36
    v_fma_f32 v56, v56, s73, -v38
    v_max_f32 v37, 0, v37
    v_max_f32 v56, 0, v56
    v_add_f32 v69, s75, v37
    v_add_f32 v77, s75, v56
    v_fma_f32 v37, v69, s75, v37
    v_fma_f32 v56, v77, s75, v56
    v_rsq_f32 v36, v37
    v_rsq_f32 v38, v56
    v_sqrt_f32 v67, v37
    v_sqrt_f32 v75, v56
    v_mul_f32 v37, v36, v36
    v_mul_f32 v56, v38, v38
    v_mul_f32 v65, 0xc0135761, v36
    v_mul_f32 v73, 0xc0135761, v38
    v_mul_f32 v37, 0x3d372713, v37
    v_mul_f32 v56, 0x3d372713, v56
    v_mul_f32 v66, v65, v37
    v_mul_f32 v74, v73, v56
    s_mov_b64 exec, s[10:11]
    ds_write_b128 v149, v[64:67] offset:0
    ds_write_b128 v149, v[72:75] offset:256
    s_mov_b64 exec, -1
    s_setprio 0
    s_waitcnt lgkmcnt(0)
    s_barrier
    v_rsq_f32 v69, v69
    v_mov_b32 v68, v64
    v_mov_b32 v71, 0
    v_mul_f32 v70, 0x3fb8aa3b, v69
    v_rsq_f32 v77, v77
    v_mov_b32 v76, v72
    v_mov_b32 v79, 0
    v_mul_f32 v78, 0x3fb8aa3b, v77
    s_mov_b64 exec, s[10:11]
    ds_write_b128 v149, v[68:71] offset:1024
    ds_write_b32 v148, v64 offset:0
    ds_write_b32 v148, v69 offset:256
    ds_write_b32 v148, v70 offset:512
    ds_write_b128 v149, v[76:79] offset:1280
    ds_write_b32 v148, v72 offset:64
    ds_write_b32 v148, v77 offset:320
    ds_write_b32 v148, v78 offset:576
    s_mov_b64 exec, -1
    s_waitcnt lgkmcnt(0)
    s_mov_b32 s90, 5
    s_mov_b32 s4, 281026592
    s_mov_b32 s5, 68
L_e2:
    s_cmp_gt_u32 s90, 6
    s_cbranch_scc1 L_e2d
    s_barrier
    s_add_u32 s90, s90, 1
    s_branch L_e2
L_e2d:
    s_lshr_b32 s73, s68, 1
    s_mul_i32 s73, s73, 114688
    s_mul_i32 s75, s69, 448
    s_add_u32 s73, s73, s75
    s_and_b32 s75, s68, 1
    s_lshl_b32 s75, s75, 1
    s_add_u32 s75, s75, s72
    s_mul_i32 s75, s75, 112
    s_add_u32 s73, s73, s75
    v_lshrrev_b32 v46, 5, v0
    v_mul_u32_u24 v46, 57344, v46
    v_and_b32 v45, 31, v0
    v_lshl_add_u32 v46, v45, 2, v46
    v_cmp_gt_u32 vcc, 28, v45
    s_nop 1
    v_cndmask_b32_e64 v46, v54, v46, vcc
    buffer_load_dword v160, v46, s[48:51], s73 offen
    s_add_u32 s73, s73, 3584
    buffer_load_dword v161, v46, s[48:51], s73 offen
    s_add_u32 s73, s73, 3584
    buffer_load_dword v162, v46, s[48:51], s73 offen
    s_add_u32 s73, s73, 3584
    buffer_load_dword v163, v46, s[48:51], s73 offen
    s_add_u32 s73, s73, 3584
    buffer_load_dword v164, v46, s[48:51], s73 offen
    s_add_u32 s73, s73, 3584
    buffer_load_dword v165, v46, s[48:51], s73 offen
    s_add_u32 s73, s73, 3584
    buffer_load_dword v166, v46, s[48:51], s73 offen
    s_add_u32 s73, s73, 3584
    buffer_load_dword v167, v46, s[48:51], s73 offen
    s_add_u32 s73, s73, 3584
    buffer_load_dword v168, v46, s[48:51], s73 offen
    s_add_u32 s73, s73, 3584
    buffer_load_dword v169, v46, s[48:51], s73 offen
    s_add_u32 s73, s73, 3584
    buffer_load_dword v170, v46, s[48:51], s73 offen
    s_add_u32 s73, s73, 3584
    buffer_load_dword v171, v46, s[48:51], s73 offen
    s_add_u32 s73, s73, 3584
    buffer_load_dword v172, v46, s[48:51], s73 offen
    s_add_u32 s73, s73, 3584
    buffer_load_dword v173, v46, s[48:51], s73 offen
    s_add_u32 s73, s73, 3584
    buffer_load_dword v174, v46, s[48:51], s73 offen
    s_add_u32 s73, s73, 3584
    buffer_load_dword v175, v46, s[48:51], s73 offen
L_w3:
    s_bitcmp1_b64 s[4:5], s90
    s_cselect_b32 s91, 6, 1
L_w3s:
    s_getreg_b32 s73, hwreg(HW_REG_IB_STS)
    s_and_b32 s73, s73, 12582927
    s_cbranch_scc0 L_w3d
    s_sub_u32 s91, s91, 1
    s_cmp_lg_u32 s91, 0
    s_cbranch_scc1 L_w3s
    s_cmp_ge_u32 s90, 22
    s_cbranch_scc1 L_w3d
    s_barrier
    s_add_u32 s90, s90, 1
    s_branch L_w3
L_w3d:
    s_waitcnt vmcnt(0)
    v_lshlrev_b32 v192, 16, v160
    v_and_b32 v193, 0xffff0000, v160
    v_lshlrev_b32 v196, 16, v161
    v_and_b32 v197, 0xffff0000, v161
    v_add_f32 v192, v192, v196
    v_add_f32 v193, v193, v197
    v_lshlrev_b32 v196, 16, v162
    v_and_b32 v197, 0xffff0000, v162
    v_add_f32 v192, v192, v196
    v_add_f32 v193, v193, v197
    v_lshlrev_b32 v196, 16, v163
    v_and_b32 v197, 0xffff0000, v163
    v_add_f32 v192, v192, v196
    v_add_f32 v193, v193, v197
    v_lshlrev_b32 v196, 16, v164
    v_and_b32 v197, 0xffff0000, v164
    v_add_f32 v192, v192, v196
    v_add_f32 v193, v193, v197
    v_lshlrev_b32 v196, 16, v165
    v_and_b32 v197, 0xffff0000, v165
    v_add_f32 v192, v192, v196
    v_add_f32 v193, v193, v197
    s_cmp_ge_u32 s90, 22
    s_cbranch_scc1 L_y4
    s_barrier
    s_add_u32 s90, s90, 1
L_y4:
    v_lshlrev_b32 v196, 16, v166
    v_and_b32 v197, 0xffff0000, v166
    v_add_f32 v192, v192, v196
    v_add_f32 v193, v193, v197
    v_lshlrev_b32 v196, 16, v167
    v_and_b32 v197, 0xffff0000, v167
    v_add_f32 v192, v192, v196
    v_add_f32 v193, v193, v197
    v_lshlrev_b32 v196, 16, v168
    v_and_b32 v197, 0xffff0000, v168
    v_add_f32 v192, v192, v196
    v_add_f32 v193, v193, v197
    v_lshlrev_b32 v196, 16, v169
    v_and_b32 v197, 0xffff0000, v169
    v_add_f32 v192, v192, v196
    v_add_f32 v193, v193, v197
    v_lshlrev_b32 v196, 16, v170
    v_and_b32 v197, 0xffff0000, v170
    v_add_f32 v192, v192, v196
    v_add_f32 v193, v193, v197
    v_lshlrev_b32 v196, 16, v171
    v_and_b32 v197, 0xffff0000, v171
    s_cmp_ge_u32 s90, 22
    s_cbranch_scc1 L_y5
    s_barrier
    s_add_u32 s90, s90, 1
L_y5:
    v_add_f32 v192, v192, v196
    v_add_f32 v193, v193, v197
    v_lshlrev_b32 v196, 16, v172
    v_and_b32 v197, 0xffff0000, v172
    v_add_f32 v192, v192, v196
    v_add_f32 v193, v193, v197
    v_lshlrev_b32 v196, 16, v173
    v_and_b32 v197, 0xffff0000, v173
    v_add_f32 v192, v192, v196
    v_add_f32 v193, v193, v197
    v_lshlrev_b32 v196, 16, v174
    v_and_b32 v197, 0xffff0000, v174
    v_add_f32 v192, v192, v196
    v_add_f32 v193, v193, v197
    v_lshlrev_b32 v196, 16, v175
    v_and_b32 v197, 0xffff0000, v175
    v_add_f32 v192, v192, v196
    v_add_f32 v193, v193, v197
    s_nop 1
    v_permlane32_swap_b32 v192, v193
    v_add_f32 v192, v192, v193
    v_and_b32 v45, 31, v0
    v_lshrrev_b32 v46, 5, v0
    v_lshlrev_b32 v46, 2, v46
    v_lshl_add_u32 v46, v45, 3, v46
    v_cmp_gt_u32 vcc, 28, v45
    s_nop 1
    v_cndmask_b32 v46, v54, v46, vcc
    s_lshr_b32 s73, s68, 1
    s_lshl_b32 s73, s73, 10
    s_and_b32 s75, s68, 1
    s_lshl_b32 s75, s75, 1
    s_add_u32 s75, s75, s72
    s_mul_i32 s75, s75, 224
    s_add_u32 s73, s73, s75
    s_add_u32 s73, s73, s88
    s_add_u32 s73, s73, 163840
    buffer_store_dword v192, v46, s[60:63], s73 offen sc1
L_w6:
    s_bitcmp1_b64 s[4:5], s90
    s_cselect_b32 s91, 6, 1
L_w6s:
    s_getreg_b32 s73, hwreg(HW_REG_IB_STS)
    s_and_b32 s73, s73, 12582927
    s_cbranch_scc0 L_w6d
    s_sub_u32 s91, s91, 1
    s_cmp_lg_u32 s91, 0
    s_cbranch_scc1 L_w6s
    s_cmp_ge_u32 s90, 22
    s_cbranch_scc1 L_w6d
    s_barrier
    s_add_u32 s90, s90, 1
    s_branch L_w6
L_w6d:
    s_waitcnt vmcnt(0)
L_e7:
    s_cmp_gt_u32 s90, 5
    s_cbranch_scc1 L_e7d
    s_barrier
    s_add_u32 s90, s90, 1
    s_branch L_e7
L_e7d:
    s_lshl_b32 s9, s68, 1
    s_add_u32 s9, s9, s72
    s_lshr_b32 s73, s9, 3
    s_lshl_b32 s73, s73, 7
    s_and_b32 s75, s9, 7
    s_lshl_b32 s75, s75, 2
    s_add_u32 s73, s73, s75
    s_add_u32 s73, s73, s85
    s_add_u32 s73, s73, 0
    v_mov_b32 v47, 0
    s_mov_b64 exec, 1
    buffer_store_dword v29, v47, s[60:63], s73 offen sc1
    s_mov_b64 exec, -1
L_e8:
    s_cmp_gt_u32 s90, 18
    s_cbranch_scc1 L_e8d
    s_barrier
    s_add_u32 s90, s90, 1
    s_branch L_e8
L_e8d:
    v_and_b32 v30, 63, v0
    v_lshrrev_b32 v47, 3, v30
    v_and_b32 v30, 7, v30
    v_lshlrev_b32 v30, 2, v30
    v_lshl_add_u32 v30, v47, 7, v30
    s_mov_b32 s6, 200000
    s_add_u32 s9, s85, 0
L_c9:
    buffer_load_dword v35, v30, s[60:63], s9 offen sc1
L_w10:
    s_bitcmp1_b64 s[4:5], s90
    s_cselect_b32 s91, 6, 1
L_w10s:
    s_getreg_b32 s73, hwreg(HW_REG_IB_STS)
    s_and_b32 s73, s73, 12582927
    s_cbranch_scc0 L_w10d
    s_sub_u32 s91, s91, 1
    s_cmp_lg_u32 s91, 0
    s_cbranch_scc1 L_w10s
    s_cmp_ge_u32 s90, 22
    s_cbranch_scc1 L_w10d
    s_barrier
    s_add_u32 s90, s90, 1
    s_branch L_w10
L_w10d:
    s_waitcnt vmcnt(0)
    v_cmp_ne_u32 vcc, 1, v35
    s_sub_u32 s6, s6, 1
    s_cmp_eq_u32 s6, 0
    s_cbranch_scc1 L_c9d
    s_cbranch_vccz L_c9d
    s_cmp_ge_u32 s90, 22
    s_cbranch_scc1 L_y11
    s_barrier
    s_add_u32 s90, s90, 1
L_y11:
    s_cmp_ge_u32 s90, 22
    s_cbranch_scc1 L_y12
    s_barrier
    s_add_u32 s90, s90, 1
L_y12:
    s_branch L_c9
L_c9d:
    v_lshlrev_b32 v40, 4, v0
    v_cmp_gt_u32 vcc, 56, v0
    s_nop 1
    v_cndmask_b32 v40, v54, v40, vcc
    s_lshl_b32 s75, s72, 13
    s_add_u32 s75, s75, s88
    s_add_u32 s75, s75, 163840
    s_add_u32 s73, s75, 0
    buffer_load_dwordx4 v[160:163], v40, s[60:63], s73 offen offset:0 sc1
    buffer_load_dwordx4 v[164:167], v40, s[60:63], s73 offen offset:1024 sc1
    buffer_load_dwordx4 v[168:171], v40, s[60:63], s73 offen offset:2048 sc1
    buffer_load_dwordx4 v[172:175], v40, s[60:63], s73 offen offset:3072 sc1
    s_add_u32 s73, s75, 4096
    buffer_load_dwordx4 v[176:179], v40, s[60:63], s73 offen offset:0 sc1
    buffer_load_dwordx4 v[180:183], v40, s[60:63], s73 offen offset:1024 sc1
    buffer_load_dwordx4 v[184:187], v40, s[60:63], s73 offen offset:2048 sc1
    buffer_load_dwordx4 v[188:191], v40, s[60:63], s73 offen offset:3072 sc1
L_w13:
    s_bitcmp1_b64 s[4:5], s90
    s_cselect_b32 s91, 6, 1
L_w13s:
    s_getreg_b32 s73, hwreg(HW_REG_IB_STS)
    s_and_b32 s73, s73, 12582927
    s_cbranch_scc0 L_w13d
    s_sub_u32 s91, s91, 1
    s_cmp_lg_u32 s91, 0
    s_cbranch_scc1 L_w13s
    s_cmp_ge_u32 s90, 22
    s_cbranch_scc1 L_w13d
    s_barrier
    s_add_u32 s90, s90, 1
    s_branch L_w13
L_w13d:
    s_waitcnt vmcnt(0)
    v_add_f32 v160, v160, v176
    v_add_f32 v161, v161, v177
    v_add_f32 v162, v162, v178
    v_add_f32 v163, v163, v179
    v_add_f32 v164, v164, v180
    v_add_f32 v165, v165, v181
    v_add_f32 v166, v166, v182
    v_add_f32 v167, v167, v183
    v_add_f32 v168, v168, v184
    v_add_f32 v169, v169, v185
    v_add_f32 v170, v170, v186
    v_add_f32 v171, v171, v187
    v_add_f32 v172, v172, v188
    v_add_f32 v173, v173, v189
    v_add_f32 v174, v174, v190
    v_add_f32 v175, v175, v191
    v_add_f32 v160, v160, v168
    v_add_f32 v161, v161, v169
    v_add_f32 v162, v162, v170
    v_add_f32 v163, v163, v171
    v_add_f32 v164, v164, v172
    v_add_f32 v165, v165, v173
    v_add_f32 v166, v166, v174
    v_add_f32 v167, v167, v175
    v_add_f32 v160, v160, v164
    v_add_f32 v161, v161, v165
    v_add_f32 v162, v162, v166
    v_add_f32 v163, v163, v167
    v_lshlrev_b32 v57, 4, v0
    v_add_u32 v57, 157696, v57
L_e14:
    s_cmp_gt_u32 s90, 17
    s_cbranch_scc1 L_e14d
    s_barrier
    s_add_u32 s90, s90, 1
    s_branch L_e14
L_e14d:
    s_cmp_eq_u32 s72, 0
    s_cbranch_scc1 L_cs1a
    ds_write_b128 v57, v[160:163] offset:1024
    s_waitcnt lgkmcnt(0)
L_cs1a:
    s_lshl_b32 s7, s69, 1
    s_add_u32 s7, s7, s72
    s_lshl_b32 s8, s7, 2
    s_lshl_b32 s7, s7, 12
    s_add_u32 s7, s7, s87
    s_add_u32 s7, s7, 4194304
    s_lshl_b32 s73, s68, 7
    s_add_u32 s8, s8, s73
    s_add_u32 s8, s8, 13705216
    v_mov_b32 v33, s8
L_e15:
    s_cmp_gt_u32 s90, 22
    s_cbranch_scc1 L_e15d
    s_barrier
    s_add_u32 s90, s90, 1
    s_branch L_e15
L_e15d:
    s_cmp_lg_u32 s72, 0
    s_cbranch_scc1 L_cs1b
    ds_read_b128 v[164:167], v57 offset:1024
    s_waitcnt lgkmcnt(0)
    v_add_f32 v160, v160, v164
    v_add_f32 v161, v161, v165
    v_add_f32 v162, v162, v166
    v_add_f32 v163, v163, v167
    ds_write_b128 v57, v[160:163]
    s_waitcnt lgkmcnt(0)
L_cs1b:
    s_lshl_b32 s73, s72, 12
    s_add_u32 s73, s73, 147456
    v_lshl_add_u32 v40, v0, 3, s73
    ds_read_b64 v[64:65], v40 offset:0
    ds_read_b64 v[66:67], v40 offset:512
    ds_read_b64 v[68:69], v40 offset:1024
    ds_read_b64 v[70:71], v40 offset:1536
    ds_read_b64 v[72:73], v40 offset:2048
    ds_read_b64 v[74:75], v40 offset:2560
    ds_read_b64 v[76:77], v40 offset:3072
    ds_read_b64 v[78:79], v40 offset:3584
    s_waitcnt lgkmcnt(0)
L_e16:
    s_cmp_gt_u32 s90, 22
    s_cbranch_scc1 L_e16d
    s_barrier
    s_add_u32 s90, s90, 1
    s_branch L_e16
L_e16d:
    v_and_b32 v30, 31, v0
    v_lshrrev_b32 v47, 3, v30
    v_and_b32 v30, 7, v30
    v_lshlrev_b32 v30, 2, v30
    v_lshl_add_u32 v30, v47, 7, v30
    s_mov_b32 s6, 200000
    s_add_u32 s9, s85, 1024
L_c17:
    buffer_load_dword v35, v30, s[60:63], s9 offen sc1
L_w18:
    s_bitcmp1_b64 s[4:5], s90
    s_cselect_b32 s91, 6, 1
L_w18s:
    s_getreg_b32 s73, hwreg(HW_REG_IB_STS)
    s_and_b32 s73, s73, 12582927
    s_cbranch_scc0 L_w18d
    s_sub_u32 s91, s91, 1
    s_cmp_lg_u32 s91, 0
    s_cbranch_scc1 L_w18s
    s_cmp_ge_u32 s90, 39
    s_cbranch_scc1 L_w18d
    s_barrier
    s_add_u32 s90, s90, 1
    s_branch L_w18
L_w18d:
    s_waitcnt vmcnt(0)
    v_cmp_ne_u32 vcc, 1, v35
    s_sub_u32 s6, s6, 1
    s_cmp_eq_u32 s6, 0
    s_cbranch_scc1 L_c17d
    s_cbranch_vccz L_c17d
    s_cmp_ge_u32 s90, 39
    s_cbranch_scc1 L_y19
    s_barrier
    s_add_u32 s90, s90, 1
L_y19:
    s_cmp_ge_u32 s90, 39
    s_cbranch_scc1 L_y20
    s_barrier
    s_add_u32 s90, s90, 1
L_y20:
    s_branch L_c17
L_c17d:
    v_lshrrev_b32 v41, 4, v0
    v_lshlrev_b32 v41, 4, v41
    v_and_b32 v40, 15, v0
    v_lshl_add_u32 v40, v40, 6, v41
    s_lshl_b32 s73, s72, 11
    s_add_u32 s75, s73, s88
    s_add_u32 s75, s75, 0
    buffer_load_dwordx4 v[192:195], v40, s[60:63], s75 offen offset:0 sc1
    buffer_load_dwordx4 v[196:199], v40, s[60:63], s75 offen offset:1024 sc1
    s_lshl_b32 s75, s72, 7
    s_add_u32 s75, s75, s88
    s_add_u32 s75, s75, 4096
    buffer_load_dwordx4 v[200:203], v41, s[60:63], s75 offen offset:0 sc1
    buffer_load_dwordx4 v[204:207], v41, s[60:63], s75 offen offset:64 sc1
    s_lshl_b32 s73, s72, 11
    s_add_u32 s75, s73, s88
    s_add_u32 s75, s75, 8192
    buffer_load_dwordx4 v[208:211], v40, s[60:63], s75 offen offset:0 sc1
    buffer_load_dwordx4 v[212:215], v40, s[60:63], s75 offen offset:1024 sc1
    s_lshl_b32 s75, s72, 7
    s_add_u32 s75, s75, s88
    s_add_u32 s75, s75, 12288
    buffer_load_dwordx4 v[216:219], v41, s[60:63], s75 offen offset:0 sc1
    buffer_load_dwordx4 v[220:223], v41, s[60:63], s75 offen offset:64 sc1
    s_lshl_b32 s73, s72, 11
    s_add_u32 s75, s73, s88
    s_add_u32 s75, s75, 16384
    buffer_load_dwordx4 v[224:227], v40, s[60:63], s75 offen offset:0 sc1
    buffer_load_dwordx4 v[228:231], v40, s[60:63], s75 offen offset:1024 sc1
    s_lshl_b32 s75, s72, 7
    s_add_u32 s75, s75, s88
    s_add_u32 s75, s75, 20480
    buffer_load_dwordx4 v[232:235], v41, s[60:63], s75 offen offset:0 sc1
    buffer_load_dwordx4 v[236:239], v41, s[60:63], s75 offen offset:64 sc1
    s_lshl_b32 s73, s72, 11
    s_add_u32 s75, s73, s88
    s_add_u32 s75, s75, 24576
    buffer_load_dwordx4 v[240:243], v40, s[60:63], s75 offen offset:0 sc1
    buffer_load_dwordx4 v[244:247], v40, s[60:63], s75 offen offset:1024 sc1
    s_lshl_b32 s75, s72, 7
    s_add_u32 s75, s75, s88
    s_add_u32 s75, s75, 28672
    buffer_load_dwordx4 v[248:251], v41, s[60:63], s75 offen offset:0 sc1
    buffer_load_dwordx4 v[252:255], v41, s[60:63], s75 offen offset:64 sc1
L_w21:
    s_bitcmp1_b64 s[4:5], s90
    s_cselect_b32 s91, 6, 1
L_w21s:
    s_getreg_b32 s73, hwreg(HW_REG_IB_STS)
    s_and_b32 s73, s73, 12582927
    s_cbranch_scc0 L_w21d
    s_sub_u32 s91, s91, 1
    s_cmp_lg_u32 s91, 0
    s_cbranch_scc1 L_w21s
    s_cmp_ge_u32 s90, 39
    s_cbranch_scc1 L_w21d
    s_barrier
    s_add_u32 s90, s90, 1
    s_branch L_w21
L_w21d:
    s_waitcnt vmcnt(0)
    s_setprio 1
    v_add_f32 v192, v192, v224
    v_add_f32 v193, v193, v225
    v_add_f32 v194, v194, v226
    v_add_f32 v195, v195, v227
    v_add_f32 v196, v196, v228
    v_add_f32 v197, v197, v229
    v_add_f32 v198, v198, v230
    v_add_f32 v199, v199, v231
    v_add_f32 v200, v200, v232
    v_add_f32 v201, v201, v233
    v_add_f32 v202, v202, v234
    v_add_f32 v203, v203, v235
    v_add_f32 v204, v204, v236
    v_add_f32 v205, v205, v237
    v_add_f32 v206, v206, v238
    v_add_f32 v207, v207, v239
    v_add_f32 v208, v208, v240
    v_add_f32 v209, v209, v241
    v_add_f32 v210, v210, v242
    v_add_f32 v211, v211, v243
    v_add_f32 v212, v212, v244
    v_add_f32 v213, v213, v245
    v_add_f32 v214, v214, v246
    v_add_f32 v215, v215, v247
    v_add_f32 v216, v216, v248
    v_add_f32 v217, v217, v249
    v_add_f32 v218, v218, v250
    v_add_f32 v219, v219, v251
    v_add_f32 v220, v220, v252
    v_add_f32 v221, v221, v253
    v_add_f32 v222, v222, v254
    v_add_f32 v223, v223, v255
    v_add_f32 v192, v192, v208
    v_add_f32 v193, v193, v209
    v_add_f32 v194, v194, v210
    v_add_f32 v195, v195, v211
    v_add_f32 v196, v196, v212
    v_add_f32 v197, v197, v213
    v_add_f32 v198, v198, v214
    v_add_f32 v199, v199, v215
    v_add_f32 v200, v200, v216
    v_add_f32 v201, v201, v217
    v_add_f32 v202, v202, v218
    v_add_f32 v203, v203, v219
    v_add_f32 v204, v204, v220
    v_add_f32 v205, v205, v221
    v_add_f32 v206, v206, v222
    v_add_f32 v207, v207, v223
    v_cvt_pk_bf16_f32 v96, v192, v193
    v_cvt_pk_bf16_f32 v97, v194, v195
    v_cvt_pk_bf16_f32 v100, v200, v201
    v_cvt_pk_bf16_f32 v101, v202, v203
    v_cvt_pk_bf16_f32 v98, v196, v197
    v_cvt_pk_bf16_f32 v99, v198, v199
    v_cvt_pk_bf16_f32 v102, v204, v205
    v_cvt_pk_bf16_f32 v103, v206, v207
    s_setprio 3
    s_nop 0
    v_mfma_f32_16x16x16_bf16 v[136:139], v[100:101], v[64:65], 0
    v_mfma_f32_16x16x16_bf16 v[140:143], v[100:101], v[66:67], 0
    v_mfma_f32_16x16x16_bf16 v[144:147], v[100:101], v[68:69], 0
    v_mfma_f32_16x16x16_bf16 v[148:151], v[100:101], v[70:71], 0
    v_mfma_f32_16x16x16_bf16 v[152:155], v[102:103], v[72:73], 0
    v_mfma_f32_16x16x16_bf16 v[156:159], v[102:103], v[74:75], 0
    v_mfma_f32_16x16x16_bf16 v[160:163], v[102:103], v[76:77], 0
    v_mfma_f32_16x16x16_bf16 v[164:167], v[102:103], v[78:79], 0
    v_mfma_f32_16x16x16_bf16 v[104:107], v[96:97], v[64:65], 0
    v_mfma_f32_16x16x16_bf16 v[108:111], v[96:97], v[66:67], 0
    v_mfma_f32_16x16x16_bf16 v[112:115], v[96:97], v[68:69], 0
    v_mfma_f32_16x16x16_bf16 v[116:119], v[96:97], v[70:71], 0
    v_mfma_f32_16x16x16_bf16 v[120:123], v[98:99], v[72:73], 0
    v_mfma_f32_16x16x16_bf16 v[124:127], v[98:99], v[74:75], 0
    v_mfma_f32_16x16x16_bf16 v[128:131], v[98:99], v[76:77], 0
    v_mfma_f32_16x16x16_bf16 v[132:135], v[98:99], v[78:79], 0
    s_setprio 0
    s_setprio 1
    v_add_f32 v136, s80, v136
    v_add_f32 v140, s80, v140
    v_add_f32 v144, s80, v144
    v_add_f32 v148, s80, v148
    v_add_f32 v152, s80, v152
    v_add_f32 v156, s80, v156
    v_add_f32 v160, s80, v160
    v_add_f32 v164, s80, v164
    v_rcp_f32 v136, v136
    v_rcp_f32 v140, v140
    v_rcp_f32 v144, v144
    v_rcp_f32 v148, v148
    v_rcp_f32 v152, v152
    v_rcp_f32 v156, v156
    v_rcp_f32 v160, v160
    v_rcp_f32 v164, v164
    v_mul_f32 v104, v104, v136
    v_mul_f32 v105, v105, v136
    v_mul_f32 v106, v106, v136
    v_mul_f32 v107, v107, v136
    v_mul_f32 v108, v108, v140
    s_cmp_ge_u32 s90, 39
    s_cbranch_scc1 L_y22
    s_barrier
    s_add_u32 s90, s90, 1
L_y22:
    v_mul_f32 v109, v109, v140
    v_mul_f32 v110, v110, v140
    v_mul_f32 v111, v111, v140
    v_cvt_pk_bf16_f32 v168, v104, v105
    v_cvt_pk_bf16_f32 v169, v106, v107
    v_cvt_pk_bf16_f32 v170, v108, v109
    v_cvt_pk_bf16_f32 v171, v110, v111
    s_nop 0
    v_permlane16_swap_b32 v168, v170
    v_permlane16_swap_b32 v169, v171
    buffer_store_dwordx4 v[168:171], v32, s[60:63], s7 offen offset:0 sc1
    v_mul_f32 v112, v112, v144
    v_mul_f32 v113, v113, v144
    v_mul_f32 v114, v114, v144
    v_mul_f32 v115, v115, v144
    v_mul_f32 v116, v116, v148
    v_mul_f32 v117, v117, v148
    v_mul_f32 v118, v118, v148
    v_mul_f32 v119, v119, v148
    v_cvt_pk_bf16_f32 v172, v112, v113
    v_cvt_pk_bf16_f32 v173, v114, v115
    v_cvt_pk_bf16_f32 v174, v116, v117
    v_cvt_pk_bf16_f32 v175, v118, v119
    s_nop 0
    v_permlane16_swap_b32 v172, v174
    v_permlane16_swap_b32 v173, v175
    buffer_store_dwordx4 v[172:175], v32, s[60:63], s7 offen offset:512 sc1
    v_mul_f32 v120, v120, v152
    v_mul_f32 v121, v121, v152
    v_mul_f32 v122, v122, v152
    v_mul_f32 v123, v123, v152
    v_mul_f32 v124, v124, v156
    v_mul_f32 v125, v125, v156
    v_mul_f32 v126, v126, v156
    v_mul_f32 v127, v127, v156
    v_cvt_pk_bf16_f32 v176, v120, v121
    v_cvt_pk_bf16_f32 v177, v122, v123
    v_cvt_pk_bf16_f32 v178, v124, v125
    v_cvt_pk_bf16_f32 v179, v126, v127
    s_nop 0
    v_permlane16_swap_b32 v176, v178
    v_permlane16_swap_b32 v177, v179
    buffer_store_dwordx4 v[176:179], v32, s[60:63], s7 offen offset:2048 sc1
    s_cmp_ge_u32 s90, 39
    s_cbranch_scc1 L_y23
    s_barrier
    s_add_u32 s90, s90, 1
L_y23:
    v_mul_f32 v128, v128, v160
    v_mul_f32 v129, v129, v160
    v_mul_f32 v130, v130, v160
    v_mul_f32 v131, v131, v160
    v_mul_f32 v132, v132, v164
    v_mul_f32 v133, v133, v164
    v_mul_f32 v134, v134, v164
    v_mul_f32 v135, v135, v164
    v_cvt_pk_bf16_f32 v180, v128, v129
    v_cvt_pk_bf16_f32 v181, v130, v131
    v_cvt_pk_bf16_f32 v182, v132, v133
    v_cvt_pk_bf16_f32 v183, v134, v135
    s_nop 0
    v_permlane16_swap_b32 v180, v182
    v_permlane16_swap_b32 v181, v183
    buffer_store_dwordx4 v[180:183], v32, s[60:63], s7 offen offset:2560 sc1
L_w24:
    s_bitcmp1_b64 s[4:5], s90
    s_cselect_b32 s91, 6, 1
L_w24s:
    s_getreg_b32 s73, hwreg(HW_REG_IB_STS)
    s_and_b32 s73, s73, 12582927
    s_cbranch_scc0 L_w24d
    s_sub_u32 s91, s91, 1
    s_cmp_lg_u32 s91, 0
    s_cbranch_scc1 L_w24s
    s_cmp_ge_u32 s90, 39
    s_cbranch_scc1 L_w24d
    s_barrier
    s_add_u32 s90, s90, 1
    s_branch L_w24
L_w24d:
    s_waitcnt vmcnt(0)
    s_mov_b64 exec, 1
    buffer_store_dword v29, v33, s[60:63], 0 offen sc1
    s_mov_b64 exec, -1
L_w25:
    s_bitcmp1_b64 s[4:5], s90
    s_cselect_b32 s91, 6, 1
L_w25s:
    s_getreg_b32 s73, hwreg(HW_REG_IB_STS)
    s_and_b32 s73, s73, 12582927
    s_cbranch_scc0 L_w25d
    s_sub_u32 s91, s91, 1
    s_cmp_lg_u32 s91, 0
    s_cbranch_scc1 L_w25s
    s_cmp_ge_u32 s90, 54
    s_cbranch_scc1 L_w25d
    s_barrier
    s_add_u32 s90, s90, 1
    s_branch L_w25
L_w25d:
    s_waitcnt vmcnt(0)
    s_endpgm
L_sync:
    s_setprio 3
    s_waitcnt lgkmcnt(0)
    s_mov_b32 s80, 0x358637bd
    s_mov_b32 s81, 0x358637bd
    s_mov_b32 s82, 0x3f803f80
    s_mov_b32 s40, s12
    s_and_b32 s41, s13, 0xffff
    s_mov_b32 s42, 524288
    s_mov_b32 s43, 0x20000
    s_mov_b32 s32, s6
    s_and_b32 s33, s7, 0xffff
    s_mov_b32 s34, 1572864
    s_mov_b32 s35, 0x20000
    s_mov_b32 s36, s8
    s_and_b32 s37, s9, 0xffff
    s_mov_b32 s38, 524288
    s_mov_b32 s39, 0x20000
    s_mov_b32 s44, s14
    s_and_b32 s45, s15, 0xffff
    s_mov_b32 s46, 524288
    s_mov_b32 s47, 0x20000
    s_mov_b32 s48, s16
    s_and_b32 s49, s17, 0xffff
    s_mov_b32 s50, 1835008
    s_mov_b32 s51, 0x20000
    s_mov_b32 s52, s18
    s_and_b32 s53, s19, 0xffff
    s_mov_b32 s54, 1835008
    s_mov_b32 s55, 0x20000
    s_mov_b32 s56, s20
    s_and_b32 s57, s21, 0xffff
    s_mov_b32 s58, 2097152
    s_mov_b32 s59, 0x20000
    s_mov_b32 s60, s24
    s_and_b32 s61, s25, 0xffff
    s_mov_b32 s62, 18874368
    s_mov_b32 s63, 0x20000
    s_mov_b32 s64, s22
    s_and_b32 s65, s23, 0xffff
    s_mov_b32 s66, 256
    s_mov_b32 s67, 0x20000
    v_mov_b32 v54, 2147483648
    v_lshlrev_b32 v55, 7, v0
    v_mov_b32 v29, 1
    v_lshrrev_b32 v40, 5, v0
    v_and_b32 v41, 31, v0
    v_lshlrev_b32 v32, 10, v40
    v_lshl_add_u32 v32, v41, 4, v32
    s_lshl_b32 s87, s68, 16
    s_lshl_b32 s88, s69, 18
    s_add_u32 s88, s88, 14680064
    s_lshl_b32 s85, s69, 12
    s_add_u32 s85, s85, 13631488
    s_lshl_b32 s73, s68, 7
    s_add_u32 s73, s73, 13697024
    s_lshl_b32 s75, s69, 2
    s_add_u32 s75, s75, s73
    v_mov_b32 v26, s75
    v_and_b32 v34, 7, v0
    v_lshlrev_b32 v34, 2, v34
    v_add_u32 v27, s73, v34
    v_and_b32 v34, 15, v0
    v_lshlrev_b32 v34, 2, v34
    v_add_u32 v33, s73, v34
    v_and_b32 v34, 31, v0
    v_lshlrev_b32 v34, 2, v34
    s_cmp_eq_u32 s68, 0
    s_cselect_b32 s75, 0, -128
    s_cmp_eq_u32 s68, 31
    s_cselect_b32 s76, 0, 128
    v_lshrrev_b32 v43, 3, v0
    v_mov_b32 v44, 0
    v_mov_b32 v45, s75
    v_mov_b32 v46, s76
    v_cmp_eq_u32 vcc, 1, v43
    s_nop 1
    v_cndmask_b32 v44, v44, v45, vcc
    v_cmp_eq_u32 vcc, 2, v43
    s_nop 1
    v_cndmask_b32 v44, v44, v46, vcc
    v_add_u32 v28, v27, v44
    s_barrier
    s_barrier
    s_barrier
    s_mov_b32 s73, 0
    buffer_load_dword v35, v34, s[64:67], s73 offen sc1
    s_barrier
    s_barrier
    s_waitcnt vmcnt(0)
    s_mov_b32 s90, 200000
    s_mov_b32 s73, 0
L_p26:
    v_cmp_ne_u32 vcc, 1, v35
    s_sub_u32 s90, s90, 1
    s_cmp_eq_u32 s90, 0
    s_cbranch_vccz L_p26d
    s_cbranch_scc1 L_p26d
    buffer_load_dword v35, v34, s[64:67], s73 offen sc1
    s_waitcnt vmcnt(0)
    s_branch L_p26
L_p26d:
    s_barrier
    s_barrier
    s_mov_b32 s73, 0
    s_mov_b64 exec, 1
    buffer_store_dword v29, v26, s[60:63], s73 offen sc1
    s_mov_b64 exec, -1
    s_barrier
    s_barrier
    s_barrier
    s_mov_b32 s73, 0
    buffer_load_dword v35, v28, s[60:63], s73 offen sc1
    s_barrier
    s_waitcnt vmcnt(0)
    s_mov_b32 s90, 200000
    s_mov_b32 s73, 0
L_p27:
    v_cmp_ne_u32 vcc, 1, v35
    s_sub_u32 s90, s90, 1
    s_cmp_eq_u32 s90, 0
    s_cbranch_vccz L_p27d
    s_cbranch_scc1 L_p27d
    buffer_load_dword v35, v28, s[60:63], s73 offen sc1
    s_waitcnt vmcnt(0)
    s_branch L_p27
L_p27d:
    s_barrier
    s_barrier
    s_barrier
    s_mul_i32 s73, s2, 2048
    v_cmp_gt_u32 vcc, 16, v0
    s_nop 1
    v_cndmask_b32 v47, v54, v55, vcc
    buffer_load_dword v62, v47, s[36:39], s73 offen
    s_mul_i32 s73, s2, 7168
    v_cmp_gt_u32 vcc, 56, v0
    s_nop 1
    v_cndmask_b32 v47, v54, v55, vcc
    buffer_load_dword v62, v47, s[52:55], s73 offen
    s_barrier
    s_barrier
    s_barrier
    s_barrier
    s_barrier
    s_mov_b32 s73, 4096
    s_mov_b64 exec, 1
    buffer_store_dword v29, v26, s[60:63], s73 offen sc1
    s_mov_b64 exec, -1
    s_lshr_b32 s73, s68, 3
    s_lshl_b32 s73, s73, 7
    s_and_b32 s75, s68, 7
    s_lshl_b32 s75, s75, 2
    s_add_u32 s73, s73, s75
    s_add_u32 s73, s73, s85
    s_add_u32 s73, s73, 1024
    v_mov_b32 v47, 0
    s_mov_b64 exec, 1
    buffer_store_dword v29, v47, s[60:63], s73 offen sc1
    s_mov_b64 exec, -1
    s_barrier
    s_barrier
    s_barrier
    s_mov_b32 s73, 4096
    buffer_load_dword v35, v27, s[60:63], s73 offen sc1
    s_waitcnt vmcnt(0)
    s_mov_b32 s90, 200000
    s_mov_b32 s73, 4096
L_p28:
    v_cmp_ne_u32 vcc, 1, v35
    s_sub_u32 s90, s90, 1
    s_cmp_eq_u32 s90, 0
    s_cbranch_vccz L_p28d
    s_cbranch_scc1 L_p28d
    buffer_load_dword v35, v27, s[60:63], s73 offen sc1
    s_waitcnt vmcnt(0)
    s_branch L_p28
L_p28d:
    s_barrier
    s_barrier
    s_lshl_b32 s73, s68, 13
    s_add_u32 s73, s73, 13762560
    s_add_u32 s75, s73, 4096
    v_lshlrev_b32_e64 v40, 3, v0
    buffer_load_dwordx2 v[64:65], v40, s[60:63], s73 offen offset:0 sc1
    buffer_load_dwordx2 v[66:67], v40, s[60:63], s73 offen offset:512 sc1
    buffer_load_dwordx2 v[68:69], v40, s[60:63], s73 offen offset:1024 sc1
    buffer_load_dwordx2 v[70:71], v40, s[60:63], s73 offen offset:1536 sc1
    buffer_load_dwordx2 v[72:73], v40, s[60:63], s73 offen offset:2048 sc1
    buffer_load_dwordx2 v[74:75], v40, s[60:63], s73 offen offset:2560 sc1
    buffer_load_dwordx2 v[76:77], v40, s[60:63], s73 offen offset:3072 sc1
    buffer_load_dwordx2 v[78:79], v40, s[60:63], s73 offen offset:3584 sc1
    buffer_load_dwordx2 v[80:81], v40, s[60:63], s75 offen offset:0 sc1
    buffer_load_dwordx2 v[82:83], v40, s[60:63], s75 offen offset:512 sc1
    buffer_load_dwordx2 v[84:85], v40, s[60:63], s75 offen offset:1024 sc1
    buffer_load_dwordx2 v[86:87], v40, s[60:63], s75 offen offset:1536 sc1
    buffer_load_dwordx2 v[88:89], v40, s[60:63], s75 offen offset:2048 sc1
    buffer_load_dwordx2 v[90:91], v40, s[60:63], s75 offen offset:2560 sc1
    buffer_load_dwordx2 v[92:93], v40, s[60:63], s75 offen offset:3072 sc1
    buffer_load_dwordx2 v[94:95], v40, s[60:63], s75 offen offset:3584 sc1
    s_barrier
    s_barrier
    s_waitcnt vmcnt(0)
    v_add_f32 v64, v64, v80
    v_add_f32 v65, v65, v81
    v_add_f32 v66, v66, v82
    v_add_f32 v67, v67, v83
    v_add_f32 v68, v68, v84
    v_add_f32 v69, v69, v85
    v_add_f32 v70, v70, v86
    v_add_f32 v71, v71, v87
    v_add_f32 v72, v72, v88
    v_add_f32 v73, v73, v89
    v_add_f32 v74, v74, v90
    v_add_f32 v75, v75, v91
    v_add_f32 v76, v76, v92
    v_add_f32 v77, v77, v93
    v_add_f32 v78, v78, v94
    v_add_f32 v79, v79, v95
    v_add_f32 v64, v64, v72
    v_add_f32 v65, v65, v73
    v_add_f32 v66, v66, v74
    v_add_f32 v67, v67, v75
    v_add_f32 v68, v68, v76
    v_add_f32 v69, v69, v77
    v_add_f32 v70, v70, v78
    v_add_f32 v71, v71, v79
    v_add_f32 v64, v64, v68
    v_add_f32 v65, v65, v69
    v_add_f32 v66, v66, v70
    v_add_f32 v67, v67, v71
    v_add_f32 v64, v64, v66
    v_add_f32 v65, v65, v67
    s_barrier
    v_mul_f32 v68, 0xbb000000, v64
    v_mul_f32 v65, 0x3b000000, v65
    v_fma_f32 v65, -v68, v68, v65
    v_max_f32 v65, 0, v65
    v_add_f32 v65, 0x3727c5ac, v65
    v_rsq_f32 v66, v65
    v_sqrt_f32 v71, v65
    v_mul_f32 v69, 0xc0135761, v66
    v_mul_f32 v67, v66, v66
    v_mul_f32 v67, v67, v66
    v_mul_f32 v70, 0xbdd2d3e8, v67
    v_lshlrev_b32 v40, 4, v0
    v_add_u32 v40, 156672, v40
    ds_write_b128 v40, v[68:71]
    s_waitcnt lgkmcnt(0)
    s_barrier
    s_barrier
    s_barrier
    s_barrier
    s_mov_b32 s73, 12288
    s_mov_b64 exec, 1
    buffer_store_dword v29, v26, s[60:63], s73 offen sc1
    s_mov_b64 exec, -1
    s_barrier
    s_barrier
    s_barrier
    s_barrier
    s_mov_b32 s73, 12288
    buffer_load_dword v35, v27, s[60:63], s73 offen sc1
    s_barrier
    s_barrier
    s_waitcnt vmcnt(0)
    s_mov_b32 s90, 200000
    s_mov_b32 s73, 12288
L_p29:
    v_cmp_ne_u32 vcc, 1, v35
    s_sub_u32 s90, s90, 1
    s_cmp_eq_u32 s90, 0
    s_cbranch_vccz L_p29d
    s_cbranch_scc1 L_p29d
    buffer_load_dword v35, v27, s[60:63], s73 offen sc1
    s_waitcnt vmcnt(0)
    s_branch L_p29
L_p29d:
    s_barrier
    s_mov_b32 s73, 16384
    s_mov_b64 exec, 1
    buffer_store_dword v29, v26, s[60:63], s73 offen sc1
    s_mov_b64 exec, -1
    s_mov_b32 s73, 8192
    buffer_load_dword v35, v33, s[60:63], s73 offen sc1
    s_barrier
    s_waitcnt vmcnt(0)
    s_mov_b32 s90, 200000
    s_mov_b32 s73, 8192
L_p30:
    v_cmp_ne_u32 vcc, 1, v35
    s_sub_u32 s90, s90, 1
    s_cmp_eq_u32 s90, 0
    s_cbranch_vccz L_p30d
    s_cbranch_scc1 L_p30d
    buffer_load_dword v35, v33, s[60:63], s73 offen sc1
    s_waitcnt vmcnt(0)
    s_branch L_p30
L_p30d:
    s_barrier
    s_barrier
    s_mov_b32 s73, 20480
    s_mov_b64 exec, 1
    buffer_store_dword v29, v26, s[60:63], s73 offen sc1
    s_mov_b64 exec, -1
    s_barrier
    s_mov_b32 s73, 16384
    buffer_load_dword v35, v27, s[60:63], s73 offen sc1
    s_barrier
    s_waitcnt vmcnt(0)
    s_mov_b32 s90, 200000
    s_mov_b32 s73, 16384
L_p31:
    v_cmp_ne_u32 vcc, 1, v35
    s_sub_u32 s90, s90, 1
    s_cmp_eq_u32 s90, 0
    s_cbranch_vccz L_p31d
    s_cbranch_scc1 L_p31d
    buffer_load_dword v35, v27, s[60:63], s73 offen sc1
    s_waitcnt vmcnt(0)
    s_branch L_p31
L_p31d:
    s_barrier
    s_barrier
    s_barrier
    s_barrier
    s_barrier
    s_mov_b32 s73, 20480
    buffer_load_dword v35, v27, s[60:63], s73 offen sc1
    s_barrier
    s_waitcnt vmcnt(0)
    s_mov_b32 s90, 200000
    s_mov_b32 s73, 20480
L_p32:
    v_cmp_ne_u32 vcc, 1, v35
    s_sub_u32 s90, s90, 1
    s_cmp_eq_u32 s90, 0
    s_cbranch_vccz L_p32d
    s_cbranch_scc1 L_p32d
    buffer_load_dword v35, v27, s[60:63], s73 offen sc1
    s_waitcnt vmcnt(0)
    s_branch L_p32
L_p32d:
    s_barrier
    s_barrier
    s_barrier
    s_endpgm
L_loader:
    s_setprio 2
    s_mov_b32 s80, 0x358637bd
    s_mov_b32 s81, 0x358637bd
    s_mov_b32 s82, 0x3f803f80
    s_mov_b32 s32, s6
    s_and_b32 s33, s7, 0xffff
    s_mov_b32 s34, 1572864
    s_mov_b32 s35, 0x20000
    s_mov_b32 s36, s8
    s_and_b32 s37, s9, 0xffff
    s_mov_b32 s38, 524288
    s_mov_b32 s39, 0x20000
    s_mov_b32 s44, s14
    s_and_b32 s45, s15, 0xffff
    s_mov_b32 s46, 524288
    s_mov_b32 s47, 0x20000
    s_mov_b32 s48, s16
    s_and_b32 s49, s17, 0xffff
    s_mov_b32 s50, 1835008
    s_mov_b32 s51, 0x20000
    s_mov_b32 s52, s18
    s_and_b32 s53, s19, 0xffff
    s_mov_b32 s54, 1835008
    s_mov_b32 s55, 0x20000
    s_mov_b32 s56, s20
    s_and_b32 s57, s21, 0xffff
    s_mov_b32 s58, 2097152
    s_mov_b32 s59, 0x20000
    s_mov_b32 s60, s24
    s_and_b32 s61, s25, 0xffff
    s_mov_b32 s62, 18874368
    s_mov_b32 s63, 0x20000
    s_mov_b32 s64, s22
    s_and_b32 s65, s23, 0xffff
    s_mov_b32 s66, 256
    s_mov_b32 s67, 0x20000
    v_mul_u32_u24 v45, 3072, v40
    v_add_u32 v45, s73, v45
    v_add_u32 v8, v45, v43
    v_add_u32 v9, v45, v44
    v_add_u32 v9, 23552, v9
    v_add_u32 v10, v45, v43
    v_add_u32 v10, 47104, v10
    v_add_u32 v11, v45, v44
    v_add_u32 v11, 70656, v11
    s_mul_i32 s73, s69, 448
    s_and_b32 s77, s69, 1
    s_lshl_b32 s75, s77, 6
    s_add_u32 s75, s75, s73
    v_mul_u32_u24 v45, 3584, v40
    v_add_u32 v45, s75, v45
    v_add_u32 v12, v45, v43
    v_add_u32 v13, v45, v44
    v_add_u32 v13, 27648, v13
    v_add_u32 v14, v45, v43
    v_add_u32 v14, 55296, v14
    v_add_u32 v15, v45, v44
    v_add_u32 v15, 82944, v15
    s_cmp_eq_u32 s77, 0
    s_cselect_b32 s75, 384, 0
    s_add_u32 s75, s75, s73
    v_and_b32 v43, 63, v43
    v_and_b32 v44, 63, v44
    v_lshrrev_b32 v46, 2, v41
    v_mul_u32_u24 v45, 3584, v40
    v_add_u32 v45, s75, v45
    v_add_u32 v16, v45, v43
    v_add_u32 v17, v45, v44
    v_add_u32 v17, 27648, v17
    v_add_u32 v18, v45, v43
    v_add_u32 v18, 55296, v18
    v_add_u32 v19, v45, v44
    v_add_u32 v19, 82944, v19
    s_add_u32 s76, s89, 0
    s_and_b32 s76, s76, 3
    s_mul_i32 s4, s76, 458752
    s_lshl_b32 s18, s76, 14
    s_add_u32 s76, s89, 1
    s_and_b32 s76, s76, 3
    s_mul_i32 s5, s76, 458752
    s_lshl_b32 s19, s76, 14
    s_add_u32 s76, s89, 2
    s_and_b32 s76, s76, 3
    s_mul_i32 s6, s76, 458752
    s_lshl_b32 s20, s76, 14
    s_add_u32 s76, s89, 3
    s_and_b32 s76, s76, 3
    s_mul_i32 s7, s76, 458752
    s_lshl_b32 s21, s76, 14
    s_add_u32 s76, s3, 0
    s_and_b32 s76, s76, 3
    s_mul_i32 s22, s76, 458752
    s_add_u32 s76, s3, 1
    s_and_b32 s76, s76, 3
    s_mul_i32 s23, s76, 458752
    s_add_u32 s76, s3, 2
    s_and_b32 s76, s76, 3
    s_mul_i32 s24, s76, 458752
    s_add_u32 s76, s3, 3
    s_and_b32 s76, s76, 3
    s_mul_i32 s25, s76, 458752
    s_sub_u32 s76, s7, s5
    v_mul_lo_u32 v45, v46, s76
    v_add_u32 v45, s5, v45
    v_add_u32 v20, v16, v45
    v_add_u32 v21, v17, v45
    v_add_u32 v22, v18, v45
    v_add_u32 v23, v19, v45
    s_sub_u32 s76, s6, s4
    v_mul_lo_u32 v45, v46, s76
    v_add_u32 v45, s4, v45
    v_add_u32 v16, v16, v45
    v_add_u32 v17, v17, v45
    v_add_u32 v18, v18, v45
    v_add_u32 v19, v19, v45
    v_lshrrev_b32 v40, 5, v0
    v_and_b32 v41, 31, v0
    v_lshlrev_b32 v40, 10, v40
    v_lshl_add_u32 v40, v41, 4, v40
    s_lshl_b32 s73, s68, 16
    s_add_u32 s73, s73, 2097152
    v_add_u32 v24, s73, v40
    v_subrev_u32 v25, 512, v24
    s_waitcnt vmcnt(16)
    s_barrier
    s_mov_b32 m0, 98304
    s_add_u32 s75, s94, 0
    s_nop 0
    buffer_load_dwordx4 v4, s[40:43], s75 offen offset:0 lds
    buffer_load_dwordx4 v5, s[40:43], s75 offen offset:1024 lds
    buffer_load_dwordx4 v6, s[40:43], s75 offen offset:2048 lds
    buffer_load_dwordx4 v7, s[40:43], s75 offen offset:3072 lds
    s_mov_b32 m0, 102400
    s_add_u32 s75, s94, 32768
    buffer_load_dwordx4 v4, s[40:43], s75 offen offset:0 lds
    buffer_load_dwordx4 v5, s[40:43], s75 offen offset:1024 lds
    buffer_load_dwordx4 v6, s[40:43], s75 offen offset:2048 lds
    buffer_load_dwordx4 v7, s[40:43], s75 offen offset:3072 lds
    s_mov_b32 m0, 106496
    s_add_u32 s75, s94, 65536
    buffer_load_dwordx4 v4, s[40:43], s75 offen offset:0 lds
    buffer_load_dwordx4 v5, s[40:43], s75 offen offset:1024 lds
    buffer_load_dwordx4 v6, s[40:43], s75 offen offset:2048 lds
    buffer_load_dwordx4 v7, s[40:43], s75 offen offset:3072 lds
    s_mov_b32 m0, 110592
    s_add_u32 s75, s94, 98304
    buffer_load_dwordx4 v4, s[40:43], s75 offen offset:0 lds
    buffer_load_dwordx4 v5, s[40:43], s75 offen offset:1024 lds
    buffer_load_dwordx4 v6, s[40:43], s75 offen offset:2048 lds
    buffer_load_dwordx4 v7, s[40:43], s75 offen offset:3072 lds
    s_mov_b32 m0, 114688
    s_add_u32 s75, s95, 0
    s_nop 0
    buffer_load_dwordx4 v4, s[40:43], s75 offen offset:0 lds
    buffer_load_dwordx4 v5, s[40:43], s75 offen offset:1024 lds
    buffer_load_dwordx4 v6, s[40:43], s75 offen offset:2048 lds
    buffer_load_dwordx4 v7, s[40:43], s75 offen offset:3072 lds
    s_mov_b32 m0, 118784
    s_add_u32 s75, s95, 32768
    buffer_load_dwordx4 v4, s[40:43], s75 offen offset:0 lds
    buffer_load_dwordx4 v5, s[40:43], s75 offen offset:1024 lds
    buffer_load_dwordx4 v6, s[40:43], s75 offen offset:2048 lds
    buffer_load_dwordx4 v7, s[40:43], s75 offen offset:3072 lds
    s_mov_b32 m0, 122880
    s_add_u32 s75, s95, 65536
    buffer_load_dwordx4 v4, s[40:43], s75 offen offset:0 lds
    buffer_load_dwordx4 v5, s[40:43], s75 offen offset:1024 lds
    buffer_load_dwordx4 v6, s[40:43], s75 offen offset:2048 lds
    buffer_load_dwordx4 v7, s[40:43], s75 offen offset:3072 lds
    s_mov_b32 m0, 126976
    s_add_u32 s75, s95, 98304
    buffer_load_dwordx4 v4, s[40:43], s75 offen offset:0 lds
    buffer_load_dwordx4 v5, s[40:43], s75 offen offset:1024 lds
    buffer_load_dwordx4 v6, s[40:43], s75 offen offset:2048 lds
    buffer_load_dwordx4 v7, s[40:43], s75 offen offset:3072 lds
    s_waitcnt vmcnt(32)
    s_barrier
    s_mov_b32 m0, 131072
    s_add_u32 s75, s96, 1024
    buffer_load_dwordx4 v8, s[32:35], s75 offen offset:0 lds
    buffer_load_dwordx4 v9, s[32:35], s75 offen offset:1024 lds
    buffer_load_dwordx4 v10, s[32:35], s75 offen offset:2048 lds
    buffer_load_dwordx4 v11, s[32:35], s75 offen offset:3072 lds
    s_mov_b32 m0, 135168
    s_add_u32 s75, s96, 99328
    buffer_load_dwordx4 v8, s[32:35], s75 offen offset:0 lds
    buffer_load_dwordx4 v9, s[32:35], s75 offen offset:1024 lds
    buffer_load_dwordx4 v10, s[32:35], s75 offen offset:2048 lds
    buffer_load_dwordx4 v11, s[32:35], s75 offen offset:3072 lds
    s_mov_b32 m0, 139264
    s_add_u32 s75, s96, 2048
    buffer_load_dwordx4 v8, s[32:35], s75 offen offset:0 lds
    buffer_load_dwordx4 v9, s[32:35], s75 offen offset:1024 lds
    buffer_load_dwordx4 v10, s[32:35], s75 offen offset:2048 lds
    buffer_load_dwordx4 v11, s[32:35], s75 offen offset:3072 lds
    s_mov_b32 m0, 143360
    s_add_u32 s75, s96, 100352
    buffer_load_dwordx4 v8, s[32:35], s75 offen offset:0 lds
    buffer_load_dwordx4 v9, s[32:35], s75 offen offset:1024 lds
    buffer_load_dwordx4 v10, s[32:35], s75 offen offset:2048 lds
    buffer_load_dwordx4 v11, s[32:35], s75 offen offset:3072 lds
    s_waitcnt vmcnt(32)
    s_barrier
    s_mov_b32 m0, 65536
    s_add_u32 s75, s96, 197632
    buffer_load_dwordx4 v8, s[32:35], s75 offen offset:0 lds
    buffer_load_dwordx4 v9, s[32:35], s75 offen offset:1024 lds
    buffer_load_dwordx4 v10, s[32:35], s75 offen offset:2048 lds
    buffer_load_dwordx4 v11, s[32:35], s75 offen offset:3072 lds
    s_mov_b32 m0, 69632
    s_add_u32 s75, s96, 295936
    buffer_load_dwordx4 v8, s[32:35], s75 offen offset:0 lds
    buffer_load_dwordx4 v9, s[32:35], s75 offen offset:1024 lds
    buffer_load_dwordx4 v10, s[32:35], s75 offen offset:2048 lds
    buffer_load_dwordx4 v11, s[32:35], s75 offen offset:3072 lds
    s_mov_b32 m0, 73728
    s_add_u32 s75, s96, 198656
    buffer_load_dwordx4 v8, s[32:35], s75 offen offset:0 lds
    buffer_load_dwordx4 v9, s[32:35], s75 offen offset:1024 lds
    buffer_load_dwordx4 v10, s[32:35], s75 offen offset:2048 lds
    buffer_load_dwordx4 v11, s[32:35], s75 offen offset:3072 lds
    s_mov_b32 m0, 77824
    s_add_u32 s75, s96, 296960
    buffer_load_dwordx4 v8, s[32:35], s75 offen offset:0 lds
    buffer_load_dwordx4 v9, s[32:35], s75 offen offset:1024 lds
    buffer_load_dwordx4 v10, s[32:35], s75 offen offset:2048 lds
    buffer_load_dwordx4 v11, s[32:35], s75 offen offset:3072 lds
    s_waitcnt vmcnt(32)
    s_barrier
    s_mov_b32 m0, 81920
    s_add_u32 s75, s97, 1024
    buffer_load_dwordx4 v8, s[32:35], s75 offen offset:0 lds
    buffer_load_dwordx4 v9, s[32:35], s75 offen offset:1024 lds
    buffer_load_dwordx4 v10, s[32:35], s75 offen offset:2048 lds
    buffer_load_dwordx4 v11, s[32:35], s75 offen offset:3072 lds
    s_mov_b32 m0, 86016
    s_add_u32 s75, s97, 99328
    buffer_load_dwordx4 v8, s[32:35], s75 offen offset:0 lds
    buffer_load_dwordx4 v9, s[32:35], s75 offen offset:1024 lds
    buffer_load_dwordx4 v10, s[32:35], s75 offen offset:2048 lds
    buffer_load_dwordx4 v11, s[32:35], s75 offen offset:3072 lds
    s_mov_b32 m0, 90112
    s_add_u32 s75, s97, 2048
    buffer_load_dwordx4 v8, s[32:35], s75 offen offset:0 lds
    buffer_load_dwordx4 v9, s[32:35], s75 offen offset:1024 lds
    buffer_load_dwordx4 v10, s[32:35], s75 offen offset:2048 lds
    buffer_load_dwordx4 v11, s[32:35], s75 offen offset:3072 lds
    s_mov_b32 m0, 94208
    s_add_u32 s75, s97, 100352
    buffer_load_dwordx4 v8, s[32:35], s75 offen offset:0 lds
    buffer_load_dwordx4 v9, s[32:35], s75 offen offset:1024 lds
    buffer_load_dwordx4 v10, s[32:35], s75 offen offset:2048 lds
    buffer_load_dwordx4 v11, s[32:35], s75 offen offset:3072 lds
    s_waitcnt vmcnt(32)
    s_barrier
    s_mov_b32 m0, 98304
    s_add_u32 s75, s97, 197632
    buffer_load_dwordx4 v8, s[32:35], s75 offen offset:0 lds
    buffer_load_dwordx4 v9, s[32:35], s75 offen offset:1024 lds
    buffer_load_dwordx4 v10, s[32:35], s75 offen offset:2048 lds
    buffer_load_dwordx4 v11, s[32:35], s75 offen offset:3072 lds
    s_mov_b32 m0, 102400
    s_add_u32 s75, s97, 295936
    buffer_load_dwordx4 v8, s[32:35], s75 offen offset:0 lds
    buffer_load_dwordx4 v9, s[32:35], s75 offen offset:1024 lds
    buffer_load_dwordx4 v10, s[32:35], s75 offen offset:2048 lds
    buffer_load_dwordx4 v11, s[32:35], s75 offen offset:3072 lds
    s_mov_b32 m0, 106496
    s_add_u32 s75, s97, 198656
    buffer_load_dwordx4 v8, s[32:35], s75 offen offset:0 lds
    buffer_load_dwordx4 v9, s[32:35], s75 offen offset:1024 lds
    buffer_load_dwordx4 v10, s[32:35], s75 offen offset:2048 lds
    buffer_load_dwordx4 v11, s[32:35], s75 offen offset:3072 lds
    s_mov_b32 m0, 110592
    s_add_u32 s75, s97, 296960
    buffer_load_dwordx4 v8, s[32:35], s75 offen offset:0 lds
    buffer_load_dwordx4 v9, s[32:35], s75 offen offset:1024 lds
    buffer_load_dwordx4 v10, s[32:35], s75 offen offset:2048 lds
    buffer_load_dwordx4 v11, s[32:35], s75 offen offset:3072 lds
    s_waitcnt vmcnt(32)
    s_barrier
    s_mov_b32 m0, 114688
    s_add_u32 s75, s98, 1024
    buffer_load_dwordx4 v8, s[32:35], s75 offen offset:0 lds
    buffer_load_dwordx4 v9, s[32:35], s75 offen offset:1024 lds
    buffer_load_dwordx4 v10, s[32:35], s75 offen offset:2048 lds
    buffer_load_dwordx4 v11, s[32:35], s75 offen offset:3072 lds
    s_mov_b32 m0, 118784
    s_add_u32 s75, s98, 99328
    buffer_load_dwordx4 v8, s[32:35], s75 offen offset:0 lds
    buffer_load_dwordx4 v9, s[32:35], s75 offen offset:1024 lds
    buffer_load_dwordx4 v10, s[32:35], s75 offen offset:2048 lds
    buffer_load_dwordx4 v11, s[32:35], s75 offen offset:3072 lds
    s_mov_b32 m0, 122880
    s_add_u32 s75, s98, 2048
    buffer_load_dwordx4 v8, s[32:35], s75 offen offset:0 lds
    buffer_load_dwordx4 v9, s[32:35], s75 offen offset:1024 lds
    buffer_load_dwordx4 v10, s[32:35], s75 offen offset:2048 lds
    buffer_load_dwordx4 v11, s[32:35], s75 offen offset:3072 lds
    s_mov_b32 m0, 126976
    s_add_u32 s75, s98, 100352
    buffer_load_dwordx4 v8, s[32:35], s75 offen offset:0 lds
    buffer_load_dwordx4 v9, s[32:35], s75 offen offset:1024 lds
    buffer_load_dwordx4 v10, s[32:35], s75 offen offset:2048 lds
    buffer_load_dwordx4 v11, s[32:35], s75 offen offset:3072 lds
    s_waitcnt vmcnt(32)
    s_barrier
    s_mov_b32 m0, 131072
    s_add_u32 s75, s98, 197632
    buffer_load_dwordx4 v8, s[32:35], s75 offen offset:0 lds
    buffer_load_dwordx4 v9, s[32:35], s75 offen offset:1024 lds
    buffer_load_dwordx4 v10, s[32:35], s75 offen offset:2048 lds
    buffer_load_dwordx4 v11, s[32:35], s75 offen offset:3072 lds
    s_mov_b32 m0, 135168
    s_add_u32 s75, s98, 295936
    buffer_load_dwordx4 v8, s[32:35], s75 offen offset:0 lds
    buffer_load_dwordx4 v9, s[32:35], s75 offen offset:1024 lds
    buffer_load_dwordx4 v10, s[32:35], s75 offen offset:2048 lds
    buffer_load_dwordx4 v11, s[32:35], s75 offen offset:3072 lds
    s_mov_b32 m0, 139264
    s_add_u32 s75, s98, 198656
    buffer_load_dwordx4 v8, s[32:35], s75 offen offset:0 lds
    buffer_load_dwordx4 v9, s[32:35], s75 offen offset:1024 lds
    buffer_load_dwordx4 v10, s[32:35], s75 offen offset:2048 lds
    buffer_load_dwordx4 v11, s[32:35], s75 offen offset:3072 lds
    s_mov_b32 m0, 143360
    s_add_u32 s75, s98, 296960
    buffer_load_dwordx4 v8, s[32:35], s75 offen offset:0 lds
    buffer_load_dwordx4 v9, s[32:35], s75 offen offset:1024 lds
    buffer_load_dwordx4 v10, s[32:35], s75 offen offset:2048 lds
    buffer_load_dwordx4 v11, s[32:35], s75 offen offset:3072 lds
    s_waitcnt vmcnt(32)
    s_barrier
    s_mov_b32 m0, 65536
    s_add_u32 s75, s99, 1024
    buffer_load_dwordx4 v8, s[32:35], s75 offen offset:0 lds
    buffer_load_dwordx4 v9, s[32:35], s75 offen offset:1024 lds
    buffer_load_dwordx4 v10, s[32:35], s75 offen offset:2048 lds
    buffer_load_dwordx4 v11, s[32:35], s75 offen offset:3072 lds
    s_mov_b32 m0, 69632
    s_add_u32 s75, s99, 99328
    buffer_load_dwordx4 v8, s[32:35], s75 offen offset:0 lds
    buffer_load_dwordx4 v9, s[32:35], s75 offen offset:1024 lds
    buffer_load_dwordx4 v10, s[32:35], s75 offen offset:2048 lds
    buffer_load_dwordx4 v11, s[32:35], s75 offen offset:3072 lds
    s_mov_b32 m0, 73728
    s_add_u32 s75, s99, 2048
    buffer_load_dwordx4 v8, s[32:35], s75 offen offset:0 lds
    buffer_load_dwordx4 v9, s[32:35], s75 offen offset:1024 lds
    buffer_load_dwordx4 v10, s[32:35], s75 offen offset:2048 lds
    buffer_load_dwordx4 v11, s[32:35], s75 offen offset:3072 lds
    s_mov_b32 m0, 77824
    s_add_u32 s75, s99, 100352
    buffer_load_dwordx4 v8, s[32:35], s75 offen offset:0 lds
    buffer_load_dwordx4 v9, s[32:35], s75 offen offset:1024 lds
    buffer_load_dwordx4 v10, s[32:35], s75 offen offset:2048 lds
    buffer_load_dwordx4 v11, s[32:35], s75 offen offset:3072 lds
    s_waitcnt vmcnt(32)
    s_barrier
    s_mov_b32 m0, 81920
    s_add_u32 s75, s99, 197632
    buffer_load_dwordx4 v8, s[32:35], s75 offen offset:0 lds
    buffer_load_dwordx4 v9, s[32:35], s75 offen offset:1024 lds
    buffer_load_dwordx4 v10, s[32:35], s75 offen offset:2048 lds
    buffer_load_dwordx4 v11, s[32:35], s75 offen offset:3072 lds
    s_mov_b32 m0, 86016
    s_add_u32 s75, s99, 295936
    buffer_load_dwordx4 v8, s[32:35], s75 offen offset:0 lds
    buffer_load_dwordx4 v9, s[32:35], s75 offen offset:1024 lds
    buffer_load_dwordx4 v10, s[32:35], s75 offen offset:2048 lds
    buffer_load_dwordx4 v11, s[32:35], s75 offen offset:3072 lds
    s_mov_b32 m0, 90112
    s_add_u32 s75, s99, 198656
    buffer_load_dwordx4 v8, s[32:35], s75 offen offset:0 lds
    buffer_load_dwordx4 v9, s[32:35], s75 offen offset:1024 lds
    buffer_load_dwordx4 v10, s[32:35], s75 offen offset:2048 lds
    buffer_load_dwordx4 v11, s[32:35], s75 offen offset:3072 lds
    s_mov_b32 m0, 94208
    s_add_u32 s75, s99, 296960
    buffer_load_dwordx4 v8, s[32:35], s75 offen offset:0 lds
    buffer_load_dwordx4 v9, s[32:35], s75 offen offset:1024 lds
    buffer_load_dwordx4 v10, s[32:35], s75 offen offset:2048 lds
    buffer_load_dwordx4 v11, s[32:35], s75 offen offset:3072 lds
    s_waitcnt vmcnt(32)
    s_barrier
    s_mov_b32 m0, 98304
    s_add_u32 s75, s92, 0
    s_nop 0
    buffer_load_dwordx4 v4, s[44:47], s75 offen offset:0 lds
    buffer_load_dwordx4 v5, s[44:47], s75 offen offset:1024 lds
    buffer_load_dwordx4 v6, s[44:47], s75 offen offset:2048 lds
    buffer_load_dwordx4 v7, s[44:47], s75 offen offset:3072 lds
    s_mov_b32 m0, 102400
    s_add_u32 s75, s92, 32768
    buffer_load_dwordx4 v4, s[44:47], s75 offen offset:0 lds
    buffer_load_dwordx4 v5, s[44:47], s75 offen offset:1024 lds
    buffer_load_dwordx4 v6, s[44:47], s75 offen offset:2048 lds
    buffer_load_dwordx4 v7, s[44:47], s75 offen offset:3072 lds
    s_mov_b32 m0, 106496
    s_add_u32 s75, s92, 65536
    buffer_load_dwordx4 v4, s[44:47], s75 offen offset:0 lds
    buffer_load_dwordx4 v5, s[44:47], s75 offen offset:1024 lds
    buffer_load_dwordx4 v6, s[44:47], s75 offen offset:2048 lds
    buffer_load_dwordx4 v7, s[44:47], s75 offen offset:3072 lds
    s_mov_b32 m0, 110592
    s_add_u32 s75, s92, 98304
    buffer_load_dwordx4 v4, s[44:47], s75 offen offset:0 lds
    buffer_load_dwordx4 v5, s[44:47], s75 offen offset:1024 lds
    buffer_load_dwordx4 v6, s[44:47], s75 offen offset:2048 lds
    buffer_load_dwordx4 v7, s[44:47], s75 offen offset:3072 lds
    s_waitcnt vmcnt(32)
    s_barrier
    s_mov_b32 m0, 114688
    s_add_u32 s75, s93, 0
    s_nop 0
    buffer_load_dwordx4 v4, s[44:47], s75 offen offset:0 lds
    buffer_load_dwordx4 v5, s[44:47], s75 offen offset:1024 lds
    buffer_load_dwordx4 v6, s[44:47], s75 offen offset:2048 lds
    buffer_load_dwordx4 v7, s[44:47], s75 offen offset:3072 lds
    s_mov_b32 m0, 118784
    s_add_u32 s75, s93, 32768
    buffer_load_dwordx4 v4, s[44:47], s75 offen offset:0 lds
    buffer_load_dwordx4 v5, s[44:47], s75 offen offset:1024 lds
    buffer_load_dwordx4 v6, s[44:47], s75 offen offset:2048 lds
    buffer_load_dwordx4 v7, s[44:47], s75 offen offset:3072 lds
    s_mov_b32 m0, 122880
    s_add_u32 s75, s93, 65536
    buffer_load_dwordx4 v4, s[44:47], s75 offen offset:0 lds
    buffer_load_dwordx4 v5, s[44:47], s75 offen offset:1024 lds
    buffer_load_dwordx4 v6, s[44:47], s75 offen offset:2048 lds
    buffer_load_dwordx4 v7, s[44:47], s75 offen offset:3072 lds
    s_mov_b32 m0, 126976
    s_add_u32 s75, s93, 98304
    buffer_load_dwordx4 v4, s[44:47], s75 offen offset:0 lds
    buffer_load_dwordx4 v5, s[44:47], s75 offen offset:1024 lds
    buffer_load_dwordx4 v6, s[44:47], s75 offen offset:2048 lds
    buffer_load_dwordx4 v7, s[44:47], s75 offen offset:3072 lds
    s_waitcnt vmcnt(32)
    s_barrier
    s_mov_b32 m0, 131072
    s_add_u32 s75, s94, 0
    s_nop 0
    buffer_load_dwordx4 v4, s[44:47], s75 offen offset:0 lds
    buffer_load_dwordx4 v5, s[44:47], s75 offen offset:1024 lds
    buffer_load_dwordx4 v6, s[44:47], s75 offen offset:2048 lds
    buffer_load_dwordx4 v7, s[44:47], s75 offen offset:3072 lds
    s_mov_b32 m0, 135168
    s_add_u32 s75, s94, 32768
    buffer_load_dwordx4 v4, s[44:47], s75 offen offset:0 lds
    buffer_load_dwordx4 v5, s[44:47], s75 offen offset:1024 lds
    buffer_load_dwordx4 v6, s[44:47], s75 offen offset:2048 lds
    buffer_load_dwordx4 v7, s[44:47], s75 offen offset:3072 lds
    s_mov_b32 m0, 139264
    s_add_u32 s75, s94, 65536
    buffer_load_dwordx4 v4, s[44:47], s75 offen offset:0 lds
    buffer_load_dwordx4 v5, s[44:47], s75 offen offset:1024 lds
    buffer_load_dwordx4 v6, s[44:47], s75 offen offset:2048 lds
    buffer_load_dwordx4 v7, s[44:47], s75 offen offset:3072 lds
    s_mov_b32 m0, 143360
    s_add_u32 s75, s94, 98304
    buffer_load_dwordx4 v4, s[44:47], s75 offen offset:0 lds
    buffer_load_dwordx4 v5, s[44:47], s75 offen offset:1024 lds
    buffer_load_dwordx4 v6, s[44:47], s75 offen offset:2048 lds
    buffer_load_dwordx4 v7, s[44:47], s75 offen offset:3072 lds
    s_waitcnt vmcnt(32)
    s_barrier
    s_mov_b32 m0, 65536
    s_add_u32 s75, s95, 0
    s_nop 0
    buffer_load_dwordx4 v4, s[44:47], s75 offen offset:0 lds
    buffer_load_dwordx4 v5, s[44:47], s75 offen offset:1024 lds
    buffer_load_dwordx4 v6, s[44:47], s75 offen offset:2048 lds
    buffer_load_dwordx4 v7, s[44:47], s75 offen offset:3072 lds
    s_mov_b32 m0, 69632
    s_add_u32 s75, s95, 32768
    buffer_load_dwordx4 v4, s[44:47], s75 offen offset:0 lds
    buffer_load_dwordx4 v5, s[44:47], s75 offen offset:1024 lds
    buffer_load_dwordx4 v6, s[44:47], s75 offen offset:2048 lds
    buffer_load_dwordx4 v7, s[44:47], s75 offen offset:3072 lds
    s_mov_b32 m0, 73728
    s_add_u32 s75, s95, 65536
    buffer_load_dwordx4 v4, s[44:47], s75 offen offset:0 lds
    buffer_load_dwordx4 v5, s[44:47], s75 offen offset:1024 lds
    buffer_load_dwordx4 v6, s[44:47], s75 offen offset:2048 lds
    buffer_load_dwordx4 v7, s[44:47], s75 offen offset:3072 lds
    s_mov_b32 m0, 77824
    s_add_u32 s75, s95, 98304
    buffer_load_dwordx4 v4, s[44:47], s75 offen offset:0 lds
    buffer_load_dwordx4 v5, s[44:47], s75 offen offset:1024 lds
    buffer_load_dwordx4 v6, s[44:47], s75 offen offset:2048 lds
    buffer_load_dwordx4 v7, s[44:47], s75 offen offset:3072 lds
    s_waitcnt vmcnt(32)
    s_barrier
    s_waitcnt vmcnt(16)
    s_barrier
    s_mov_b32 m0, 81920
    s_add_u32 s75, s96, 0
    s_nop 0
    buffer_load_dwordx4 v8, s[32:35], s75 offen offset:0 lds
    buffer_load_dwordx4 v9, s[32:35], s75 offen offset:1024 lds
    buffer_load_dwordx4 v10, s[32:35], s75 offen offset:2048 lds
    buffer_load_dwordx4 v11, s[32:35], s75 offen offset:3072 lds
    s_mov_b32 m0, 86016
    s_add_u32 s75, s96, 98304
    buffer_load_dwordx4 v8, s[32:35], s75 offen offset:0 lds
    buffer_load_dwordx4 v9, s[32:35], s75 offen offset:1024 lds
    buffer_load_dwordx4 v10, s[32:35], s75 offen offset:2048 lds
    buffer_load_dwordx4 v11, s[32:35], s75 offen offset:3072 lds
    s_mov_b32 m0, 90112
    s_add_u32 s75, s96, 196608
    buffer_load_dwordx4 v8, s[32:35], s75 offen offset:0 lds
    buffer_load_dwordx4 v9, s[32:35], s75 offen offset:1024 lds
    buffer_load_dwordx4 v10, s[32:35], s75 offen offset:2048 lds
    buffer_load_dwordx4 v11, s[32:35], s75 offen offset:3072 lds
    s_mov_b32 m0, 94208
    s_add_u32 s75, s96, 294912
    buffer_load_dwordx4 v8, s[32:35], s75 offen offset:0 lds
    buffer_load_dwordx4 v9, s[32:35], s75 offen offset:1024 lds
    buffer_load_dwordx4 v10, s[32:35], s75 offen offset:2048 lds
    buffer_load_dwordx4 v11, s[32:35], s75 offen offset:3072 lds
    s_waitcnt vmcnt(16)
    s_barrier
    s_barrier
    s_mov_b32 m0, 98304
    s_add_u32 s75, s97, 0
    buffer_load_dwordx4 v8, s[32:35], s75 offen offset:0 lds
    buffer_load_dwordx4 v9, s[32:35], s75 offen offset:1024 lds
    buffer_load_dwordx4 v10, s[32:35], s75 offen offset:2048 lds
    buffer_load_dwordx4 v11, s[32:35], s75 offen offset:3072 lds
    s_mov_b32 m0, 102400
    s_add_u32 s75, s97, 98304
    buffer_load_dwordx4 v8, s[32:35], s75 offen offset:0 lds
    buffer_load_dwordx4 v9, s[32:35], s75 offen offset:1024 lds
    buffer_load_dwordx4 v10, s[32:35], s75 offen offset:2048 lds
    buffer_load_dwordx4 v11, s[32:35], s75 offen offset:3072 lds
    s_mov_b32 m0, 106496
    s_add_u32 s75, s97, 196608
    buffer_load_dwordx4 v8, s[32:35], s75 offen offset:0 lds
    buffer_load_dwordx4 v9, s[32:35], s75 offen offset:1024 lds
    buffer_load_dwordx4 v10, s[32:35], s75 offen offset:2048 lds
    buffer_load_dwordx4 v11, s[32:35], s75 offen offset:3072 lds
    s_mov_b32 m0, 110592
    s_add_u32 s75, s97, 294912
    buffer_load_dwordx4 v8, s[32:35], s75 offen offset:0 lds
    buffer_load_dwordx4 v9, s[32:35], s75 offen offset:1024 lds
    buffer_load_dwordx4 v10, s[32:35], s75 offen offset:2048 lds
    buffer_load_dwordx4 v11, s[32:35], s75 offen offset:3072 lds
    s_waitcnt vmcnt(16)
    s_barrier
    s_mov_b32 m0, 114688
    s_add_u32 s75, s98, 0
    s_nop 0
    buffer_load_dwordx4 v8, s[32:35], s75 offen offset:0 lds
    buffer_load_dwordx4 v9, s[32:35], s75 offen offset:1024 lds
    buffer_load_dwordx4 v10, s[32:35], s75 offen offset:2048 lds
    buffer_load_dwordx4 v11, s[32:35], s75 offen offset:3072 lds
    s_mov_b32 m0, 118784
    s_add_u32 s75, s98, 98304
    buffer_load_dwordx4 v8, s[32:35], s75 offen offset:0 lds
    buffer_load_dwordx4 v9, s[32:35], s75 offen offset:1024 lds
    buffer_load_dwordx4 v10, s[32:35], s75 offen offset:2048 lds
    buffer_load_dwordx4 v11, s[32:35], s75 offen offset:3072 lds
    s_mov_b32 m0, 122880
    s_add_u32 s75, s98, 196608
    buffer_load_dwordx4 v8, s[32:35], s75 offen offset:0 lds
    buffer_load_dwordx4 v9, s[32:35], s75 offen offset:1024 lds
    buffer_load_dwordx4 v10, s[32:35], s75 offen offset:2048 lds
    buffer_load_dwordx4 v11, s[32:35], s75 offen offset:3072 lds
    s_mov_b32 m0, 126976
    s_add_u32 s75, s98, 294912
    buffer_load_dwordx4 v8, s[32:35], s75 offen offset:0 lds
    buffer_load_dwordx4 v9, s[32:35], s75 offen offset:1024 lds
    buffer_load_dwordx4 v10, s[32:35], s75 offen offset:2048 lds
    buffer_load_dwordx4 v11, s[32:35], s75 offen offset:3072 lds
    s_waitcnt vmcnt(16)
    s_barrier
    s_mov_b32 m0, 131072
    s_add_u32 s75, s99, 0
    s_nop 0
    buffer_load_dwordx4 v8, s[32:35], s75 offen offset:0 lds
    buffer_load_dwordx4 v9, s[32:35], s75 offen offset:1024 lds
    buffer_load_dwordx4 v10, s[32:35], s75 offen offset:2048 lds
    buffer_load_dwordx4 v11, s[32:35], s75 offen offset:3072 lds
    s_mov_b32 m0, 135168
    s_add_u32 s75, s99, 98304
    buffer_load_dwordx4 v8, s[32:35], s75 offen offset:0 lds
    buffer_load_dwordx4 v9, s[32:35], s75 offen offset:1024 lds
    buffer_load_dwordx4 v10, s[32:35], s75 offen offset:2048 lds
    buffer_load_dwordx4 v11, s[32:35], s75 offen offset:3072 lds
    s_mov_b32 m0, 139264
    s_add_u32 s75, s99, 196608
    buffer_load_dwordx4 v8, s[32:35], s75 offen offset:0 lds
    buffer_load_dwordx4 v9, s[32:35], s75 offen offset:1024 lds
    buffer_load_dwordx4 v10, s[32:35], s75 offen offset:2048 lds
    buffer_load_dwordx4 v11, s[32:35], s75 offen offset:3072 lds
    s_mov_b32 m0, 143360
    s_add_u32 s75, s99, 294912
    buffer_load_dwordx4 v8, s[32:35], s75 offen offset:0 lds
    buffer_load_dwordx4 v9, s[32:35], s75 offen offset:1024 lds
    buffer_load_dwordx4 v10, s[32:35], s75 offen offset:2048 lds
    buffer_load_dwordx4 v11, s[32:35], s75 offen offset:3072 lds
    s_mov_b32 m0, 65536
    s_add_u32 s75, s4, 0
    s_nop 0
    buffer_load_dwordx4 v12, s[48:51], s75 offen offset:0 lds
    buffer_load_dwordx4 v13, s[48:51], s75 offen offset:1024 lds
    buffer_load_dwordx4 v14, s[48:51], s75 offen offset:2048 lds
    buffer_load_dwordx4 v15, s[48:51], s75 offen offset:3072 lds
    s_mov_b32 m0, 69632
    s_add_u32 s75, s4, 114688
    buffer_load_dwordx4 v12, s[48:51], s75 offen offset:0 lds
    buffer_load_dwordx4 v13, s[48:51], s75 offen offset:1024 lds
    buffer_load_dwordx4 v14, s[48:51], s75 offen offset:2048 lds
    buffer_load_dwordx4 v15, s[48:51], s75 offen offset:3072 lds
    s_mov_b32 m0, 73728
    s_add_u32 s75, s4, 229376
    buffer_load_dwordx4 v12, s[48:51], s75 offen offset:0 lds
    buffer_load_dwordx4 v13, s[48:51], s75 offen offset:1024 lds
    buffer_load_dwordx4 v14, s[48:51], s75 offen offset:2048 lds
    buffer_load_dwordx4 v15, s[48:51], s75 offen offset:3072 lds
    s_mov_b32 m0, 77824
    s_add_u32 s75, s4, 344064
    buffer_load_dwordx4 v12, s[48:51], s75 offen offset:0 lds
    buffer_load_dwordx4 v13, s[48:51], s75 offen offset:1024 lds
    buffer_load_dwordx4 v14, s[48:51], s75 offen offset:2048 lds
    buffer_load_dwordx4 v15, s[48:51], s75 offen offset:3072 lds
    s_waitcnt vmcnt(32)
    s_barrier
    s_mov_b32 m0, 81920
    s_add_u32 s75, s5, 0
    s_nop 0
    buffer_load_dwordx4 v12, s[48:51], s75 offen offset:0 lds
    buffer_load_dwordx4 v13, s[48:51], s75 offen offset:1024 lds
    buffer_load_dwordx4 v14, s[48:51], s75 offen offset:2048 lds
    buffer_load_dwordx4 v15, s[48:51], s75 offen offset:3072 lds
    s_mov_b32 m0, 86016
    s_add_u32 s75, s5, 114688
    buffer_load_dwordx4 v12, s[48:51], s75 offen offset:0 lds
    buffer_load_dwordx4 v13, s[48:51], s75 offen offset:1024 lds
    buffer_load_dwordx4 v14, s[48:51], s75 offen offset:2048 lds
    buffer_load_dwordx4 v15, s[48:51], s75 offen offset:3072 lds
    s_mov_b32 m0, 90112
    s_add_u32 s75, s5, 229376
    buffer_load_dwordx4 v12, s[48:51], s75 offen offset:0 lds
    buffer_load_dwordx4 v13, s[48:51], s75 offen offset:1024 lds
    buffer_load_dwordx4 v14, s[48:51], s75 offen offset:2048 lds
    buffer_load_dwordx4 v15, s[48:51], s75 offen offset:3072 lds
    s_mov_b32 m0, 94208
    s_add_u32 s75, s5, 344064
    buffer_load_dwordx4 v12, s[48:51], s75 offen offset:0 lds
    buffer_load_dwordx4 v13, s[48:51], s75 offen offset:1024 lds
    buffer_load_dwordx4 v14, s[48:51], s75 offen offset:2048 lds
    buffer_load_dwordx4 v15, s[48:51], s75 offen offset:3072 lds
    s_waitcnt vmcnt(32)
    s_barrier
    s_mov_b32 m0, 98304
    s_add_u32 s75, s6, 0
    s_nop 0
    buffer_load_dwordx4 v12, s[48:51], s75 offen offset:0 lds
    buffer_load_dwordx4 v13, s[48:51], s75 offen offset:1024 lds
    buffer_load_dwordx4 v14, s[48:51], s75 offen offset:2048 lds
    buffer_load_dwordx4 v15, s[48:51], s75 offen offset:3072 lds
    s_mov_b32 m0, 102400
    s_add_u32 s75, s6, 114688
    buffer_load_dwordx4 v12, s[48:51], s75 offen offset:0 lds
    buffer_load_dwordx4 v13, s[48:51], s75 offen offset:1024 lds
    buffer_load_dwordx4 v14, s[48:51], s75 offen offset:2048 lds
    buffer_load_dwordx4 v15, s[48:51], s75 offen offset:3072 lds
    s_mov_b32 m0, 106496
    s_add_u32 s75, s6, 229376
    buffer_load_dwordx4 v12, s[48:51], s75 offen offset:0 lds
    buffer_load_dwordx4 v13, s[48:51], s75 offen offset:1024 lds
    buffer_load_dwordx4 v14, s[48:51], s75 offen offset:2048 lds
    buffer_load_dwordx4 v15, s[48:51], s75 offen offset:3072 lds
    s_mov_b32 m0, 110592
    s_add_u32 s75, s6, 344064
    buffer_load_dwordx4 v12, s[48:51], s75 offen offset:0 lds
    buffer_load_dwordx4 v13, s[48:51], s75 offen offset:1024 lds
    buffer_load_dwordx4 v14, s[48:51], s75 offen offset:2048 lds
    buffer_load_dwordx4 v15, s[48:51], s75 offen offset:3072 lds
    s_barrier
    s_waitcnt vmcnt(44)
    s_mov_b32 m0, 114688
    s_add_u32 s75, s7, 0
    s_nop 0
    buffer_load_dwordx4 v12, s[48:51], s75 offen offset:0 lds
    buffer_load_dwordx4 v13, s[48:51], s75 offen offset:1024 lds
    buffer_load_dwordx4 v14, s[48:51], s75 offen offset:2048 lds
    buffer_load_dwordx4 v15, s[48:51], s75 offen offset:3072 lds
    s_mov_b32 m0, 118784
    s_add_u32 s75, s7, 114688
    buffer_load_dwordx4 v12, s[48:51], s75 offen offset:0 lds
    buffer_load_dwordx4 v13, s[48:51], s75 offen offset:1024 lds
    buffer_load_dwordx4 v14, s[48:51], s75 offen offset:2048 lds
    buffer_load_dwordx4 v15, s[48:51], s75 offen offset:3072 lds
    s_mov_b32 m0, 122880
    s_add_u32 s75, s7, 229376
    buffer_load_dwordx4 v12, s[48:51], s75 offen offset:0 lds
    buffer_load_dwordx4 v13, s[48:51], s75 offen offset:1024 lds
    buffer_load_dwordx4 v14, s[48:51], s75 offen offset:2048 lds
    buffer_load_dwordx4 v15, s[48:51], s75 offen offset:3072 lds
    s_mov_b32 m0, 126976
    s_add_u32 s75, s7, 344064
    buffer_load_dwordx4 v12, s[48:51], s75 offen offset:0 lds
    buffer_load_dwordx4 v13, s[48:51], s75 offen offset:1024 lds
    buffer_load_dwordx4 v14, s[48:51], s75 offen offset:2048 lds
    buffer_load_dwordx4 v15, s[48:51], s75 offen offset:3072 lds
    s_waitcnt vmcnt(44)
    s_mov_b32 m0, 131072
    s_mov_b32 s75, 0
    buffer_load_dwordx4 v16, s[48:51], s75 offen offset:0 lds
    buffer_load_dwordx4 v17, s[48:51], s75 offen offset:1024 lds
    buffer_load_dwordx4 v18, s[48:51], s75 offen offset:2048 lds
    buffer_load_dwordx4 v19, s[48:51], s75 offen offset:3072 lds
    s_mov_b32 m0, 135168
    s_mov_b32 s75, 114688
    buffer_load_dwordx4 v16, s[48:51], s75 offen offset:0 lds
    buffer_load_dwordx4 v17, s[48:51], s75 offen offset:1024 lds
    buffer_load_dwordx4 v18, s[48:51], s75 offen offset:2048 lds
    buffer_load_dwordx4 v19, s[48:51], s75 offen offset:3072 lds
    s_mov_b32 m0, 139264
    s_mov_b32 s75, 229376
    buffer_load_dwordx4 v16, s[48:51], s75 offen offset:0 lds
    buffer_load_dwordx4 v17, s[48:51], s75 offen offset:1024 lds
    buffer_load_dwordx4 v18, s[48:51], s75 offen offset:2048 lds
    buffer_load_dwordx4 v19, s[48:51], s75 offen offset:3072 lds
    s_mov_b32 m0, 143360
    s_mov_b32 s75, 344064
    buffer_load_dwordx4 v16, s[48:51], s75 offen offset:0 lds
    buffer_load_dwordx4 v17, s[48:51], s75 offen offset:1024 lds
    buffer_load_dwordx4 v18, s[48:51], s75 offen offset:2048 lds
    buffer_load_dwordx4 v19, s[48:51], s75 offen offset:3072 lds
    s_barrier
    s_mov_b32 m0, 0
    s_add_u32 s75, s18, 0
    s_nop 0
    buffer_load_dwordx4 v24, s[60:63], s75 offen offset:0 sc1 lds
    buffer_load_dwordx4 v25, s[60:63], s75 offen offset:1024 sc1 lds
    buffer_load_dwordx4 v24, s[60:63], s75 offen offset:2048 sc1 lds
    buffer_load_dwordx4 v25, s[60:63], s75 offen offset:3072 sc1 lds
    s_mov_b32 m0, 4096
    s_add_u32 s75, s18, 4096
    buffer_load_dwordx4 v24, s[60:63], s75 offen offset:0 sc1 lds
    buffer_load_dwordx4 v25, s[60:63], s75 offen offset:1024 sc1 lds
    buffer_load_dwordx4 v24, s[60:63], s75 offen offset:2048 sc1 lds
    buffer_load_dwordx4 v25, s[60:63], s75 offen offset:3072 sc1 lds
    s_mov_b32 m0, 8192
    s_add_u32 s75, s18, 8192
    buffer_load_dwordx4 v24, s[60:63], s75 offen offset:0 sc1 lds
    buffer_load_dwordx4 v25, s[60:63], s75 offen offset:1024 sc1 lds
    buffer_load_dwordx4 v24, s[60:63], s75 offen offset:2048 sc1 lds
    buffer_load_dwordx4 v25, s[60:63], s75 offen offset:3072 sc1 lds
    s_mov_b32 m0, 12288
    s_add_u32 s75, s18, 12288
    buffer_load_dwordx4 v24, s[60:63], s75 offen offset:0 sc1 lds
    buffer_load_dwordx4 v25, s[60:63], s75 offen offset:1024 sc1 lds
    buffer_load_dwordx4 v24, s[60:63], s75 offen offset:2048 sc1 lds
    buffer_load_dwordx4 v25, s[60:63], s75 offen offset:3072 sc1 lds
    s_mov_b32 m0, 16384
    s_add_u32 s75, s19, 0
    s_nop 0
    buffer_load_dwordx4 v24, s[60:63], s75 offen offset:0 sc1 lds
    buffer_load_dwordx4 v25, s[60:63], s75 offen offset:1024 sc1 lds
    buffer_load_dwordx4 v24, s[60:63], s75 offen offset:2048 sc1 lds
    buffer_load_dwordx4 v25, s[60:63], s75 offen offset:3072 sc1 lds
    s_mov_b32 m0, 20480
    s_add_u32 s75, s19, 4096
    buffer_load_dwordx4 v24, s[60:63], s75 offen offset:0 sc1 lds
    buffer_load_dwordx4 v25, s[60:63], s75 offen offset:1024 sc1 lds
    buffer_load_dwordx4 v24, s[60:63], s75 offen offset:2048 sc1 lds
    buffer_load_dwordx4 v25, s[60:63], s75 offen offset:3072 sc1 lds
    s_mov_b32 m0, 24576
    s_add_u32 s75, s19, 8192
    buffer_load_dwordx4 v24, s[60:63], s75 offen offset:0 sc1 lds
    buffer_load_dwordx4 v25, s[60:63], s75 offen offset:1024 sc1 lds
    buffer_load_dwordx4 v24, s[60:63], s75 offen offset:2048 sc1 lds
    buffer_load_dwordx4 v25, s[60:63], s75 offen offset:3072 sc1 lds
    s_mov_b32 m0, 28672
    s_add_u32 s75, s19, 12288
    buffer_load_dwordx4 v24, s[60:63], s75 offen offset:0 sc1 lds
    buffer_load_dwordx4 v25, s[60:63], s75 offen offset:1024 sc1 lds
    buffer_load_dwordx4 v24, s[60:63], s75 offen offset:2048 sc1 lds
    buffer_load_dwordx4 v25, s[60:63], s75 offen offset:3072 sc1 lds
    s_mov_b32 m0, 32768
    s_add_u32 s75, s20, 0
    s_nop 0
    buffer_load_dwordx4 v24, s[60:63], s75 offen offset:0 sc1 lds
    buffer_load_dwordx4 v25, s[60:63], s75 offen offset:1024 sc1 lds
    buffer_load_dwordx4 v24, s[60:63], s75 offen offset:2048 sc1 lds
    buffer_load_dwordx4 v25, s[60:63], s75 offen offset:3072 sc1 lds
    s_mov_b32 m0, 36864
    s_add_u32 s75, s20, 4096
    buffer_load_dwordx4 v24, s[60:63], s75 offen offset:0 sc1 lds
    buffer_load_dwordx4 v25, s[60:63], s75 offen offset:1024 sc1 lds
    buffer_load_dwordx4 v24, s[60:63], s75 offen offset:2048 sc1 lds
    buffer_load_dwordx4 v25, s[60:63], s75 offen offset:3072 sc1 lds
    s_mov_b32 m0, 40960
    s_add_u32 s75, s20, 8192
    buffer_load_dwordx4 v24, s[60:63], s75 offen offset:0 sc1 lds
    buffer_load_dwordx4 v25, s[60:63], s75 offen offset:1024 sc1 lds
    buffer_load_dwordx4 v24, s[60:63], s75 offen offset:2048 sc1 lds
    buffer_load_dwordx4 v25, s[60:63], s75 offen offset:3072 sc1 lds
    s_mov_b32 m0, 45056
    s_add_u32 s75, s20, 12288
    buffer_load_dwordx4 v24, s[60:63], s75 offen offset:0 sc1 lds
    buffer_load_dwordx4 v25, s[60:63], s75 offen offset:1024 sc1 lds
    buffer_load_dwordx4 v24, s[60:63], s75 offen offset:2048 sc1 lds
    buffer_load_dwordx4 v25, s[60:63], s75 offen offset:3072 sc1 lds
    s_mov_b32 m0, 49152
    s_add_u32 s75, s21, 0
    s_nop 0
    buffer_load_dwordx4 v24, s[60:63], s75 offen offset:0 sc1 lds
    buffer_load_dwordx4 v25, s[60:63], s75 offen offset:1024 sc1 lds
    buffer_load_dwordx4 v24, s[60:63], s75 offen offset:2048 sc1 lds
    buffer_load_dwordx4 v25, s[60:63], s75 offen offset:3072 sc1 lds
    s_mov_b32 m0, 53248
    s_add_u32 s75, s21, 4096
    buffer_load_dwordx4 v24, s[60:63], s75 offen offset:0 sc1 lds
    buffer_load_dwordx4 v25, s[60:63], s75 offen offset:1024 sc1 lds
    buffer_load_dwordx4 v24, s[60:63], s75 offen offset:2048 sc1 lds
    buffer_load_dwordx4 v25, s[60:63], s75 offen offset:3072 sc1 lds
    s_mov_b32 m0, 57344
    s_add_u32 s75, s21, 8192
    buffer_load_dwordx4 v24, s[60:63], s75 offen offset:0 sc1 lds
    buffer_load_dwordx4 v25, s[60:63], s75 offen offset:1024 sc1 lds
    buffer_load_dwordx4 v24, s[60:63], s75 offen offset:2048 sc1 lds
    buffer_load_dwordx4 v25, s[60:63], s75 offen offset:3072 sc1 lds
    s_mov_b32 m0, 61440
    s_add_u32 s75, s21, 12288
    buffer_load_dwordx4 v24, s[60:63], s75 offen offset:0 sc1 lds
    buffer_load_dwordx4 v25, s[60:63], s75 offen offset:1024 sc1 lds
    buffer_load_dwordx4 v24, s[60:63], s75 offen offset:2048 sc1 lds
    buffer_load_dwordx4 v25, s[60:63], s75 offen offset:3072 sc1 lds
    s_waitcnt vmcnt(48)
    s_barrier
    s_waitcnt vmcnt(32)
    s_barrier
    s_waitcnt vmcnt(16)
    s_barrier
    s_mov_b32 m0, 65536
    s_mov_b32 s75, 0
    s_nop 0
    buffer_load_dwordx4 v20, s[48:51], s75 offen offset:0 lds
    buffer_load_dwordx4 v21, s[48:51], s75 offen offset:1024 lds
    buffer_load_dwordx4 v22, s[48:51], s75 offen offset:2048 lds
    buffer_load_dwordx4 v23, s[48:51], s75 offen offset:3072 lds
    s_mov_b32 m0, 69632
    s_mov_b32 s75, 114688
    buffer_load_dwordx4 v20, s[48:51], s75 offen offset:0 lds
    buffer_load_dwordx4 v21, s[48:51], s75 offen offset:1024 lds
    buffer_load_dwordx4 v22, s[48:51], s75 offen offset:2048 lds
    buffer_load_dwordx4 v23, s[48:51], s75 offen offset:3072 lds
    s_mov_b32 m0, 73728
    s_mov_b32 s75, 229376
    buffer_load_dwordx4 v20, s[48:51], s75 offen offset:0 lds
    buffer_load_dwordx4 v21, s[48:51], s75 offen offset:1024 lds
    buffer_load_dwordx4 v22, s[48:51], s75 offen offset:2048 lds
    buffer_load_dwordx4 v23, s[48:51], s75 offen offset:3072 lds
    s_mov_b32 m0, 77824
    s_mov_b32 s75, 344064
    buffer_load_dwordx4 v20, s[48:51], s75 offen offset:0 lds
    buffer_load_dwordx4 v21, s[48:51], s75 offen offset:1024 lds
    buffer_load_dwordx4 v22, s[48:51], s75 offen offset:2048 lds
    buffer_load_dwordx4 v23, s[48:51], s75 offen offset:3072 lds
    s_waitcnt vmcnt(16)
    s_barrier
    s_mov_b32 m0, 81920
    s_add_u32 s75, s4, 128
    buffer_load_dwordx4 v12, s[48:51], s75 offen offset:0 lds
    buffer_load_dwordx4 v13, s[48:51], s75 offen offset:1024 lds
    buffer_load_dwordx4 v14, s[48:51], s75 offen offset:2048 lds
    buffer_load_dwordx4 v15, s[48:51], s75 offen offset:3072 lds
    s_mov_b32 m0, 86016
    s_add_u32 s75, s4, 114816
    buffer_load_dwordx4 v12, s[48:51], s75 offen offset:0 lds
    buffer_load_dwordx4 v13, s[48:51], s75 offen offset:1024 lds
    buffer_load_dwordx4 v14, s[48:51], s75 offen offset:2048 lds
    buffer_load_dwordx4 v15, s[48:51], s75 offen offset:3072 lds
    s_mov_b32 m0, 90112
    s_add_u32 s75, s4, 229504
    buffer_load_dwordx4 v12, s[48:51], s75 offen offset:0 lds
    buffer_load_dwordx4 v13, s[48:51], s75 offen offset:1024 lds
    buffer_load_dwordx4 v14, s[48:51], s75 offen offset:2048 lds
    buffer_load_dwordx4 v15, s[48:51], s75 offen offset:3072 lds
    s_mov_b32 m0, 94208
    s_add_u32 s75, s4, 344192
    buffer_load_dwordx4 v12, s[48:51], s75 offen offset:0 lds
    buffer_load_dwordx4 v13, s[48:51], s75 offen offset:1024 lds
    buffer_load_dwordx4 v14, s[48:51], s75 offen offset:2048 lds
    buffer_load_dwordx4 v15, s[48:51], s75 offen offset:3072 lds
    s_barrier
    s_nop 0
    s_mov_b32 m0, 98304
    s_add_u32 s75, s5, 128
    buffer_load_dwordx4 v12, s[48:51], s75 offen offset:0 lds
    buffer_load_dwordx4 v13, s[48:51], s75 offen offset:1024 lds
    buffer_load_dwordx4 v14, s[48:51], s75 offen offset:2048 lds
    buffer_load_dwordx4 v15, s[48:51], s75 offen offset:3072 lds
    s_mov_b32 m0, 102400
    s_add_u32 s75, s5, 114816
    buffer_load_dwordx4 v12, s[48:51], s75 offen offset:0 lds
    buffer_load_dwordx4 v13, s[48:51], s75 offen offset:1024 lds
    buffer_load_dwordx4 v14, s[48:51], s75 offen offset:2048 lds
    buffer_load_dwordx4 v15, s[48:51], s75 offen offset:3072 lds
    s_mov_b32 m0, 106496
    s_add_u32 s75, s5, 229504
    buffer_load_dwordx4 v12, s[48:51], s75 offen offset:0 lds
    buffer_load_dwordx4 v13, s[48:51], s75 offen offset:1024 lds
    buffer_load_dwordx4 v14, s[48:51], s75 offen offset:2048 lds
    buffer_load_dwordx4 v15, s[48:51], s75 offen offset:3072 lds
    s_mov_b32 m0, 110592
    s_add_u32 s75, s5, 344192
    buffer_load_dwordx4 v12, s[48:51], s75 offen offset:0 lds
    buffer_load_dwordx4 v13, s[48:51], s75 offen offset:1024 lds
    buffer_load_dwordx4 v14, s[48:51], s75 offen offset:2048 lds
    buffer_load_dwordx4 v15, s[48:51], s75 offen offset:3072 lds
    s_waitcnt vmcnt(44)
    s_nop 0
    s_mov_b32 m0, 114688
    s_add_u32 s75, s6, 128
    buffer_load_dwordx4 v12, s[48:51], s75 offen offset:0 lds
    buffer_load_dwordx4 v13, s[48:51], s75 offen offset:1024 lds
    buffer_load_dwordx4 v14, s[48:51], s75 offen offset:2048 lds
    buffer_load_dwordx4 v15, s[48:51], s75 offen offset:3072 lds
    s_mov_b32 m0, 118784
    s_add_u32 s75, s6, 114816
    buffer_load_dwordx4 v12, s[48:51], s75 offen offset:0 lds
    buffer_load_dwordx4 v13, s[48:51], s75 offen offset:1024 lds
    buffer_load_dwordx4 v14, s[48:51], s75 offen offset:2048 lds
    buffer_load_dwordx4 v15, s[48:51], s75 offen offset:3072 lds
    s_mov_b32 m0, 122880
    s_add_u32 s75, s6, 229504
    buffer_load_dwordx4 v12, s[48:51], s75 offen offset:0 lds
    buffer_load_dwordx4 v13, s[48:51], s75 offen offset:1024 lds
    buffer_load_dwordx4 v14, s[48:51], s75 offen offset:2048 lds
    buffer_load_dwordx4 v15, s[48:51], s75 offen offset:3072 lds
    s_mov_b32 m0, 126976
    s_add_u32 s75, s6, 344192
    buffer_load_dwordx4 v12, s[48:51], s75 offen offset:0 lds
    buffer_load_dwordx4 v13, s[48:51], s75 offen offset:1024 lds
    buffer_load_dwordx4 v14, s[48:51], s75 offen offset:2048 lds
    buffer_load_dwordx4 v15, s[48:51], s75 offen offset:3072 lds
    s_waitcnt vmcnt(44)
    s_mov_b32 m0, 0
    s_add_u32 s75, s7, 128
    buffer_load_dwordx4 v12, s[48:51], s75 offen offset:0 lds
    buffer_load_dwordx4 v13, s[48:51], s75 offen offset:1024 lds
    buffer_load_dwordx4 v14, s[48:51], s75 offen offset:2048 lds
    buffer_load_dwordx4 v15, s[48:51], s75 offen offset:3072 lds
    s_mov_b32 m0, 4096
    s_add_u32 s75, s7, 114816
    buffer_load_dwordx4 v12, s[48:51], s75 offen offset:0 lds
    buffer_load_dwordx4 v13, s[48:51], s75 offen offset:1024 lds
    buffer_load_dwordx4 v14, s[48:51], s75 offen offset:2048 lds
    buffer_load_dwordx4 v15, s[48:51], s75 offen offset:3072 lds
    s_mov_b32 m0, 8192
    s_add_u32 s75, s7, 229504
    buffer_load_dwordx4 v12, s[48:51], s75 offen offset:0 lds
    buffer_load_dwordx4 v13, s[48:51], s75 offen offset:1024 lds
    buffer_load_dwordx4 v14, s[48:51], s75 offen offset:2048 lds
    buffer_load_dwordx4 v15, s[48:51], s75 offen offset:3072 lds
    s_mov_b32 m0, 12288
    s_add_u32 s75, s7, 344192
    buffer_load_dwordx4 v12, s[48:51], s75 offen offset:0 lds
    buffer_load_dwordx4 v13, s[48:51], s75 offen offset:1024 lds
    buffer_load_dwordx4 v14, s[48:51], s75 offen offset:2048 lds
    buffer_load_dwordx4 v15, s[48:51], s75 offen offset:3072 lds
    s_barrier
    s_waitcnt vmcnt(44)
    s_mov_b32 m0, 16384
    s_add_u32 s75, s4, 256
    buffer_load_dwordx4 v12, s[48:51], s75 offen offset:0 lds
    buffer_load_dwordx4 v13, s[48:51], s75 offen offset:1024 lds
    buffer_load_dwordx4 v14, s[48:51], s75 offen offset:2048 lds
    buffer_load_dwordx4 v15, s[48:51], s75 offen offset:3072 lds
    s_mov_b32 m0, 20480
    s_add_u32 s75, s4, 114944
    buffer_load_dwordx4 v12, s[48:51], s75 offen offset:0 lds
    buffer_load_dwordx4 v13, s[48:51], s75 offen offset:1024 lds
    buffer_load_dwordx4 v14, s[48:51], s75 offen offset:2048 lds
    buffer_load_dwordx4 v15, s[48:51], s75 offen offset:3072 lds
    s_mov_b32 m0, 24576
    s_add_u32 s75, s4, 229632
    buffer_load_dwordx4 v12, s[48:51], s75 offen offset:0 lds
    buffer_load_dwordx4 v13, s[48:51], s75 offen offset:1024 lds
    buffer_load_dwordx4 v14, s[48:51], s75 offen offset:2048 lds
    buffer_load_dwordx4 v15, s[48:51], s75 offen offset:3072 lds
    s_mov_b32 m0, 28672
    s_add_u32 s75, s4, 344320
    buffer_load_dwordx4 v12, s[48:51], s75 offen offset:0 lds
    buffer_load_dwordx4 v13, s[48:51], s75 offen offset:1024 lds
    buffer_load_dwordx4 v14, s[48:51], s75 offen offset:2048 lds
    buffer_load_dwordx4 v15, s[48:51], s75 offen offset:3072 lds
    s_barrier
    s_waitcnt vmcnt(44)
    s_mov_b32 m0, 32768
    s_add_u32 s75, s5, 256
    buffer_load_dwordx4 v12, s[48:51], s75 offen offset:0 lds
    buffer_load_dwordx4 v13, s[48:51], s75 offen offset:1024 lds
    buffer_load_dwordx4 v14, s[48:51], s75 offen offset:2048 lds
    buffer_load_dwordx4 v15, s[48:51], s75 offen offset:3072 lds
    s_mov_b32 m0, 36864
    s_add_u32 s75, s5, 114944
    buffer_load_dwordx4 v12, s[48:51], s75 offen offset:0 lds
    buffer_load_dwordx4 v13, s[48:51], s75 offen offset:1024 lds
    buffer_load_dwordx4 v14, s[48:51], s75 offen offset:2048 lds
    buffer_load_dwordx4 v15, s[48:51], s75 offen offset:3072 lds
    s_mov_b32 m0, 40960
    s_add_u32 s75, s5, 229632
    buffer_load_dwordx4 v12, s[48:51], s75 offen offset:0 lds
    buffer_load_dwordx4 v13, s[48:51], s75 offen offset:1024 lds
    buffer_load_dwordx4 v14, s[48:51], s75 offen offset:2048 lds
    buffer_load_dwordx4 v15, s[48:51], s75 offen offset:3072 lds
    s_mov_b32 m0, 45056
    s_add_u32 s75, s5, 344320
    buffer_load_dwordx4 v12, s[48:51], s75 offen offset:0 lds
    buffer_load_dwordx4 v13, s[48:51], s75 offen offset:1024 lds
    buffer_load_dwordx4 v14, s[48:51], s75 offen offset:2048 lds
    buffer_load_dwordx4 v15, s[48:51], s75 offen offset:3072 lds
    s_barrier
    s_waitcnt vmcnt(44)
    s_mov_b32 m0, 49152
    s_add_u32 s75, s6, 256
    buffer_load_dwordx4 v12, s[48:51], s75 offen offset:0 lds
    buffer_load_dwordx4 v13, s[48:51], s75 offen offset:1024 lds
    buffer_load_dwordx4 v14, s[48:51], s75 offen offset:2048 lds
    buffer_load_dwordx4 v15, s[48:51], s75 offen offset:3072 lds
    s_mov_b32 m0, 53248
    s_add_u32 s75, s6, 114944
    buffer_load_dwordx4 v12, s[48:51], s75 offen offset:0 lds
    buffer_load_dwordx4 v13, s[48:51], s75 offen offset:1024 lds
    buffer_load_dwordx4 v14, s[48:51], s75 offen offset:2048 lds
    buffer_load_dwordx4 v15, s[48:51], s75 offen offset:3072 lds
    s_mov_b32 m0, 57344
    s_add_u32 s75, s6, 229632
    buffer_load_dwordx4 v12, s[48:51], s75 offen offset:0 lds
    buffer_load_dwordx4 v13, s[48:51], s75 offen offset:1024 lds
    buffer_load_dwordx4 v14, s[48:51], s75 offen offset:2048 lds
    buffer_load_dwordx4 v15, s[48:51], s75 offen offset:3072 lds
    s_mov_b32 m0, 61440
    s_add_u32 s75, s6, 344320
    buffer_load_dwordx4 v12, s[48:51], s75 offen offset:0 lds
    buffer_load_dwordx4 v13, s[48:51], s75 offen offset:1024 lds
    buffer_load_dwordx4 v14, s[48:51], s75 offen offset:2048 lds
    buffer_load_dwordx4 v15, s[48:51], s75 offen offset:3072 lds
    s_barrier
    s_waitcnt vmcnt(44)
    s_mov_b32 m0, 131072
    s_add_u32 s75, s7, 256
    buffer_load_dwordx4 v12, s[48:51], s75 offen offset:0 lds
    buffer_load_dwordx4 v13, s[48:51], s75 offen offset:1024 lds
    buffer_load_dwordx4 v14, s[48:51], s75 offen offset:2048 lds
    buffer_load_dwordx4 v15, s[48:51], s75 offen offset:3072 lds
    s_mov_b32 m0, 135168
    s_add_u32 s75, s7, 114944
    buffer_load_dwordx4 v12, s[48:51], s75 offen offset:0 lds
    buffer_load_dwordx4 v13, s[48:51], s75 offen offset:1024 lds
    buffer_load_dwordx4 v14, s[48:51], s75 offen offset:2048 lds
    buffer_load_dwordx4 v15, s[48:51], s75 offen offset:3072 lds
    s_mov_b32 m0, 139264
    s_add_u32 s75, s7, 229632
    buffer_load_dwordx4 v12, s[48:51], s75 offen offset:0 lds
    buffer_load_dwordx4 v13, s[48:51], s75 offen offset:1024 lds
    buffer_load_dwordx4 v14, s[48:51], s75 offen offset:2048 lds
    buffer_load_dwordx4 v15, s[48:51], s75 offen offset:3072 lds
    s_mov_b32 m0, 143360
    s_add_u32 s75, s7, 344320
    buffer_load_dwordx4 v12, s[48:51], s75 offen offset:0 lds
    buffer_load_dwordx4 v13, s[48:51], s75 offen offset:1024 lds
    buffer_load_dwordx4 v14, s[48:51], s75 offen offset:2048 lds
    buffer_load_dwordx4 v15, s[48:51], s75 offen offset:3072 lds
    s_barrier
    s_waitcnt vmcnt(44)
    s_mov_b32 m0, 65536
    s_add_u32 s75, s22, 0
    s_nop 0
    buffer_load_dwordx4 v4, s[52:55], s75 offen offset:0 lds
    buffer_load_dwordx4 v5, s[52:55], s75 offen offset:1024 lds
    buffer_load_dwordx4 v6, s[52:55], s75 offen offset:2048 lds
    buffer_load_dwordx4 v7, s[52:55], s75 offen offset:3072 lds
    s_mov_b32 m0, 69632
    s_add_u32 s75, s22, 32768
    buffer_load_dwordx4 v4, s[52:55], s75 offen offset:0 lds
    buffer_load_dwordx4 v5, s[52:55], s75 offen offset:1024 lds
    buffer_load_dwordx4 v6, s[52:55], s75 offen offset:2048 lds
    buffer_load_dwordx4 v7, s[52:55], s75 offen offset:3072 lds
    s_mov_b32 m0, 73728
    s_add_u32 s75, s22, 262144
    buffer_load_dwordx4 v4, s[52:55], s75 offen offset:0 lds
    buffer_load_dwordx4 v5, s[52:55], s75 offen offset:1024 lds
    buffer_load_dwordx4 v6, s[52:55], s75 offen offset:2048 lds
    buffer_load_dwordx4 v7, s[52:55], s75 offen offset:3072 lds
    s_mov_b32 m0, 77824
    s_add_u32 s75, s22, 294912
    buffer_load_dwordx4 v4, s[52:55], s75 offen offset:0 lds
    buffer_load_dwordx4 v5, s[52:55], s75 offen offset:1024 lds
    buffer_load_dwordx4 v6, s[52:55], s75 offen offset:2048 lds
    buffer_load_dwordx4 v7, s[52:55], s75 offen offset:3072 lds
    s_barrier
    s_waitcnt vmcnt(44)
    s_mov_b32 m0, 81920
    s_add_u32 s75, s23, 0
    s_nop 0
    buffer_load_dwordx4 v4, s[52:55], s75 offen offset:0 lds
    buffer_load_dwordx4 v5, s[52:55], s75 offen offset:1024 lds
    buffer_load_dwordx4 v6, s[52:55], s75 offen offset:2048 lds
    buffer_load_dwordx4 v7, s[52:55], s75 offen offset:3072 lds
    s_mov_b32 m0, 86016
    s_add_u32 s75, s23, 32768
    buffer_load_dwordx4 v4, s[52:55], s75 offen offset:0 lds
    buffer_load_dwordx4 v5, s[52:55], s75 offen offset:1024 lds
    buffer_load_dwordx4 v6, s[52:55], s75 offen offset:2048 lds
    buffer_load_dwordx4 v7, s[52:55], s75 offen offset:3072 lds
    s_mov_b32 m0, 90112
    s_add_u32 s75, s23, 262144
    buffer_load_dwordx4 v4, s[52:55], s75 offen offset:0 lds
    buffer_load_dwordx4 v5, s[52:55], s75 offen offset:1024 lds
    buffer_load_dwordx4 v6, s[52:55], s75 offen offset:2048 lds
    buffer_load_dwordx4 v7, s[52:55], s75 offen offset:3072 lds
    s_mov_b32 m0, 94208
    s_add_u32 s75, s23, 294912
    buffer_load_dwordx4 v4, s[52:55], s75 offen offset:0 lds
    buffer_load_dwordx4 v5, s[52:55], s75 offen offset:1024 lds
    buffer_load_dwordx4 v6, s[52:55], s75 offen offset:2048 lds
    buffer_load_dwordx4 v7, s[52:55], s75 offen offset:3072 lds
    s_waitcnt vmcnt(44)
    s_mov_b32 m0, 98304
    s_add_u32 s75, s24, 0
    buffer_load_dwordx4 v4, s[52:55], s75 offen offset:0 lds
    buffer_load_dwordx4 v5, s[52:55], s75 offen offset:1024 lds
    buffer_load_dwordx4 v6, s[52:55], s75 offen offset:2048 lds
    buffer_load_dwordx4 v7, s[52:55], s75 offen offset:3072 lds
    s_mov_b32 m0, 102400
    s_add_u32 s75, s24, 32768
    buffer_load_dwordx4 v4, s[52:55], s75 offen offset:0 lds
    buffer_load_dwordx4 v5, s[52:55], s75 offen offset:1024 lds
    buffer_load_dwordx4 v6, s[52:55], s75 offen offset:2048 lds
    buffer_load_dwordx4 v7, s[52:55], s75 offen offset:3072 lds
    s_mov_b32 m0, 106496
    s_add_u32 s75, s24, 262144
    buffer_load_dwordx4 v4, s[52:55], s75 offen offset:0 lds
    buffer_load_dwordx4 v5, s[52:55], s75 offen offset:1024 lds
    buffer_load_dwordx4 v6, s[52:55], s75 offen offset:2048 lds
    buffer_load_dwordx4 v7, s[52:55], s75 offen offset:3072 lds
    s_mov_b32 m0, 110592
    s_add_u32 s75, s24, 294912
    buffer_load_dwordx4 v4, s[52:55], s75 offen offset:0 lds
    buffer_load_dwordx4 v5, s[52:55], s75 offen offset:1024 lds
    buffer_load_dwordx4 v6, s[52:55], s75 offen offset:2048 lds
    buffer_load_dwordx4 v7, s[52:55], s75 offen offset:3072 lds
    s_waitcnt vmcnt(44)
    s_mov_b32 m0, 114688
    s_add_u32 s75, s25, 0
    buffer_load_dwordx4 v4, s[52:55], s75 offen offset:0 lds
    buffer_load_dwordx4 v5, s[52:55], s75 offen offset:1024 lds
    buffer_load_dwordx4 v6, s[52:55], s75 offen offset:2048 lds
    buffer_load_dwordx4 v7, s[52:55], s75 offen offset:3072 lds
    s_mov_b32 m0, 118784
    s_add_u32 s75, s25, 32768
    buffer_load_dwordx4 v4, s[52:55], s75 offen offset:0 lds
    buffer_load_dwordx4 v5, s[52:55], s75 offen offset:1024 lds
    buffer_load_dwordx4 v6, s[52:55], s75 offen offset:2048 lds
    buffer_load_dwordx4 v7, s[52:55], s75 offen offset:3072 lds
    s_mov_b32 m0, 122880
    s_add_u32 s75, s25, 262144
    buffer_load_dwordx4 v4, s[52:55], s75 offen offset:0 lds
    buffer_load_dwordx4 v5, s[52:55], s75 offen offset:1024 lds
    buffer_load_dwordx4 v6, s[52:55], s75 offen offset:2048 lds
    buffer_load_dwordx4 v7, s[52:55], s75 offen offset:3072 lds
    s_mov_b32 m0, 126976
    s_add_u32 s75, s25, 294912
    buffer_load_dwordx4 v4, s[52:55], s75 offen offset:0 lds
    buffer_load_dwordx4 v5, s[52:55], s75 offen offset:1024 lds
    buffer_load_dwordx4 v6, s[52:55], s75 offen offset:2048 lds
    buffer_load_dwordx4 v7, s[52:55], s75 offen offset:3072 lds
    s_waitcnt vmcnt(44)
    s_mov_b32 m0, 0
    s_add_u32 s79, s3, 0
    s_and_b32 s79, s79, 3
    s_lshl_b32 s79, s79, 17
    s_add_u32 s75, s79, 0
    buffer_load_dwordx4 v4, s[36:39], s75 offen offset:0 lds
    buffer_load_dwordx4 v5, s[36:39], s75 offen offset:1024 lds
    buffer_load_dwordx4 v6, s[36:39], s75 offen offset:2048 lds
    buffer_load_dwordx4 v7, s[36:39], s75 offen offset:3072 lds
    s_mov_b32 m0, 4096
    s_add_u32 s75, s79, 32768
    buffer_load_dwordx4 v4, s[36:39], s75 offen offset:0 lds
    buffer_load_dwordx4 v5, s[36:39], s75 offen offset:1024 lds
    buffer_load_dwordx4 v6, s[36:39], s75 offen offset:2048 lds
    buffer_load_dwordx4 v7, s[36:39], s75 offen offset:3072 lds
    s_mov_b32 m0, 8192
    s_add_u32 s75, s79, 65536
    buffer_load_dwordx4 v4, s[36:39], s75 offen offset:0 lds
    buffer_load_dwordx4 v5, s[36:39], s75 offen offset:1024 lds
    buffer_load_dwordx4 v6, s[36:39], s75 offen offset:2048 lds
    buffer_load_dwordx4 v7, s[36:39], s75 offen offset:3072 lds
    s_mov_b32 m0, 12288
    s_add_u32 s75, s79, 98304
    buffer_load_dwordx4 v4, s[36:39], s75 offen offset:0 lds
    buffer_load_dwordx4 v5, s[36:39], s75 offen offset:1024 lds
    buffer_load_dwordx4 v6, s[36:39], s75 offen offset:2048 lds
    buffer_load_dwordx4 v7, s[36:39], s75 offen offset:3072 lds
    s_barrier
    s_barrier
    s_waitcnt vmcnt(44)
    s_mov_b32 m0, 16384
    s_add_u32 s79, s3, 1
    s_and_b32 s79, s79, 3
    s_lshl_b32 s79, s79, 17
    s_add_u32 s75, s79, 0
    s_nop 0
    buffer_load_dwordx4 v4, s[36:39], s75 offen offset:0 lds
    buffer_load_dwordx4 v5, s[36:39], s75 offen offset:1024 lds
    buffer_load_dwordx4 v6, s[36:39], s75 offen offset:2048 lds
    buffer_load_dwordx4 v7, s[36:39], s75 offen offset:3072 lds
    s_mov_b32 m0, 20480
    s_add_u32 s75, s79, 32768
    buffer_load_dwordx4 v4, s[36:39], s75 offen offset:0 lds
    buffer_load_dwordx4 v5, s[36:39], s75 offen offset:1024 lds
    buffer_load_dwordx4 v6, s[36:39], s75 offen offset:2048 lds
    buffer_load_dwordx4 v7, s[36:39], s75 offen offset:3072 lds
    s_mov_b32 m0, 24576
    s_add_u32 s75, s79, 65536
    buffer_load_dwordx4 v4, s[36:39], s75 offen offset:0 lds
    buffer_load_dwordx4 v5, s[36:39], s75 offen offset:1024 lds
    buffer_load_dwordx4 v6, s[36:39], s75 offen offset:2048 lds
    buffer_load_dwordx4 v7, s[36:39], s75 offen offset:3072 lds
    s_mov_b32 m0, 28672
    s_add_u32 s75, s79, 98304
    buffer_load_dwordx4 v4, s[36:39], s75 offen offset:0 lds
    buffer_load_dwordx4 v5, s[36:39], s75 offen offset:1024 lds
    buffer_load_dwordx4 v6, s[36:39], s75 offen offset:2048 lds
    buffer_load_dwordx4 v7, s[36:39], s75 offen offset:3072 lds
    s_barrier
    s_waitcnt vmcnt(44)
    s_mov_b32 m0, 147456
    s_add_u32 s79, s3, 2
    s_and_b32 s79, s79, 3
    s_lshl_b32 s79, s79, 17
    s_add_u32 s75, s79, 0
    buffer_load_dwordx4 v4, s[36:39], s75 offen offset:0 lds
    buffer_load_dwordx4 v5, s[36:39], s75 offen offset:1024 lds
    buffer_load_dwordx4 v6, s[36:39], s75 offen offset:2048 lds
    buffer_load_dwordx4 v7, s[36:39], s75 offen offset:3072 lds
    s_mov_b32 m0, 151552
    s_add_u32 s75, s79, 32768
    buffer_load_dwordx4 v4, s[36:39], s75 offen offset:0 lds
    buffer_load_dwordx4 v5, s[36:39], s75 offen offset:1024 lds
    buffer_load_dwordx4 v6, s[36:39], s75 offen offset:2048 lds
    buffer_load_dwordx4 v7, s[36:39], s75 offen offset:3072 lds
    s_mov_b32 m0, 155648
    s_add_u32 s75, s79, 65536
    buffer_load_dwordx4 v4, s[36:39], s75 offen offset:0 lds
    buffer_load_dwordx4 v5, s[36:39], s75 offen offset:1024 lds
    buffer_load_dwordx4 v6, s[36:39], s75 offen offset:2048 lds
    buffer_load_dwordx4 v7, s[36:39], s75 offen offset:3072 lds
    s_mov_b32 m0, 159744
    s_add_u32 s75, s79, 98304
    buffer_load_dwordx4 v4, s[36:39], s75 offen offset:0 lds
    buffer_load_dwordx4 v5, s[36:39], s75 offen offset:1024 lds
    buffer_load_dwordx4 v6, s[36:39], s75 offen offset:2048 lds
    buffer_load_dwordx4 v7, s[36:39], s75 offen offset:3072 lds
    s_barrier
    s_waitcnt vmcnt(44)
    s_mov_b32 m0, 32768
    s_add_u32 s79, s3, 3
    s_and_b32 s79, s79, 3
    s_lshl_b32 s79, s79, 17
    s_add_u32 s75, s79, 0
    buffer_load_dwordx4 v4, s[36:39], s75 offen offset:0 lds
    buffer_load_dwordx4 v5, s[36:39], s75 offen offset:1024 lds
    buffer_load_dwordx4 v6, s[36:39], s75 offen offset:2048 lds
    buffer_load_dwordx4 v7, s[36:39], s75 offen offset:3072 lds
    s_mov_b32 m0, 36864
    s_add_u32 s75, s79, 32768
    buffer_load_dwordx4 v4, s[36:39], s75 offen offset:0 lds
    buffer_load_dwordx4 v5, s[36:39], s75 offen offset:1024 lds
    buffer_load_dwordx4 v6, s[36:39], s75 offen offset:2048 lds
    buffer_load_dwordx4 v7, s[36:39], s75 offen offset:3072 lds
    s_mov_b32 m0, 40960
    s_add_u32 s75, s79, 65536
    buffer_load_dwordx4 v4, s[36:39], s75 offen offset:0 lds
    buffer_load_dwordx4 v5, s[36:39], s75 offen offset:1024 lds
    buffer_load_dwordx4 v6, s[36:39], s75 offen offset:2048 lds
    buffer_load_dwordx4 v7, s[36:39], s75 offen offset:3072 lds
    s_mov_b32 m0, 45056
    s_add_u32 s75, s79, 98304
    buffer_load_dwordx4 v4, s[36:39], s75 offen offset:0 lds
    buffer_load_dwordx4 v5, s[36:39], s75 offen offset:1024 lds
    buffer_load_dwordx4 v6, s[36:39], s75 offen offset:2048 lds
    buffer_load_dwordx4 v7, s[36:39], s75 offen offset:3072 lds
    s_barrier
    s_barrier
    s_barrier
    s_waitcnt vmcnt(44)
    s_mov_b32 m0, 49152
    s_add_u32 s75, s22, 65536
    buffer_load_dwordx4 v4, s[52:55], s75 offen offset:0 lds
    buffer_load_dwordx4 v5, s[52:55], s75 offen offset:1024 lds
    buffer_load_dwordx4 v6, s[52:55], s75 offen offset:2048 lds
    buffer_load_dwordx4 v7, s[52:55], s75 offen offset:3072 lds
    s_mov_b32 m0, 53248
    s_add_u32 s75, s22, 98304
    buffer_load_dwordx4 v4, s[52:55], s75 offen offset:0 lds
    buffer_load_dwordx4 v5, s[52:55], s75 offen offset:1024 lds
    buffer_load_dwordx4 v6, s[52:55], s75 offen offset:2048 lds
    buffer_load_dwordx4 v7, s[52:55], s75 offen offset:3072 lds
    s_mov_b32 m0, 57344
    s_add_u32 s75, s22, 327680
    buffer_load_dwordx4 v4, s[52:55], s75 offen offset:0 lds
    buffer_load_dwordx4 v5, s[52:55], s75 offen offset:1024 lds
    buffer_load_dwordx4 v6, s[52:55], s75 offen offset:2048 lds
    buffer_load_dwordx4 v7, s[52:55], s75 offen offset:3072 lds
    s_mov_b32 m0, 61440
    s_add_u32 s75, s22, 360448
    buffer_load_dwordx4 v4, s[52:55], s75 offen offset:0 lds
    buffer_load_dwordx4 v5, s[52:55], s75 offen offset:1024 lds
    buffer_load_dwordx4 v6, s[52:55], s75 offen offset:2048 lds
    buffer_load_dwordx4 v7, s[52:55], s75 offen offset:3072 lds
    s_barrier
    s_waitcnt vmcnt(44)
    s_mov_b32 m0, 131072
    s_add_u32 s75, s23, 65536
    buffer_load_dwordx4 v4, s[52:55], s75 offen offset:0 lds
    buffer_load_dwordx4 v5, s[52:55], s75 offen offset:1024 lds
    buffer_load_dwordx4 v6, s[52:55], s75 offen offset:2048 lds
    buffer_load_dwordx4 v7, s[52:55], s75 offen offset:3072 lds
    s_mov_b32 m0, 135168
    s_add_u32 s75, s23, 98304
    buffer_load_dwordx4 v4, s[52:55], s75 offen offset:0 lds
    buffer_load_dwordx4 v5, s[52:55], s75 offen offset:1024 lds
    buffer_load_dwordx4 v6, s[52:55], s75 offen offset:2048 lds
    buffer_load_dwordx4 v7, s[52:55], s75 offen offset:3072 lds
    s_mov_b32 m0, 139264
    s_add_u32 s75, s23, 327680
    buffer_load_dwordx4 v4, s[52:55], s75 offen offset:0 lds
    buffer_load_dwordx4 v5, s[52:55], s75 offen offset:1024 lds
    buffer_load_dwordx4 v6, s[52:55], s75 offen offset:2048 lds
    buffer_load_dwordx4 v7, s[52:55], s75 offen offset:3072 lds
    s_mov_b32 m0, 143360
    s_add_u32 s75, s23, 360448
    buffer_load_dwordx4 v4, s[52:55], s75 offen offset:0 lds
    buffer_load_dwordx4 v5, s[52:55], s75 offen offset:1024 lds
    buffer_load_dwordx4 v6, s[52:55], s75 offen offset:2048 lds
    buffer_load_dwordx4 v7, s[52:55], s75 offen offset:3072 lds
    s_barrier
    s_waitcnt vmcnt(44)
    s_mov_b32 m0, 65536
    s_add_u32 s75, s24, 65536
    buffer_load_dwordx4 v4, s[52:55], s75 offen offset:0 lds
    buffer_load_dwordx4 v5, s[52:55], s75 offen offset:1024 lds
    buffer_load_dwordx4 v6, s[52:55], s75 offen offset:2048 lds
    buffer_load_dwordx4 v7, s[52:55], s75 offen offset:3072 lds
    s_mov_b32 m0, 69632
    s_add_u32 s75, s24, 98304
    buffer_load_dwordx4 v4, s[52:55], s75 offen offset:0 lds
    buffer_load_dwordx4 v5, s[52:55], s75 offen offset:1024 lds
    buffer_load_dwordx4 v6, s[52:55], s75 offen offset:2048 lds
    buffer_load_dwordx4 v7, s[52:55], s75 offen offset:3072 lds
    s_mov_b32 m0, 73728
    s_add_u32 s75, s24, 327680
    buffer_load_dwordx4 v4, s[52:55], s75 offen offset:0 lds
    buffer_load_dwordx4 v5, s[52:55], s75 offen offset:1024 lds
    buffer_load_dwordx4 v6, s[52:55], s75 offen offset:2048 lds
    buffer_load_dwordx4 v7, s[52:55], s75 offen offset:3072 lds
    s_mov_b32 m0, 77824
    s_add_u32 s75, s24, 360448
    buffer_load_dwordx4 v4, s[52:55], s75 offen offset:0 lds
    buffer_load_dwordx4 v5, s[52:55], s75 offen offset:1024 lds
    buffer_load_dwordx4 v6, s[52:55], s75 offen offset:2048 lds
    buffer_load_dwordx4 v7, s[52:55], s75 offen offset:3072 lds
    s_barrier
    s_waitcnt vmcnt(44)
    s_mov_b32 m0, 81920
    s_add_u32 s75, s25, 65536
    buffer_load_dwordx4 v4, s[52:55], s75 offen offset:0 lds
    buffer_load_dwordx4 v5, s[52:55], s75 offen offset:1024 lds
    buffer_load_dwordx4 v6, s[52:55], s75 offen offset:2048 lds
    buffer_load_dwordx4 v7, s[52:55], s75 offen offset:3072 lds
    s_mov_b32 m0, 86016
    s_add_u32 s75, s25, 98304
    buffer_load_dwordx4 v4, s[52:55], s75 offen offset:0 lds
    buffer_load_dwordx4 v5, s[52:55], s75 offen offset:1024 lds
    buffer_load_dwordx4 v6, s[52:55], s75 offen offset:2048 lds
    buffer_load_dwordx4 v7, s[52:55], s75 offen offset:3072 lds
    s_mov_b32 m0, 90112
    s_add_u32 s75, s25, 327680
    buffer_load_dwordx4 v4, s[52:55], s75 offen offset:0 lds
    buffer_load_dwordx4 v5, s[52:55], s75 offen offset:1024 lds
    buffer_load_dwordx4 v6, s[52:55], s75 offen offset:2048 lds
    buffer_load_dwordx4 v7, s[52:55], s75 offen offset:3072 lds
    s_mov_b32 m0, 94208
    s_add_u32 s75, s25, 360448
    buffer_load_dwordx4 v4, s[52:55], s75 offen offset:0 lds
    buffer_load_dwordx4 v5, s[52:55], s75 offen offset:1024 lds
    buffer_load_dwordx4 v6, s[52:55], s75 offen offset:2048 lds
    buffer_load_dwordx4 v7, s[52:55], s75 offen offset:3072 lds
    s_barrier
    s_waitcnt vmcnt(44)
    s_mov_b32 m0, 98304
    s_add_u32 s79, s3, 0
    s_and_b32 s79, s79, 1
    s_mul_i32 s79, s79, 917504
    s_add_u32 s75, s79, 196608
    buffer_load_dwordx4 v4, s[52:55], s75 offen offset:0 lds
    buffer_load_dwordx4 v5, s[52:55], s75 offen offset:1024 lds
    buffer_load_dwordx4 v6, s[52:55], s75 offen offset:2048 lds
    buffer_load_dwordx4 v7, s[52:55], s75 offen offset:3072 lds
    s_mov_b32 m0, 102400
    s_add_u32 s75, s79, 229376
    buffer_load_dwordx4 v4, s[52:55], s75 offen offset:0 lds
    buffer_load_dwordx4 v5, s[52:55], s75 offen offset:1024 lds
    buffer_load_dwordx4 v6, s[52:55], s75 offen offset:2048 lds
    buffer_load_dwordx4 v7, s[52:55], s75 offen offset:3072 lds
    s_mov_b32 m0, 106496
    s_add_u32 s75, s79, 655360
    buffer_load_dwordx4 v4, s[52:55], s75 offen offset:0 lds
    buffer_load_dwordx4 v5, s[52:55], s75 offen offset:1024 lds
    buffer_load_dwordx4 v6, s[52:55], s75 offen offset:2048 lds
    buffer_load_dwordx4 v7, s[52:55], s75 offen offset:3072 lds
    s_mov_b32 m0, 110592
    s_add_u32 s75, s79, 688128
    buffer_load_dwordx4 v4, s[52:55], s75 offen offset:0 lds
    buffer_load_dwordx4 v5, s[52:55], s75 offen offset:1024 lds
    buffer_load_dwordx4 v6, s[52:55], s75 offen offset:2048 lds
    buffer_load_dwordx4 v7, s[52:55], s75 offen offset:3072 lds
    s_barrier
    s_waitcnt vmcnt(44)
    s_mov_b32 m0, 114688
    s_add_u32 s79, s3, 1
    s_and_b32 s79, s79, 1
    s_mul_i32 s79, s79, 917504
    s_add_u32 s75, s79, 196608
    buffer_load_dwordx4 v4, s[52:55], s75 offen offset:0 lds
    buffer_load_dwordx4 v5, s[52:55], s75 offen offset:1024 lds
    buffer_load_dwordx4 v6, s[52:55], s75 offen offset:2048 lds
    buffer_load_dwordx4 v7, s[52:55], s75 offen offset:3072 lds
    s_mov_b32 m0, 118784
    s_add_u32 s75, s79, 229376
    buffer_load_dwordx4 v4, s[52:55], s75 offen offset:0 lds
    buffer_load_dwordx4 v5, s[52:55], s75 offen offset:1024 lds
    buffer_load_dwordx4 v6, s[52:55], s75 offen offset:2048 lds
    buffer_load_dwordx4 v7, s[52:55], s75 offen offset:3072 lds
    s_mov_b32 m0, 122880
    s_add_u32 s75, s79, 655360
    buffer_load_dwordx4 v4, s[52:55], s75 offen offset:0 lds
    buffer_load_dwordx4 v5, s[52:55], s75 offen offset:1024 lds
    buffer_load_dwordx4 v6, s[52:55], s75 offen offset:2048 lds
    buffer_load_dwordx4 v7, s[52:55], s75 offen offset:3072 lds
    s_mov_b32 m0, 126976
    s_add_u32 s75, s79, 688128
    buffer_load_dwordx4 v4, s[52:55], s75 offen offset:0 lds
    buffer_load_dwordx4 v5, s[52:55], s75 offen offset:1024 lds
    buffer_load_dwordx4 v6, s[52:55], s75 offen offset:2048 lds
    buffer_load_dwordx4 v7, s[52:55], s75 offen offset:3072 lds
    s_barrier
    s_waitcnt vmcnt(44)
    s_mov_b32 m0, 0
    s_nop 0
    s_add_u32 s75, s22, 131072
    buffer_load_dwordx4 v4, s[52:55], s75 offen offset:0 lds
    buffer_load_dwordx4 v5, s[52:55], s75 offen offset:1024 lds
    buffer_load_dwordx4 v6, s[52:55], s75 offen offset:2048 lds
    buffer_load_dwordx4 v7, s[52:55], s75 offen offset:3072 lds
    s_mov_b32 m0, 4096
    s_add_u32 s75, s22, 163840
    buffer_load_dwordx4 v4, s[52:55], s75 offen offset:0 lds
    buffer_load_dwordx4 v5, s[52:55], s75 offen offset:1024 lds
    buffer_load_dwordx4 v6, s[52:55], s75 offen offset:2048 lds
    buffer_load_dwordx4 v7, s[52:55], s75 offen offset:3072 lds
    s_mov_b32 m0, 8192
    s_add_u32 s75, s22, 393216
    buffer_load_dwordx4 v4, s[52:55], s75 offen offset:0 lds
    buffer_load_dwordx4 v5, s[52:55], s75 offen offset:1024 lds
    buffer_load_dwordx4 v6, s[52:55], s75 offen offset:2048 lds
    buffer_load_dwordx4 v7, s[52:55], s75 offen offset:3072 lds
    s_mov_b32 m0, 12288
    s_add_u32 s75, s22, 425984
    buffer_load_dwordx4 v4, s[52:55], s75 offen offset:0 lds
    buffer_load_dwordx4 v5, s[52:55], s75 offen offset:1024 lds
    buffer_load_dwordx4 v6, s[52:55], s75 offen offset:2048 lds
    buffer_load_dwordx4 v7, s[52:55], s75 offen offset:3072 lds
    s_barrier
    s_waitcnt vmcnt(44)
    s_mov_b32 m0, 16384
    s_add_u32 s75, s23, 131072
    buffer_load_dwordx4 v4, s[52:55], s75 offen offset:0 lds
    buffer_load_dwordx4 v5, s[52:55], s75 offen offset:1024 lds
    buffer_load_dwordx4 v6, s[52:55], s75 offen offset:2048 lds
    buffer_load_dwordx4 v7, s[52:55], s75 offen offset:3072 lds
    s_mov_b32 m0, 20480
    s_add_u32 s75, s23, 163840
    buffer_load_dwordx4 v4, s[52:55], s75 offen offset:0 lds
    buffer_load_dwordx4 v5, s[52:55], s75 offen offset:1024 lds
    buffer_load_dwordx4 v6, s[52:55], s75 offen offset:2048 lds
    buffer_load_dwordx4 v7, s[52:55], s75 offen offset:3072 lds
    s_mov_b32 m0, 24576
    s_add_u32 s75, s23, 393216
    buffer_load_dwordx4 v4, s[52:55], s75 offen offset:0 lds
    buffer_load_dwordx4 v5, s[52:55], s75 offen offset:1024 lds
    buffer_load_dwordx4 v6, s[52:55], s75 offen offset:2048 lds
    buffer_load_dwordx4 v7, s[52:55], s75 offen offset:3072 lds
    s_mov_b32 m0, 28672
    s_add_u32 s75, s23, 425984
    buffer_load_dwordx4 v4, s[52:55], s75 offen offset:0 lds
    buffer_load_dwordx4 v5, s[52:55], s75 offen offset:1024 lds
    buffer_load_dwordx4 v6, s[52:55], s75 offen offset:2048 lds
    buffer_load_dwordx4 v7, s[52:55], s75 offen offset:3072 lds
    s_barrier
    s_waitcnt vmcnt(44)
    s_mov_b32 m0, 32768
    s_add_u32 s75, s24, 131072
    buffer_load_dwordx4 v4, s[52:55], s75 offen offset:0 lds
    buffer_load_dwordx4 v5, s[52:55], s75 offen offset:1024 lds
    buffer_load_dwordx4 v6, s[52:55], s75 offen offset:2048 lds
    buffer_load_dwordx4 v7, s[52:55], s75 offen offset:3072 lds
    s_mov_b32 m0, 36864
    s_add_u32 s75, s24, 163840
    buffer_load_dwordx4 v4, s[52:55], s75 offen offset:0 lds
    buffer_load_dwordx4 v5, s[52:55], s75 offen offset:1024 lds
    buffer_load_dwordx4 v6, s[52:55], s75 offen offset:2048 lds
    buffer_load_dwordx4 v7, s[52:55], s75 offen offset:3072 lds
    s_mov_b32 m0, 40960
    s_add_u32 s75, s24, 393216
    buffer_load_dwordx4 v4, s[52:55], s75 offen offset:0 lds
    buffer_load_dwordx4 v5, s[52:55], s75 offen offset:1024 lds
    buffer_load_dwordx4 v6, s[52:55], s75 offen offset:2048 lds
    buffer_load_dwordx4 v7, s[52:55], s75 offen offset:3072 lds
    s_mov_b32 m0, 45056
    s_add_u32 s75, s24, 425984
    buffer_load_dwordx4 v4, s[52:55], s75 offen offset:0 lds
    buffer_load_dwordx4 v5, s[52:55], s75 offen offset:1024 lds
    buffer_load_dwordx4 v6, s[52:55], s75 offen offset:2048 lds
    buffer_load_dwordx4 v7, s[52:55], s75 offen offset:3072 lds
    s_barrier
    s_waitcnt vmcnt(44)
    s_mov_b32 m0, 49152
    s_add_u32 s75, s25, 131072
    buffer_load_dwordx4 v4, s[52:55], s75 offen offset:0 lds
    buffer_load_dwordx4 v5, s[52:55], s75 offen offset:1024 lds
    buffer_load_dwordx4 v6, s[52:55], s75 offen offset:2048 lds
    buffer_load_dwordx4 v7, s[52:55], s75 offen offset:3072 lds
    s_mov_b32 m0, 53248
    s_add_u32 s75, s25, 163840
    buffer_load_dwordx4 v4, s[52:55], s75 offen offset:0 lds
    buffer_load_dwordx4 v5, s[52:55], s75 offen offset:1024 lds
    buffer_load_dwordx4 v6, s[52:55], s75 offen offset:2048 lds
    buffer_load_dwordx4 v7, s[52:55], s75 offen offset:3072 lds
    s_mov_b32 m0, 57344
    s_add_u32 s75, s25, 393216
    buffer_load_dwordx4 v4, s[52:55], s75 offen offset:0 lds
    buffer_load_dwordx4 v5, s[52:55], s75 offen offset:1024 lds
    buffer_load_dwordx4 v6, s[52:55], s75 offen offset:2048 lds
    buffer_load_dwordx4 v7, s[52:55], s75 offen offset:3072 lds
    s_mov_b32 m0, 61440
    s_add_u32 s75, s25, 425984
    buffer_load_dwordx4 v4, s[52:55], s75 offen offset:0 lds
    buffer_load_dwordx4 v5, s[52:55], s75 offen offset:1024 lds
    buffer_load_dwordx4 v6, s[52:55], s75 offen offset:2048 lds
    buffer_load_dwordx4 v7, s[52:55], s75 offen offset:3072 lds
    s_barrier
    s_waitcnt vmcnt(48)
    s_barrier
    s_waitcnt vmcnt(32)
    s_barrier
    s_waitcnt vmcnt(16)
    s_barrier
    s_waitcnt vmcnt(0)
    s_barrier
    s_endpgm
L_compute:
    v_lshrrev_b32 v228, 4, v0
    v_and_b32 v229, 15, v0
    v_lshrrev_b32 v230, 2, v229
    v_and_b32 v231, 3, v0
    v_lshrrev_b32 v232, 5, v0
    v_and_b32 v233, 31, v0
    v_and_b32 v234, 1, v228
    v_lshlrev_b32 v22, 4, v0
    v_lshlrev_b32 v242, 3, v0
    s_lshr_b32 s76, s2, 3
    s_lshl_b32 s76, s76, 2
    s_add_u32 s76, s76, s70
    s_lshl_b32 s76, s76, 9
    s_getpc_b64 s[92:93]
L_pc:
    s_sub_u32 s92, s92, L_pc-parallel_sum__linear_attn_block__mixer_s_mlp__prompt_kernel
    s_subb_u32 s93, s93, 0
    s_and_b32 s93, s93, 0xffff
    s_mov_b32 s94, L_end-parallel_sum__linear_attn_block__mixer_s_mlp__prompt_kernel
    s_mov_b32 s95, 0x20000
    buffer_load_dword v24, v242, s[92:95], s76 offen
    s_waitcnt lgkmcnt(0)
    s_mov_b32 s80, 0x358637bd
    s_mov_b32 s81, 0x358637bd
    s_mov_b32 s82, 0x3f803f80
    s_mov_b32 s28, s4
    s_and_b32 s29, s5, 0xffff
    s_mov_b32 s30, 2097152
    s_mov_b32 s31, 0x20000
    s_mov_b32 s40, s12
    s_and_b32 s41, s13, 0xffff
    s_mov_b32 s42, 524288
    s_mov_b32 s43, 0x20000
    s_mov_b32 s32, s6
    s_and_b32 s33, s7, 0xffff
    s_mov_b32 s34, 1572864
    s_mov_b32 s35, 0x20000
    s_mov_b32 s36, s8
    s_and_b32 s37, s9, 0xffff
    s_mov_b32 s38, 524288
    s_mov_b32 s39, 0x20000
    s_mov_b32 s44, s14
    s_and_b32 s45, s15, 0xffff
    s_mov_b32 s46, 524288
    s_mov_b32 s47, 0x20000
    s_mov_b32 s48, s16
    s_and_b32 s49, s17, 0xffff
    s_mov_b32 s50, 1835008
    s_mov_b32 s51, 0x20000
    s_mov_b32 s52, s18
    s_and_b32 s53, s19, 0xffff
    s_mov_b32 s54, 1835008
    s_mov_b32 s55, 0x20000
    s_mov_b32 s56, s20
    s_and_b32 s57, s21, 0xffff
    s_mov_b32 s58, 2097152
    s_mov_b32 s59, 0x20000
    s_mov_b32 s60, s24
    s_and_b32 s61, s25, 0xffff
    s_mov_b32 s62, 18874368
    s_mov_b32 s63, 0x20000
    s_mov_b32 s64, s22
    s_and_b32 s65, s23, 0xffff
    s_mov_b32 s66, 256
    s_mov_b32 s67, 0x20000
    s_lshr_b32 s73, s68, 2
    s_or_b32 s73, s73, s70
    s_cmp_lg_u32 s73, 0
    s_cbranch_scc1 L_nozero
    v_mov_b32 v244, 0
    v_mov_b32 v245, 0
    v_mov_b32 v246, 0
    v_mov_b32 v247, 0
    s_lshl_b32 s76, s69, 2
    s_add_u32 s76, s76, s68
    s_lshl_b32 s73, s76, 10
    s_add_u32 s73, s73, 13631488
    buffer_store_dwordx4 v[244:247], v22, s[60:63], s73 offen sc1
    s_lshl_b32 s73, s69, 18
    s_lshl_b32 s75, s68, 13
    s_add_u32 s73, s73, s75
    s_add_u32 s73, s73, 14680064
    s_add_u32 s75, s73, 4096
    buffer_store_dwordx4 v[244:247], v22, s[60:63], s73 offen offset:0 sc1
    buffer_store_dwordx4 v[244:247], v22, s[60:63], s73 offen offset:1024 sc1
    buffer_store_dwordx4 v[244:247], v22, s[60:63], s73 offen offset:2048 sc1
    buffer_store_dwordx4 v[244:247], v22, s[60:63], s73 offen offset:3072 sc1
    buffer_store_dwordx4 v[244:247], v22, s[60:63], s75 offen offset:0 sc1
    v_lshlrev_b32 v248, 12, v228
    v_lshl_add_u32 v248, v229, 3, v248
    s_lshl_b32 s73, s76, 7
    s_add_u32 s73, s73, 13697024
    buffer_store_dwordx2 v[244:245], v248, s[60:63], s73 offen sc1
    s_add_u32 s73, s73, 16384
    buffer_store_dwordx2 v[244:245], v248, s[60:63], s73 offen sc1
    v_mov_b32 v249, 1
    s_lshl_b32 s73, s76, 2
    v_mov_b32 v250, s73
    s_waitcnt vmcnt(0)
    s_mov_b64 exec, 1
    buffer_store_dword v249, v250, s[64:67], 0 offen sc1
    s_mov_b64 exec, -1
L_nozero:
    v_mov_b32 v241, 2147483648
    v_or_b32 v240, 0, v228
    v_xor_b32 v240, v240, v229
    v_lshlrev_b32 v240, 4, v240
    v_lshl_add_u32 v2, v229, 8, v240
    v_or_b32 v240, 4, v228
    v_xor_b32 v240, v240, v229
    v_lshlrev_b32 v240, 4, v240
    v_lshl_add_u32 v3, v229, 8, v240
    v_or_b32 v240, 8, v228
    v_xor_b32 v240, v240, v229
    v_lshlrev_b32 v240, 4, v240
    v_lshl_add_u32 v4, v229, 8, v240
    v_or_b32 v240, 12, v228
    v_xor_b32 v240, v240, v229
    v_lshlrev_b32 v240, 4, v240
    v_lshl_add_u32 v5, v229, 8, v240
    v_lshrrev_b32 v244, 1, v230
    v_lshlrev_b32 v244, 2, v244
    v_lshrrev_b32 v245, 1, v231
    v_and_b32 v246, 1, v231
    v_lshlrev_b32 v246, 3, v246
    s_lshl_b32 s73, s70, 1
    v_add_u32 v247, s73, v245
    v_xor_b32 v247, v247, v244
    v_lshlrev_b32 v248, 1, v234
    v_xor_b32 v247, v247, v248
    v_lshl_add_u32 v247, v247, 4, v246
    v_lshl_add_u32 v249, v228, 3, v230
    v_lshl_add_u32 v6, v249, 7, v247
    s_lshl_b32 s73, s72, 2
    v_add3_u32 v247, s73, v248, v245
    v_xor_b32 v247, v247, v244
    s_lshl_b32 s75, s72, 13
    v_lshlrev_b32 v249, 1, v232
    v_xor_b32 v249, v249, v247
    v_lshl_add_u32 v249, v249, 4, v246
    v_lshl_add_u32 v250, v232, 3, v230
    v_lshl_add_u32 v249, v250, 7, v249
    v_add_u32 v8, s75, v249
    v_xor_b32 v9, 64, v8
    v_lshl_add_u32 v249, v247, 4, v246
    v_lshl_add_u32 v250, v232, 2, v230
    v_lshl_add_u32 v14, v250, 7, v249
    v_xor_b32 v15, 32, v14
    v_add_u32 v15, 1024, v15
    v_add_u32 v10, s75, v14
    v_add_u32 v11, s75, v15
    v_xor_b32 v12, 64, v10
    v_xor_b32 v13, 64, v11
    v_lshlrev_b32 v20, 10, v232
    v_lshl_add_u32 v20, v233, 4, v20
    s_lshl_b32 s73, s71, 9
    v_add_u32 v21, s73, v20
    v_mov_b32 v56, s82
    v_mov_b32 v57, s82
    v_mov_b32 v58, s82
    v_mov_b32 v59, s82
    s_lshl_b32 s73, s71, 5
    v_add_u32 v240, s73, v233
    s_lshl_b32 s75, s72, 13
    v_lshl_add_u32 v242, v232, 10, s75
    s_add_u32 s73, s89, 0
    s_and_b32 s73, s73, 3
    s_lshl_b32 s96, s73, 14
    s_lshr_b32 s76, s73, 1
    s_add_u32 s76, s76, 1
    s_sub_u32 s77, 0, s76
    s_bitcmp1_b32 s73, 0
    s_cselect_b32 s76, s76, s77
    v_add_u32 v243, s76, v240
    v_ashrrev_i32 v244, 6, v243
    v_add_u32 v244, s68, v244
    v_and_b32 v243, 63, v243
    v_lshl_add_u32 v243, v243, 4, v242
    v_lshl_add_u32 v243, v244, 16, v243
    v_add_u32 v243, s96, v243
    v_cmp_gt_u32 vcc, 32, v244
    s_nop 1
    v_cndmask_b32 v252, v241, v243, vcc
    s_add_u32 s73, s89, 1
    s_and_b32 s73, s73, 3
    s_lshl_b32 s97, s73, 14
    s_lshr_b32 s76, s73, 1
    s_add_u32 s76, s76, 1
    s_sub_u32 s77, 0, s76
    s_bitcmp1_b32 s73, 0
    s_cselect_b32 s76, s76, s77
    v_add_u32 v243, s76, v240
    v_ashrrev_i32 v244, 6, v243
    v_add_u32 v244, s68, v244
    v_and_b32 v243, 63, v243
    v_lshl_add_u32 v243, v243, 4, v242
    v_lshl_add_u32 v243, v244, 16, v243
    v_add_u32 v243, s97, v243
    v_cmp_gt_u32 vcc, 32, v244
    s_nop 1
    v_cndmask_b32 v253, v241, v243, vcc
    s_add_u32 s73, s89, 2
    s_and_b32 s73, s73, 3
    s_lshl_b32 s98, s73, 14
    s_lshr_b32 s76, s73, 1
    s_add_u32 s76, s76, 1
    s_sub_u32 s77, 0, s76
    s_bitcmp1_b32 s73, 0
    s_cselect_b32 s76, s76, s77
    v_add_u32 v243, s76, v240
    v_ashrrev_i32 v244, 6, v243
    v_add_u32 v244, s68, v244
    v_and_b32 v243, 63, v243
    v_lshl_add_u32 v243, v243, 4, v242
    v_lshl_add_u32 v243, v244, 16, v243
    v_add_u32 v243, s98, v243
    v_cmp_gt_u32 vcc, 32, v244
    s_nop 1
    v_cndmask_b32 v254, v241, v243, vcc
    s_add_u32 s73, s89, 3
    s_and_b32 s73, s73, 3
    s_lshl_b32 s99, s73, 14
    s_lshr_b32 s76, s73, 1
    s_add_u32 s76, s76, 1
    s_sub_u32 s77, 0, s76
    s_bitcmp1_b32 s73, 0
    s_cselect_b32 s76, s76, s77
    v_add_u32 v243, s76, v240
    v_ashrrev_i32 v244, 6, v243
    v_add_u32 v244, s68, v244
    v_and_b32 v243, 63, v243
    v_lshl_add_u32 v243, v243, 4, v242
    v_lshl_add_u32 v243, v244, 16, v243
    v_add_u32 v243, s99, v243
    v_cmp_gt_u32 vcc, 32, v244
    s_nop 1
    v_cndmask_b32 v255, v241, v243, vcc
    v_lshlrev_b32 v1, 4, v229
    v_add_u32 v1, 147456, v1
    v_lshlrev_b32 v54, 4, v228
    v_add_u32 v54, 149504, v54
    v_lshlrev_b32 v18, 4, v240
    v_add_u32 v18, 148480, v18
    s_and_b32 s73, s69, 1
    s_lshl_b32 s73, s73, 3
    s_lshl_b32 s75, s72, 2
    s_add_u32 s73, s73, s75
    s_lshr_b32 s75, s69, 1
    s_sub_u32 s75, s75, s89
    s_and_b32 s75, s75, 3
    s_lshl_b32 s75, s75, 14
    v_xor_b32 v19, s73, v229
    v_lshlrev_b32 v19, 4, v19
    v_lshl_add_u32 v19, v232, 3, v19
    v_lshl_add_u32 v19, v240, 8, v19
    v_add_u32 v19, s75, v19
    s_xor_b32 s73, s70, 2
    s_lshl_b32 s73, s73, 12
    s_add_u32 s73, s73, 147456
    v_add_u32 v23, s73, v22
    s_lshl_b32 s85, s68, 16
    s_lshl_b32 s73, s69, 2
    s_add_u32 s73, s73, s70
    s_lshl_b32 s73, s73, 11
    s_add_u32 s86, s85, s73
    s_and_b32 s73, s68, 3
    s_lshl_b32 s73, s73, 13
    s_lshl_b32 s87, s69, 18
    s_add_u32 s87, s87, s73
    s_add_u32 s87, s87, 14680064
    s_mul_i32 s88, s68, 229376
    s_add_u32 s88, s88, 6291456
    s_setprio 2
    v_add_u32 v7, 65536, v6
    s_barrier
    ds_read_b64_tr_b16 v[96:97], v7 offset:0
    ds_read_b64_tr_b16 v[98:99], v7 offset:512
    ds_read_b128 v[80:83], v2 offset:0
    ds_read_b128 v[84:87], v2 offset:4096
    ds_read_b128 v[88:91], v2 offset:8192
    ds_read_b128 v[92:95], v2 offset:12288
    ds_read_b64_tr_b16 v[116:117], v7 offset:4096
    ds_read_b64_tr_b16 v[118:119], v7 offset:4608
    ds_read_b128 v[100:103], v3 offset:0
    ds_read_b128 v[104:107], v3 offset:4096
    ds_read_b128 v[108:111], v3 offset:8192
    ds_read_b128 v[112:115], v3 offset:12288
    s_waitcnt lgkmcnt(6)
    v_mfma_f32_16x16x32_bf16 v[76:79], v[96:99], v[56:59], 0
    ds_read_b64_tr_b16 v[136:137], v7 offset:8192
    ds_read_b64_tr_b16 v[138:139], v7 offset:8704
    v_mfma_f32_16x16x32_bf16 v[60:63], v[96:99], v[80:83], 0
    ds_read_b128 v[120:123], v4 offset:0
    ds_read_b128 v[124:127], v4 offset:4096
    v_mfma_f32_16x16x32_bf16 v[64:67], v[96:99], v[84:87], 0
    ds_read_b128 v[128:131], v4 offset:8192
    ds_read_b128 v[132:135], v4 offset:12288
    v_mfma_f32_16x16x32_bf16 v[68:71], v[96:99], v[88:91], 0
    v_mfma_f32_16x16x32_bf16 v[72:75], v[96:99], v[92:95], 0
    s_waitcnt lgkmcnt(6)
    v_mfma_f32_16x16x32_bf16 v[76:79], v[116:119], v[56:59], v[76:79]
    ds_read_b64_tr_b16 v[96:97], v7 offset:12288
    ds_read_b64_tr_b16 v[98:99], v7 offset:12800
    v_mfma_f32_16x16x32_bf16 v[60:63], v[116:119], v[100:103], v[60:63]
    ds_read_b128 v[80:83], v5 offset:0
    ds_read_b128 v[84:87], v5 offset:4096
    v_mfma_f32_16x16x32_bf16 v[64:67], v[116:119], v[104:107], v[64:67]
    ds_read_b128 v[88:91], v5 offset:8192
    ds_read_b128 v[92:95], v5 offset:12288
    v_mfma_f32_16x16x32_bf16 v[68:71], v[116:119], v[108:111], v[68:71]
    v_mfma_f32_16x16x32_bf16 v[72:75], v[116:119], v[112:115], v[72:75]
    s_waitcnt lgkmcnt(6)
    v_mfma_f32_16x16x32_bf16 v[76:79], v[136:139], v[56:59], v[76:79]
    v_add_u32 v7, 81920, v6
    s_barrier
    ds_read_b64_tr_b16 v[116:117], v7 offset:0
    ds_read_b64_tr_b16 v[118:119], v7 offset:512
    v_mfma_f32_16x16x32_bf16 v[60:63], v[136:139], v[120:123], v[60:63]
    ds_read_b128 v[100:103], v2 offset:16384
    ds_read_b128 v[104:107], v2 offset:20480
    v_mfma_f32_16x16x32_bf16 v[64:67], v[136:139], v[124:127], v[64:67]
    ds_read_b128 v[108:111], v2 offset:24576
    ds_read_b128 v[112:115], v2 offset:28672
    v_mfma_f32_16x16x32_bf16 v[68:71], v[136:139], v[128:131], v[68:71]
    v_mfma_f32_16x16x32_bf16 v[72:75], v[136:139], v[132:135], v[72:75]
    s_waitcnt lgkmcnt(6)
    v_mfma_f32_16x16x32_bf16 v[76:79], v[96:99], v[56:59], v[76:79]
    ds_read_b64_tr_b16 v[136:137], v7 offset:4096
    ds_read_b64_tr_b16 v[138:139], v7 offset:4608
    v_mfma_f32_16x16x32_bf16 v[60:63], v[96:99], v[80:83], v[60:63]
    ds_read_b128 v[120:123], v3 offset:16384
    ds_read_b128 v[124:127], v3 offset:20480
    v_mfma_f32_16x16x32_bf16 v[64:67], v[96:99], v[84:87], v[64:67]
    ds_read_b128 v[128:131], v3 offset:24576
    ds_read_b128 v[132:135], v3 offset:28672
    v_mfma_f32_16x16x32_bf16 v[68:71], v[96:99], v[88:91], v[68:71]
    v_mfma_f32_16x16x32_bf16 v[72:75], v[96:99], v[92:95], v[72:75]
    s_waitcnt lgkmcnt(6)
    v_mfma_f32_16x16x32_bf16 v[76:79], v[116:119], v[56:59], v[76:79]
    ds_read_b64_tr_b16 v[96:97], v7 offset:8192
    ds_read_b64_tr_b16 v[98:99], v7 offset:8704
    v_mfma_f32_16x16x32_bf16 v[60:63], v[116:119], v[100:103], v[60:63]
    ds_read_b128 v[80:83], v4 offset:16384
    ds_read_b128 v[84:87], v4 offset:20480
    v_mfma_f32_16x16x32_bf16 v[64:67], v[116:119], v[104:107], v[64:67]
    ds_read_b128 v[88:91], v4 offset:24576
    ds_read_b128 v[92:95], v4 offset:28672
    v_mfma_f32_16x16x32_bf16 v[68:71], v[116:119], v[108:111], v[68:71]
    v_mfma_f32_16x16x32_bf16 v[72:75], v[116:119], v[112:115], v[72:75]
    s_waitcnt lgkmcnt(6)
    v_mfma_f32_16x16x32_bf16 v[76:79], v[136:139], v[56:59], v[76:79]
    ds_read_b64_tr_b16 v[116:117], v7 offset:12288
    ds_read_b64_tr_b16 v[118:119], v7 offset:12800
    v_mfma_f32_16x16x32_bf16 v[60:63], v[136:139], v[120:123], v[60:63]
    ds_read_b128 v[100:103], v5 offset:16384
    ds_read_b128 v[104:107], v5 offset:20480
    v_mfma_f32_16x16x32_bf16 v[64:67], v[136:139], v[124:127], v[64:67]
    ds_read_b128 v[108:111], v5 offset:24576
    ds_read_b128 v[112:115], v5 offset:28672
    v_mfma_f32_16x16x32_bf16 v[68:71], v[136:139], v[128:131], v[68:71]
    v_mfma_f32_16x16x32_bf16 v[72:75], v[136:139], v[132:135], v[72:75]
    s_waitcnt lgkmcnt(6)
    v_mfma_f32_16x16x32_bf16 v[76:79], v[96:99], v[56:59], v[76:79]
    v_add_u32 v7, 98304, v6
    s_barrier
    ds_read_b64_tr_b16 v[136:137], v7 offset:0
    ds_read_b64_tr_b16 v[138:139], v7 offset:512
    v_mfma_f32_16x16x32_bf16 v[60:63], v[96:99], v[80:83], v[60:63]
    ds_read_b128 v[120:123], v2 offset:32768
    ds_read_b128 v[124:127], v2 offset:36864
    v_mfma_f32_16x16x32_bf16 v[64:67], v[96:99], v[84:87], v[64:67]
    ds_read_b128 v[128:131], v2 offset:40960
    ds_read_b128 v[132:135], v2 offset:45056
    v_mfma_f32_16x16x32_bf16 v[68:71], v[96:99], v[88:91], v[68:71]
    v_mfma_f32_16x16x32_bf16 v[72:75], v[96:99], v[92:95], v[72:75]
    s_waitcnt lgkmcnt(6)
    v_mfma_f32_16x16x32_bf16 v[76:79], v[116:119], v[56:59], v[76:79]
    ds_read_b64_tr_b16 v[96:97], v7 offset:4096
    ds_read_b64_tr_b16 v[98:99], v7 offset:4608
    v_mfma_f32_16x16x32_bf16 v[60:63], v[116:119], v[100:103], v[60:63]
    ds_read_b128 v[80:83], v3 offset:32768
    ds_read_b128 v[84:87], v3 offset:36864
    v_mfma_f32_16x16x32_bf16 v[64:67], v[116:119], v[104:107], v[64:67]
    ds_read_b128 v[88:91], v3 offset:40960
    ds_read_b128 v[92:95], v3 offset:45056
    v_mfma_f32_16x16x32_bf16 v[68:71], v[116:119], v[108:111], v[68:71]
    v_mfma_f32_16x16x32_bf16 v[72:75], v[116:119], v[112:115], v[72:75]
    s_waitcnt lgkmcnt(6)
    v_mfma_f32_16x16x32_bf16 v[76:79], v[136:139], v[56:59], v[76:79]
    ds_read_b64_tr_b16 v[116:117], v7 offset:8192
    ds_read_b64_tr_b16 v[118:119], v7 offset:8704
    v_mfma_f32_16x16x32_bf16 v[60:63], v[136:139], v[120:123], v[60:63]
    ds_read_b128 v[100:103], v4 offset:32768
    ds_read_b128 v[104:107], v4 offset:36864
    v_mfma_f32_16x16x32_bf16 v[64:67], v[136:139], v[124:127], v[64:67]
    ds_read_b128 v[108:111], v4 offset:40960
    ds_read_b128 v[112:115], v4 offset:45056
    v_mfma_f32_16x16x32_bf16 v[68:71], v[136:139], v[128:131], v[68:71]
    v_mfma_f32_16x16x32_bf16 v[72:75], v[136:139], v[132:135], v[72:75]
    s_waitcnt lgkmcnt(6)
    v_mfma_f32_16x16x32_bf16 v[76:79], v[96:99], v[56:59], v[76:79]
    ds_read_b64_tr_b16 v[136:137], v7 offset:12288
    ds_read_b64_tr_b16 v[138:139], v7 offset:12800
    v_mfma_f32_16x16x32_bf16 v[60:63], v[96:99], v[80:83], v[60:63]
    ds_read_b128 v[120:123], v5 offset:32768
    ds_read_b128 v[124:127], v5 offset:36864
    v_mfma_f32_16x16x32_bf16 v[64:67], v[96:99], v[84:87], v[64:67]
    ds_read_b128 v[128:131], v5 offset:40960
    ds_read_b128 v[132:135], v5 offset:45056
    v_mfma_f32_16x16x32_bf16 v[68:71], v[96:99], v[88:91], v[68:71]
    v_mfma_f32_16x16x32_bf16 v[72:75], v[96:99], v[92:95], v[72:75]
    s_waitcnt lgkmcnt(6)
    v_mfma_f32_16x16x32_bf16 v[76:79], v[116:119], v[56:59], v[76:79]
    v_add_u32 v7, 114688, v6
    s_barrier
    ds_read_b64_tr_b16 v[96:97], v7 offset:0
    ds_read_b64_tr_b16 v[98:99], v7 offset:512
    v_mfma_f32_16x16x32_bf16 v[60:63], v[116:119], v[100:103], v[60:63]
    ds_read_b128 v[80:83], v2 offset:49152
    ds_read_b128 v[84:87], v2 offset:53248
    v_mfma_f32_16x16x32_bf16 v[64:67], v[116:119], v[104:107], v[64:67]
    ds_read_b128 v[88:91], v2 offset:57344
    ds_read_b128 v[92:95], v2 offset:61440
    v_mfma_f32_16x16x32_bf16 v[68:71], v[116:119], v[108:111], v[68:71]
    v_mfma_f32_16x16x32_bf16 v[72:75], v[116:119], v[112:115], v[72:75]
    s_waitcnt lgkmcnt(6)
    v_mfma_f32_16x16x32_bf16 v[76:79], v[136:139], v[56:59], v[76:79]
    ds_read_b64_tr_b16 v[116:117], v7 offset:4096
    ds_read_b64_tr_b16 v[118:119], v7 offset:4608
    v_mfma_f32_16x16x32_bf16 v[60:63], v[136:139], v[120:123], v[60:63]
    ds_read_b128 v[100:103], v3 offset:49152
    ds_read_b128 v[104:107], v3 offset:53248
    v_mfma_f32_16x16x32_bf16 v[64:67], v[136:139], v[124:127], v[64:67]
    ds_read_b128 v[108:111], v3 offset:57344
    ds_read_b128 v[112:115], v3 offset:61440
    v_mfma_f32_16x16x32_bf16 v[68:71], v[136:139], v[128:131], v[68:71]
    v_mfma_f32_16x16x32_bf16 v[72:75], v[136:139], v[132:135], v[72:75]
    s_waitcnt lgkmcnt(6)
    v_mfma_f32_16x16x32_bf16 v[76:79], v[96:99], v[56:59], v[76:79]
    ds_read_b64_tr_b16 v[136:137], v7 offset:8192
    ds_read_b64_tr_b16 v[138:139], v7 offset:8704
    v_mfma_f32_16x16x32_bf16 v[60:63], v[96:99], v[80:83], v[60:63]
    ds_read_b128 v[120:123], v4 offset:49152
    ds_read_b128 v[124:127], v4 offset:53248
    v_mfma_f32_16x16x32_bf16 v[64:67], v[96:99], v[84:87], v[64:67]
    ds_read_b128 v[128:131], v4 offset:57344
    ds_read_b128 v[132:135], v4 offset:61440
    v_mfma_f32_16x16x32_bf16 v[68:71], v[96:99], v[88:91], v[68:71]
    v_mfma_f32_16x16x32_bf16 v[72:75], v[96:99], v[92:95], v[72:75]
    s_waitcnt lgkmcnt(6)
    v_mfma_f32_16x16x32_bf16 v[76:79], v[116:119], v[56:59], v[76:79]
    ds_read_b64_tr_b16 v[96:97], v7 offset:12288
    ds_read_b64_tr_b16 v[98:99], v7 offset:12800
    v_mfma_f32_16x16x32_bf16 v[60:63], v[116:119], v[100:103], v[60:63]
    ds_read_b128 v[80:83], v5 offset:49152
    ds_read_b128 v[84:87], v5 offset:53248
    v_mfma_f32_16x16x32_bf16 v[64:67], v[116:119], v[104:107], v[64:67]
    ds_read_b128 v[88:91], v5 offset:57344
    ds_read_b128 v[92:95], v5 offset:61440
    v_mfma_f32_16x16x32_bf16 v[68:71], v[116:119], v[108:111], v[68:71]
    v_mfma_f32_16x16x32_bf16 v[72:75], v[116:119], v[112:115], v[72:75]
    s_waitcnt lgkmcnt(6)
    v_mfma_f32_16x16x32_bf16 v[76:79], v[136:139], v[56:59], v[76:79]
    v_mfma_f32_16x16x32_bf16 v[60:63], v[136:139], v[120:123], v[60:63]
    v_mfma_f32_16x16x32_bf16 v[64:67], v[136:139], v[124:127], v[64:67]
    v_mfma_f32_16x16x32_bf16 v[68:71], v[136:139], v[128:131], v[68:71]
    v_mfma_f32_16x16x32_bf16 v[72:75], v[136:139], v[132:135], v[72:75]
    s_waitcnt lgkmcnt(0)
    v_mfma_f32_16x16x32_bf16 v[76:79], v[96:99], v[56:59], v[76:79]
    v_mfma_f32_16x16x32_bf16 v[60:63], v[96:99], v[80:83], v[60:63]
    v_mfma_f32_16x16x32_bf16 v[64:67], v[96:99], v[84:87], v[64:67]
    v_mfma_f32_16x16x32_bf16 v[68:71], v[96:99], v[88:91], v[68:71]
    v_mfma_f32_16x16x32_bf16 v[72:75], v[96:99], v[92:95], v[72:75]
    v_add_u32 v7, 131072, v6
    s_barrier
    ds_read_b128 v[228:231], v1 offset:0
    ds_read_b128 v[232:235], v1 offset:256
    ds_read_b128 v[236:239], v1 offset:512
    ds_read_b128 v[240:243], v1 offset:768
    ds_read_b64_tr_b16 v[196:197], v7 offset:0
    ds_read_b64_tr_b16 v[198:199], v7 offset:512
    ds_read_b128 v[180:183], v2 offset:0
    ds_read_b64_tr_b16 v[200:201], v7 offset:8192
    ds_read_b64_tr_b16 v[202:203], v7 offset:8704
    ds_read_b128 v[184:187], v2 offset:4096
    ds_read_b128 v[188:191], v2 offset:8192
    ds_read_b128 v[192:195], v2 offset:12288
    s_waitcnt lgkmcnt(8)
    s_nop 0
    v_pk_fma_f32 v[60:61], v[76:77], v[228:229], v[60:61] op_sel:[0,0,0] op_sel_hi:[1,0,1]
    v_pk_fma_f32 v[62:63], v[78:79], v[228:229], v[62:63] op_sel:[0,0,0] op_sel_hi:[1,0,1]
    v_pk_fma_f32 v[64:65], v[76:77], v[232:233], v[64:65] op_sel:[0,0,0] op_sel_hi:[1,0,1]
    v_pk_fma_f32 v[66:67], v[78:79], v[232:233], v[66:67] op_sel:[0,0,0] op_sel_hi:[1,0,1]
    v_pk_fma_f32 v[68:69], v[76:77], v[236:237], v[68:69] op_sel:[0,0,0] op_sel_hi:[1,0,1]
    v_pk_fma_f32 v[70:71], v[78:79], v[236:237], v[70:71] op_sel:[0,0,0] op_sel_hi:[1,0,1]
    v_pk_fma_f32 v[72:73], v[76:77], v[240:241], v[72:73] op_sel:[0,0,0] op_sel_hi:[1,0,1]
    v_pk_fma_f32 v[74:75], v[78:79], v[240:241], v[74:75] op_sel:[0,0,0] op_sel_hi:[1,0,1]
    v_pk_mul_f32 v[100:101], v[60:61], v[60:61]
    v_pk_mul_f32 v[102:103], v[62:63], v[62:63]
    v_pk_mul_f32 v[104:105], v[64:65], v[64:65]
    v_pk_mul_f32 v[106:107], v[66:67], v[66:67]
    v_pk_mul_f32 v[108:109], v[68:69], v[68:69]
    v_pk_mul_f32 v[110:111], v[70:71], v[70:71]
    v_pk_mul_f32 v[112:113], v[72:73], v[72:73]
    v_pk_mul_f32 v[114:115], v[74:75], v[74:75]
    v_pk_fma_f32 v[100:101], v[100:101], v[230:231], v[228:229] op_sel:[0,0,1] op_sel_hi:[1,0,1]
    v_pk_fma_f32 v[102:103], v[102:103], v[230:231], v[228:229] op_sel:[0,0,1] op_sel_hi:[1,0,1]
    v_pk_fma_f32 v[104:105], v[104:105], v[234:235], v[232:233] op_sel:[0,0,1] op_sel_hi:[1,0,1]
    v_pk_fma_f32 v[106:107], v[106:107], v[234:235], v[232:233] op_sel:[0,0,1] op_sel_hi:[1,0,1]
    v_pk_fma_f32 v[108:109], v[108:109], v[238:239], v[236:237] op_sel:[0,0,1] op_sel_hi:[1,0,1]
    v_pk_fma_f32 v[110:111], v[110:111], v[238:239], v[236:237] op_sel:[0,0,1] op_sel_hi:[1,0,1]
    v_pk_fma_f32 v[112:113], v[112:113], v[242:243], v[240:241] op_sel:[0,0,1] op_sel_hi:[1,0,1]
    v_pk_fma_f32 v[114:115], v[114:115], v[242:243], v[240:241] op_sel:[0,0,1] op_sel_hi:[1,0,1]
    v_pk_mul_f32 v[100:101], v[100:101], v[60:61]
    v_pk_mul_f32 v[102:103], v[102:103], v[62:63]
    v_pk_mul_f32 v[104:105], v[104:105], v[64:65]
    v_pk_mul_f32 v[106:107], v[106:107], v[66:67]
    v_pk_mul_f32 v[108:109], v[108:109], v[68:69]
    v_pk_mul_f32 v[110:111], v[110:111], v[70:71]
    v_pk_mul_f32 v[112:113], v[112:113], v[72:73]
    v_pk_mul_f32 v[114:115], v[114:115], v[74:75]
    v_exp_f32_e64 v100, v100
    v_exp_f32_e64 v101, v101
    v_exp_f32_e64 v102, v102
    v_exp_f32_e64 v103, v103
    v_exp_f32_e64 v104, v104
    v_exp_f32_e64 v105, v105
    v_exp_f32_e64 v106, v106
    v_exp_f32_e64 v107, v107
    v_exp_f32_e64 v108, v108
    v_exp_f32_e64 v109, v109
    v_exp_f32_e64 v110, v110
    v_exp_f32_e64 v111, v111
    v_exp_f32_e64 v112, v112
    v_exp_f32_e64 v113, v113
    v_exp_f32_e64 v114, v114
    v_exp_f32_e64 v115, v115
    v_pk_fma_f32 v[100:101], v[100:101], v[230:231], v[230:231] op_sel:[0,1,1] op_sel_hi:[1,1,1]
    v_pk_fma_f32 v[102:103], v[102:103], v[230:231], v[230:231] op_sel:[0,1,1] op_sel_hi:[1,1,1]
    v_pk_fma_f32 v[104:105], v[104:105], v[234:235], v[234:235] op_sel:[0,1,1] op_sel_hi:[1,1,1]
    v_pk_fma_f32 v[106:107], v[106:107], v[234:235], v[234:235] op_sel:[0,1,1] op_sel_hi:[1,1,1]
    v_pk_fma_f32 v[108:109], v[108:109], v[238:239], v[238:239] op_sel:[0,1,1] op_sel_hi:[1,1,1]
    v_pk_fma_f32 v[110:111], v[110:111], v[238:239], v[238:239] op_sel:[0,1,1] op_sel_hi:[1,1,1]
    v_pk_fma_f32 v[112:113], v[112:113], v[242:243], v[242:243] op_sel:[0,1,1] op_sel_hi:[1,1,1]
    v_pk_fma_f32 v[114:115], v[114:115], v[242:243], v[242:243] op_sel:[0,1,1] op_sel_hi:[1,1,1]
    v_rcp_f32_e64 v100, v100
    v_rcp_f32_e64 v101, v101
    v_rcp_f32_e64 v102, v102
    v_rcp_f32_e64 v103, v103
    v_rcp_f32_e64 v104, v104
    v_rcp_f32_e64 v105, v105
    v_rcp_f32_e64 v106, v106
    v_rcp_f32_e64 v107, v107
    v_rcp_f32_e64 v108, v108
    v_rcp_f32_e64 v109, v109
    v_rcp_f32_e64 v110, v110
    v_rcp_f32_e64 v111, v111
    v_rcp_f32_e64 v112, v112
    v_rcp_f32_e64 v113, v113
    v_rcp_f32_e64 v114, v114
    v_rcp_f32_e64 v115, v115
    v_pk_mul_f32 v[100:101], v[100:101], v[60:61]
    v_pk_mul_f32 v[102:103], v[102:103], v[62:63]
    v_pk_mul_f32 v[104:105], v[104:105], v[64:65]
    v_pk_mul_f32 v[106:107], v[106:107], v[66:67]
    v_pk_mul_f32 v[108:109], v[108:109], v[68:69]
    v_pk_mul_f32 v[110:111], v[110:111], v[70:71]
    v_pk_mul_f32 v[112:113], v[112:113], v[72:73]
    v_pk_mul_f32 v[114:115], v[114:115], v[74:75]
    v_cvt_pk_bf16_f32 v116, v100, v101
    v_cvt_pk_bf16_f32 v117, v102, v103
    v_cvt_pk_bf16_f32 v118, v104, v105
    v_cvt_pk_bf16_f32 v119, v106, v107
    v_cvt_pk_bf16_f32 v120, v108, v109
    v_cvt_pk_bf16_f32 v121, v110, v111
    v_cvt_pk_bf16_f32 v122, v112, v113
    v_cvt_pk_bf16_f32 v123, v114, v115
    v_permlane16_swap_b32 v116, v118
    v_permlane16_swap_b32 v117, v119
    buffer_store_dwordx4 v[116:119], v20, s[60:63], s86 offen offset:0 sc1
    v_permlane16_swap_b32 v120, v122
    v_permlane16_swap_b32 v121, v123
    buffer_store_dwordx4 v[120:123], v20, s[60:63], s86 offen offset:512 sc1
    s_waitcnt lgkmcnt(0)
    s_nop 0
    v_mfma_f32_16x16x32_bf16 v[172:175], v[56:59], v[196:199], 0
    ds_read_b64_tr_b16 v[220:221], v7 offset:4096
    v_mfma_f32_16x16x32_bf16 v[176:179], v[56:59], v[200:203], 0
    ds_read_b64_tr_b16 v[222:223], v7 offset:4608
    v_mfma_f32_16x16x32_bf16 v[140:143], v[180:183], v[196:199], 0
    ds_read_b128 v[204:207], v3 offset:0
    v_mfma_f32_16x16x32_bf16 v[156:159], v[180:183], v[200:203], 0
    ds_read_b64_tr_b16 v[224:225], v7 offset:12288
    v_mfma_f32_16x16x32_bf16 v[144:147], v[184:187], v[196:199], 0
    ds_read_b64_tr_b16 v[226:227], v7 offset:12800
    v_mfma_f32_16x16x32_bf16 v[160:163], v[184:187], v[200:203], 0
    ds_read_b128 v[208:211], v3 offset:4096
    v_mfma_f32_16x16x32_bf16 v[148:151], v[188:191], v[196:199], 0
    ds_read_b128 v[212:215], v3 offset:8192
    v_mfma_f32_16x16x32_bf16 v[164:167], v[188:191], v[200:203], 0
    ds_read_b128 v[216:219], v3 offset:12288
    v_mfma_f32_16x16x32_bf16 v[152:155], v[192:195], v[196:199], 0
    v_mfma_f32_16x16x32_bf16 v[168:171], v[192:195], v[200:203], 0
    s_waitcnt lgkmcnt(3)
    v_mfma_f32_16x16x32_bf16 v[172:175], v[56:59], v[220:223], v[172:175]
    v_add_u32 v7, 65536, v6
    s_barrier
    ds_read_b64_tr_b16 v[196:197], v7 offset:0
    v_mfma_f32_16x16x32_bf16 v[176:179], v[56:59], v[224:227], v[176:179]
    ds_read_b64_tr_b16 v[198:199], v7 offset:512
    v_mfma_f32_16x16x32_bf16 v[140:143], v[204:207], v[220:223], v[140:143]
    ds_read_b128 v[180:183], v4 offset:0
    v_mfma_f32_16x16x32_bf16 v[156:159], v[204:207], v[224:227], v[156:159]
    ds_read_b64_tr_b16 v[200:201], v7 offset:8192
    s_waitcnt lgkmcnt(4)
    v_mfma_f32_16x16x32_bf16 v[144:147], v[208:211], v[220:223], v[144:147]
    ds_read_b64_tr_b16 v[202:203], v7 offset:8704
    v_mfma_f32_16x16x32_bf16 v[160:163], v[208:211], v[224:227], v[160:163]
    ds_read_b128 v[184:187], v4 offset:4096
    v_mfma_f32_16x16x32_bf16 v[148:151], v[212:215], v[220:223], v[148:151]
    ds_read_b128 v[188:191], v4 offset:8192
    v_mfma_f32_16x16x32_bf16 v[164:167], v[212:215], v[224:227], v[164:167]
    ds_read_b128 v[192:195], v4 offset:12288
    v_mfma_f32_16x16x32_bf16 v[152:155], v[216:219], v[220:223], v[152:155]
    v_mfma_f32_16x16x32_bf16 v[168:171], v[216:219], v[224:227], v[168:171]
    s_waitcnt lgkmcnt(3)
    v_mfma_f32_16x16x32_bf16 v[172:175], v[56:59], v[196:199], v[172:175]
    ds_read_b64_tr_b16 v[220:221], v7 offset:4096
    v_mfma_f32_16x16x32_bf16 v[176:179], v[56:59], v[200:203], v[176:179]
    ds_read_b64_tr_b16 v[222:223], v7 offset:4608
    v_mfma_f32_16x16x32_bf16 v[140:143], v[180:183], v[196:199], v[140:143]
    ds_read_b128 v[204:207], v5 offset:0
    v_mfma_f32_16x16x32_bf16 v[156:159], v[180:183], v[200:203], v[156:159]
    ds_read_b64_tr_b16 v[224:225], v7 offset:12288
    s_waitcnt lgkmcnt(4)
    v_mfma_f32_16x16x32_bf16 v[144:147], v[184:187], v[196:199], v[144:147]
    ds_read_b64_tr_b16 v[226:227], v7 offset:12800
    v_mfma_f32_16x16x32_bf16 v[160:163], v[184:187], v[200:203], v[160:163]
    ds_read_b128 v[208:211], v5 offset:4096
    v_mfma_f32_16x16x32_bf16 v[148:151], v[188:191], v[196:199], v[148:151]
    ds_read_b128 v[212:215], v5 offset:8192
    v_mfma_f32_16x16x32_bf16 v[164:167], v[188:191], v[200:203], v[164:167]
    ds_read_b128 v[216:219], v5 offset:12288
    v_mfma_f32_16x16x32_bf16 v[152:155], v[192:195], v[196:199], v[152:155]
    v_mfma_f32_16x16x32_bf16 v[168:171], v[192:195], v[200:203], v[168:171]
    s_waitcnt lgkmcnt(3)
    v_mfma_f32_16x16x32_bf16 v[172:175], v[56:59], v[220:223], v[172:175]
    v_add_u32 v7, 81920, v6
    s_waitcnt vmcnt(0)
    s_barrier
    ds_read_b64_tr_b16 v[196:197], v7 offset:0
    v_mfma_f32_16x16x32_bf16 v[176:179], v[56:59], v[224:227], v[176:179]
    ds_read_b64_tr_b16 v[198:199], v7 offset:512
    v_mfma_f32_16x16x32_bf16 v[140:143], v[204:207], v[220:223], v[140:143]
    ds_read_b128 v[180:183], v2 offset:16384
    v_mfma_f32_16x16x32_bf16 v[156:159], v[204:207], v[224:227], v[156:159]
    ds_read_b64_tr_b16 v[200:201], v7 offset:8192
    s_waitcnt lgkmcnt(4)
    v_mfma_f32_16x16x32_bf16 v[144:147], v[208:211], v[220:223], v[144:147]
    ds_read_b64_tr_b16 v[202:203], v7 offset:8704
    v_mfma_f32_16x16x32_bf16 v[160:163], v[208:211], v[224:227], v[160:163]
    ds_read_b128 v[184:187], v2 offset:20480
    v_mfma_f32_16x16x32_bf16 v[148:151], v[212:215], v[220:223], v[148:151]
    ds_read_b128 v[188:191], v2 offset:24576
    v_mfma_f32_16x16x32_bf16 v[164:167], v[212:215], v[224:227], v[164:167]
    ds_read_b128 v[192:195], v2 offset:28672
    v_mfma_f32_16x16x32_bf16 v[152:155], v[216:219], v[220:223], v[152:155]
    v_mfma_f32_16x16x32_bf16 v[168:171], v[216:219], v[224:227], v[168:171]
    s_waitcnt lgkmcnt(3)
    v_mfma_f32_16x16x32_bf16 v[172:175], v[56:59], v[196:199], v[172:175]
    ds_read_b64_tr_b16 v[220:221], v7 offset:4096
    v_mfma_f32_16x16x32_bf16 v[176:179], v[56:59], v[200:203], v[176:179]
    ds_read_b64_tr_b16 v[222:223], v7 offset:4608
    v_mfma_f32_16x16x32_bf16 v[140:143], v[180:183], v[196:199], v[140:143]
    ds_read_b128 v[204:207], v3 offset:16384
    v_mfma_f32_16x16x32_bf16 v[156:159], v[180:183], v[200:203], v[156:159]
    ds_read_b64_tr_b16 v[224:225], v7 offset:12288
    s_waitcnt lgkmcnt(4)
    v_mfma_f32_16x16x32_bf16 v[144:147], v[184:187], v[196:199], v[144:147]
    ds_read_b64_tr_b16 v[226:227], v7 offset:12800
    v_mfma_f32_16x16x32_bf16 v[160:163], v[184:187], v[200:203], v[160:163]
    ds_read_b128 v[208:211], v3 offset:20480
    v_mfma_f32_16x16x32_bf16 v[148:151], v[188:191], v[196:199], v[148:151]
    ds_read_b128 v[212:215], v3 offset:24576
    v_mfma_f32_16x16x32_bf16 v[164:167], v[188:191], v[200:203], v[164:167]
    ds_read_b128 v[216:219], v3 offset:28672
    v_mfma_f32_16x16x32_bf16 v[152:155], v[192:195], v[196:199], v[152:155]
    v_mfma_f32_16x16x32_bf16 v[168:171], v[192:195], v[200:203], v[168:171]
    s_waitcnt lgkmcnt(3)
    v_mfma_f32_16x16x32_bf16 v[172:175], v[56:59], v[220:223], v[172:175]
    v_add_u32 v7, 98304, v6
    s_barrier
    ds_read_b64_tr_b16 v[196:197], v7 offset:0
    v_mfma_f32_16x16x32_bf16 v[176:179], v[56:59], v[224:227], v[176:179]
    ds_read_b64_tr_b16 v[198:199], v7 offset:512
    v_mfma_f32_16x16x32_bf16 v[140:143], v[204:207], v[220:223], v[140:143]
    ds_read_b128 v[180:183], v4 offset:16384
    v_mfma_f32_16x16x32_bf16 v[156:159], v[204:207], v[224:227], v[156:159]
    ds_read_b64_tr_b16 v[200:201], v7 offset:8192
    s_waitcnt lgkmcnt(4)
    v_mfma_f32_16x16x32_bf16 v[144:147], v[208:211], v[220:223], v[144:147]
    ds_read_b64_tr_b16 v[202:203], v7 offset:8704
    v_mfma_f32_16x16x32_bf16 v[160:163], v[208:211], v[224:227], v[160:163]
    ds_read_b128 v[184:187], v4 offset:20480
    v_mfma_f32_16x16x32_bf16 v[148:151], v[212:215], v[220:223], v[148:151]
    ds_read_b128 v[188:191], v4 offset:24576
    v_mfma_f32_16x16x32_bf16 v[164:167], v[212:215], v[224:227], v[164:167]
    ds_read_b128 v[192:195], v4 offset:28672
    v_mfma_f32_16x16x32_bf16 v[152:155], v[216:219], v[220:223], v[152:155]
    v_mfma_f32_16x16x32_bf16 v[168:171], v[216:219], v[224:227], v[168:171]
    s_waitcnt lgkmcnt(3)
    v_mfma_f32_16x16x32_bf16 v[172:175], v[56:59], v[196:199], v[172:175]
    ds_read_b64_tr_b16 v[220:221], v7 offset:4096
    v_mfma_f32_16x16x32_bf16 v[176:179], v[56:59], v[200:203], v[176:179]
    ds_read_b64_tr_b16 v[222:223], v7 offset:4608
    v_mfma_f32_16x16x32_bf16 v[140:143], v[180:183], v[196:199], v[140:143]
    ds_read_b128 v[204:207], v5 offset:16384
    v_mfma_f32_16x16x32_bf16 v[156:159], v[180:183], v[200:203], v[156:159]
    ds_read_b64_tr_b16 v[224:225], v7 offset:12288
    s_waitcnt lgkmcnt(4)
    v_mfma_f32_16x16x32_bf16 v[144:147], v[184:187], v[196:199], v[144:147]
    ds_read_b64_tr_b16 v[226:227], v7 offset:12800
    v_mfma_f32_16x16x32_bf16 v[160:163], v[184:187], v[200:203], v[160:163]
    ds_read_b128 v[208:211], v5 offset:20480
    v_mfma_f32_16x16x32_bf16 v[148:151], v[188:191], v[196:199], v[148:151]
    ds_read_b128 v[212:215], v5 offset:24576
    v_mfma_f32_16x16x32_bf16 v[164:167], v[188:191], v[200:203], v[164:167]
    ds_read_b128 v[216:219], v5 offset:28672
    v_mfma_f32_16x16x32_bf16 v[152:155], v[192:195], v[196:199], v[152:155]
    v_mfma_f32_16x16x32_bf16 v[168:171], v[192:195], v[200:203], v[168:171]
    s_waitcnt lgkmcnt(3)
    v_mfma_f32_16x16x32_bf16 v[172:175], v[56:59], v[220:223], v[172:175]
    v_add_u32 v7, 114688, v6
    s_barrier
    ds_read_b64_tr_b16 v[196:197], v7 offset:0
    v_mfma_f32_16x16x32_bf16 v[176:179], v[56:59], v[224:227], v[176:179]
    ds_read_b64_tr_b16 v[198:199], v7 offset:512
    v_mfma_f32_16x16x32_bf16 v[140:143], v[204:207], v[220:223], v[140:143]
    ds_read_b128 v[180:183], v2 offset:32768
    v_mfma_f32_16x16x32_bf16 v[156:159], v[204:207], v[224:227], v[156:159]
    ds_read_b64_tr_b16 v[200:201], v7 offset:8192
    s_waitcnt lgkmcnt(4)
    v_mfma_f32_16x16x32_bf16 v[144:147], v[208:211], v[220:223], v[144:147]
    ds_read_b64_tr_b16 v[202:203], v7 offset:8704
    v_mfma_f32_16x16x32_bf16 v[160:163], v[208:211], v[224:227], v[160:163]
    ds_read_b128 v[184:187], v2 offset:36864
    v_mfma_f32_16x16x32_bf16 v[148:151], v[212:215], v[220:223], v[148:151]
    ds_read_b128 v[188:191], v2 offset:40960
    v_mfma_f32_16x16x32_bf16 v[164:167], v[212:215], v[224:227], v[164:167]
    ds_read_b128 v[192:195], v2 offset:45056
    v_mfma_f32_16x16x32_bf16 v[152:155], v[216:219], v[220:223], v[152:155]
    v_mfma_f32_16x16x32_bf16 v[168:171], v[216:219], v[224:227], v[168:171]
    s_waitcnt lgkmcnt(3)
    v_mfma_f32_16x16x32_bf16 v[172:175], v[56:59], v[196:199], v[172:175]
    ds_read_b64_tr_b16 v[220:221], v7 offset:4096
    v_mfma_f32_16x16x32_bf16 v[176:179], v[56:59], v[200:203], v[176:179]
    ds_read_b64_tr_b16 v[222:223], v7 offset:4608
    v_mfma_f32_16x16x32_bf16 v[140:143], v[180:183], v[196:199], v[140:143]
    ds_read_b128 v[204:207], v3 offset:32768
    v_mfma_f32_16x16x32_bf16 v[156:159], v[180:183], v[200:203], v[156:159]
    ds_read_b64_tr_b16 v[224:225], v7 offset:12288
    s_waitcnt lgkmcnt(4)
    v_mfma_f32_16x16x32_bf16 v[144:147], v[184:187], v[196:199], v[144:147]
    ds_read_b64_tr_b16 v[226:227], v7 offset:12800
    v_mfma_f32_16x16x32_bf16 v[160:163], v[184:187], v[200:203], v[160:163]
    ds_read_b128 v[208:211], v3 offset:36864
    v_mfma_f32_16x16x32_bf16 v[148:151], v[188:191], v[196:199], v[148:151]
    ds_read_b128 v[212:215], v3 offset:40960
    v_mfma_f32_16x16x32_bf16 v[164:167], v[188:191], v[200:203], v[164:167]
    ds_read_b128 v[216:219], v3 offset:45056
    v_mfma_f32_16x16x32_bf16 v[152:155], v[192:195], v[196:199], v[152:155]
    v_mfma_f32_16x16x32_bf16 v[168:171], v[192:195], v[200:203], v[168:171]
    s_waitcnt lgkmcnt(3)
    v_mfma_f32_16x16x32_bf16 v[172:175], v[56:59], v[220:223], v[172:175]
    v_add_u32 v7, 131072, v6
    s_barrier
    ds_read_b64_tr_b16 v[196:197], v7 offset:0
    v_mfma_f32_16x16x32_bf16 v[176:179], v[56:59], v[224:227], v[176:179]
    ds_read_b64_tr_b16 v[198:199], v7 offset:512
    v_mfma_f32_16x16x32_bf16 v[140:143], v[204:207], v[220:223], v[140:143]
    ds_read_b128 v[180:183], v4 offset:32768
    v_mfma_f32_16x16x32_bf16 v[156:159], v[204:207], v[224:227], v[156:159]
    ds_read_b64_tr_b16 v[200:201], v7 offset:8192
    s_waitcnt lgkmcnt(4)
    v_mfma_f32_16x16x32_bf16 v[144:147], v[208:211], v[220:223], v[144:147]
    ds_read_b64_tr_b16 v[202:203], v7 offset:8704
    v_mfma_f32_16x16x32_bf16 v[160:163], v[208:211], v[224:227], v[160:163]
    ds_read_b128 v[184:187], v4 offset:36864
    v_mfma_f32_16x16x32_bf16 v[148:151], v[212:215], v[220:223], v[148:151]
    ds_read_b128 v[188:191], v4 offset:40960
    v_mfma_f32_16x16x32_bf16 v[164:167], v[212:215], v[224:227], v[164:167]
    ds_read_b128 v[192:195], v4 offset:45056
    v_mfma_f32_16x16x32_bf16 v[152:155], v[216:219], v[220:223], v[152:155]
    v_mfma_f32_16x16x32_bf16 v[168:171], v[216:219], v[224:227], v[168:171]
    s_waitcnt lgkmcnt(3)
    v_mfma_f32_16x16x32_bf16 v[172:175], v[56:59], v[196:199], v[172:175]
    ds_read_b64_tr_b16 v[220:221], v7 offset:4096
    v_mfma_f32_16x16x32_bf16 v[176:179], v[56:59], v[200:203], v[176:179]
    ds_read_b64_tr_b16 v[222:223], v7 offset:4608
    v_mfma_f32_16x16x32_bf16 v[140:143], v[180:183], v[196:199], v[140:143]
    ds_read_b128 v[204:207], v5 offset:32768
    v_mfma_f32_16x16x32_bf16 v[156:159], v[180:183], v[200:203], v[156:159]
    ds_read_b64_tr_b16 v[224:225], v7 offset:12288
    s_waitcnt lgkmcnt(4)
    v_mfma_f32_16x16x32_bf16 v[144:147], v[184:187], v[196:199], v[144:147]
    ds_read_b64_tr_b16 v[226:227], v7 offset:12800
    v_mfma_f32_16x16x32_bf16 v[160:163], v[184:187], v[200:203], v[160:163]
    ds_read_b128 v[208:211], v5 offset:36864
    v_mfma_f32_16x16x32_bf16 v[148:151], v[188:191], v[196:199], v[148:151]
    ds_read_b128 v[212:215], v5 offset:40960
    v_mfma_f32_16x16x32_bf16 v[164:167], v[188:191], v[200:203], v[164:167]
    ds_read_b128 v[216:219], v5 offset:45056
    v_mfma_f32_16x16x32_bf16 v[152:155], v[192:195], v[196:199], v[152:155]
    v_mfma_f32_16x16x32_bf16 v[168:171], v[192:195], v[200:203], v[168:171]
    s_waitcnt lgkmcnt(3)
    v_mfma_f32_16x16x32_bf16 v[172:175], v[56:59], v[220:223], v[172:175]
    v_add_u32 v7, 65536, v6
    s_barrier
    v_xor_b32 v236, 16, v19
    v_xor_b32 v237, 32, v19
    v_xor_b32 v238, 48, v19
    ds_read_b64 v[228:229], v19
    ds_read_b64 v[230:231], v236
    ds_read_b64 v[232:233], v237
    ds_read_b64 v[234:235], v238
    ds_read_b64 v[240:241], v18
    ds_read_b64_tr_b16 v[196:197], v7 offset:0
    v_mfma_f32_16x16x32_bf16 v[176:179], v[56:59], v[224:227], v[176:179]
    ds_read_b64_tr_b16 v[198:199], v7 offset:512
    v_mfma_f32_16x16x32_bf16 v[140:143], v[204:207], v[220:223], v[140:143]
    ds_read_b128 v[180:183], v2 offset:49152
    v_mfma_f32_16x16x32_bf16 v[156:159], v[204:207], v[224:227], v[156:159]
    ds_read_b64_tr_b16 v[200:201], v7 offset:8192
    s_waitcnt lgkmcnt(9)
    v_mfma_f32_16x16x32_bf16 v[144:147], v[208:211], v[220:223], v[144:147]
    ds_read_b64_tr_b16 v[202:203], v7 offset:8704
    v_mfma_f32_16x16x32_bf16 v[160:163], v[208:211], v[224:227], v[160:163]
    ds_read_b128 v[184:187], v2 offset:53248
    v_mfma_f32_16x16x32_bf16 v[148:151], v[212:215], v[220:223], v[148:151]
    ds_read_b128 v[188:191], v2 offset:57344
    v_mfma_f32_16x16x32_bf16 v[164:167], v[212:215], v[224:227], v[164:167]
    ds_read_b128 v[192:195], v2 offset:61440
    v_mfma_f32_16x16x32_bf16 v[152:155], v[216:219], v[220:223], v[152:155]
    v_mfma_f32_16x16x32_bf16 v[168:171], v[216:219], v[224:227], v[168:171]
    s_waitcnt lgkmcnt(3)
    v_mfma_f32_16x16x32_bf16 v[172:175], v[56:59], v[196:199], v[172:175]
    ds_read_b64_tr_b16 v[220:221], v7 offset:4096
    v_mfma_f32_16x16x32_bf16 v[176:179], v[56:59], v[200:203], v[176:179]
    ds_read_b64_tr_b16 v[222:223], v7 offset:4608
    v_mfma_f32_16x16x32_bf16 v[140:143], v[180:183], v[196:199], v[140:143]
    ds_read_b128 v[204:207], v3 offset:49152
    v_mfma_f32_16x16x32_bf16 v[156:159], v[180:183], v[200:203], v[156:159]
    ds_read_b64_tr_b16 v[224:225], v7 offset:12288
    s_waitcnt lgkmcnt(4)
    v_mfma_f32_16x16x32_bf16 v[144:147], v[184:187], v[196:199], v[144:147]
    ds_read_b64_tr_b16 v[226:227], v7 offset:12800
    v_mfma_f32_16x16x32_bf16 v[160:163], v[184:187], v[200:203], v[160:163]
    ds_read_b128 v[208:211], v3 offset:53248
    v_mfma_f32_16x16x32_bf16 v[148:151], v[188:191], v[196:199], v[148:151]
    ds_read_b128 v[212:215], v3 offset:57344
    v_mfma_f32_16x16x32_bf16 v[164:167], v[188:191], v[200:203], v[164:167]
    ds_read_b128 v[216:219], v3 offset:61440
    v_mfma_f32_16x16x32_bf16 v[152:155], v[192:195], v[196:199], v[152:155]
    v_mfma_f32_16x16x32_bf16 v[168:171], v[192:195], v[200:203], v[168:171]
    s_waitcnt lgkmcnt(3)
    v_mfma_f32_16x16x32_bf16 v[172:175], v[56:59], v[220:223], v[172:175]
    v_add_u32 v7, 81920, v6
    v_lshlrev_b32 v24, 16, v228
    v_and_b32 v25, 0xffff0000, v228
    v_lshlrev_b32 v26, 16, v229
    v_and_b32 v27, 0xffff0000, v229
    v_lshlrev_b32 v28, 16, v230
    v_and_b32 v29, 0xffff0000, v230
    v_lshlrev_b32 v30, 16, v231
    v_and_b32 v31, 0xffff0000, v231
    v_lshlrev_b32 v32, 16, v232
    v_and_b32 v33, 0xffff0000, v232
    v_lshlrev_b32 v34, 16, v233
    v_and_b32 v35, 0xffff0000, v233
    v_lshlrev_b32 v36, 16, v234
    v_and_b32 v37, 0xffff0000, v234
    v_lshlrev_b32 v38, 16, v235
    v_and_b32 v39, 0xffff0000, v235
    v_mul_f32 v240, v240, v241
    v_fma_f32 v124, v24, v241, v240
    v_fma_f32 v125, v25, v241, v240
    v_fma_f32 v126, v26, v241, v240
    v_fma_f32 v127, v27, v241, v240
    v_fma_f32 v128, v28, v241, v240
    v_fma_f32 v129, v29, v241, v240
    v_fma_f32 v130, v30, v241, v240
    v_fma_f32 v131, v31, v241, v240
    v_fma_f32 v132, v32, v241, v240
    v_fma_f32 v133, v33, v241, v240
    v_fma_f32 v134, v34, v241, v240
    v_fma_f32 v135, v35, v241, v240
    v_fma_f32 v136, v36, v241, v240
    v_fma_f32 v137, v37, v241, v240
    v_fma_f32 v138, v38, v241, v240
    v_fma_f32 v139, v39, v241, v240
    s_barrier
    ds_read_b64_tr_b16 v[196:197], v7 offset:0
    v_mfma_f32_16x16x32_bf16 v[176:179], v[56:59], v[224:227], v[176:179]
    ds_read_b64_tr_b16 v[198:199], v7 offset:512
    v_mfma_f32_16x16x32_bf16 v[140:143], v[204:207], v[220:223], v[140:143]
    ds_read_b128 v[180:183], v4 offset:49152
    v_mfma_f32_16x16x32_bf16 v[156:159], v[204:207], v[224:227], v[156:159]
    ds_read_b64_tr_b16 v[200:201], v7 offset:8192
    s_waitcnt lgkmcnt(4)
    v_mfma_f32_16x16x32_bf16 v[144:147], v[208:211], v[220:223], v[144:147]
    s_mov_b32 s79, 0
    buffer_load_dwordx4 v[60:63], v252, s[60:63], s79 offen offset:0 sc1
    ds_read_b64_tr_b16 v[202:203], v7 offset:8704
    v_mfma_f32_16x16x32_bf16 v[160:163], v[208:211], v[224:227], v[160:163]
    ds_read_b128 v[184:187], v4 offset:53248
    v_mfma_f32_16x16x32_bf16 v[148:151], v[212:215], v[220:223], v[148:151]
    ds_read_b128 v[188:191], v4 offset:57344
    v_mfma_f32_16x16x32_bf16 v[164:167], v[212:215], v[224:227], v[164:167]
    ds_read_b128 v[192:195], v4 offset:61440
    v_mfma_f32_16x16x32_bf16 v[152:155], v[216:219], v[220:223], v[152:155]
    buffer_load_dwordx4 v[64:67], v252, s[60:63], s79 offen offset:2048 sc1
    v_mfma_f32_16x16x32_bf16 v[168:171], v[216:219], v[224:227], v[168:171]
    s_waitcnt lgkmcnt(3)
    v_mfma_f32_16x16x32_bf16 v[172:175], v[56:59], v[196:199], v[172:175]
    ds_read_b64_tr_b16 v[220:221], v7 offset:4096
    v_mfma_f32_16x16x32_bf16 v[176:179], v[56:59], v[200:203], v[176:179]
    ds_read_b64_tr_b16 v[222:223], v7 offset:4608
    v_mfma_f32_16x16x32_bf16 v[140:143], v[180:183], v[196:199], v[140:143]
    s_mov_b32 s79, 4096
    buffer_load_dwordx4 v[68:71], v252, s[60:63], s79 offen offset:0 sc1
    ds_read_b128 v[204:207], v5 offset:49152
    v_mfma_f32_16x16x32_bf16 v[156:159], v[180:183], v[200:203], v[156:159]
    ds_read_b64_tr_b16 v[224:225], v7 offset:12288
    s_waitcnt lgkmcnt(4)
    v_mfma_f32_16x16x32_bf16 v[144:147], v[184:187], v[196:199], v[144:147]
    ds_read_b64_tr_b16 v[226:227], v7 offset:12800
    v_mfma_f32_16x16x32_bf16 v[160:163], v[184:187], v[200:203], v[160:163]
    ds_read_b128 v[208:211], v5 offset:53248
    v_mfma_f32_16x16x32_bf16 v[148:151], v[188:191], v[196:199], v[148:151]
    buffer_load_dwordx4 v[72:75], v252, s[60:63], s79 offen offset:2048 sc1
    ds_read_b128 v[212:215], v5 offset:57344
    v_mfma_f32_16x16x32_bf16 v[164:167], v[188:191], v[200:203], v[164:167]
    ds_read_b128 v[216:219], v5 offset:61440
    v_mfma_f32_16x16x32_bf16 v[152:155], v[192:195], v[196:199], v[152:155]
    v_mfma_f32_16x16x32_bf16 v[168:171], v[192:195], v[200:203], v[168:171]
    s_waitcnt lgkmcnt(3)
    v_mfma_f32_16x16x32_bf16 v[172:175], v[56:59], v[220:223], v[172:175]
    s_mov_b32 s79, 0
    buffer_load_dwordx4 v[76:79], v253, s[60:63], s79 offen offset:0 sc1
    v_add_u32 v16, 98304, v8
    v_add_u32 v17, 98304, v9
    s_barrier
    ds_read_b64_tr_b16 v[228:229], v16 offset:0
    v_mfma_f32_16x16x32_bf16 v[176:179], v[56:59], v[224:227], v[176:179]
    ds_read_b64_tr_b16 v[230:231], v16 offset:512
    v_mfma_f32_16x16x32_bf16 v[140:143], v[204:207], v[220:223], v[140:143]
    ds_read_b64_tr_b16 v[232:233], v17 offset:0
    v_mfma_f32_16x16x32_bf16 v[156:159], v[204:207], v[224:227], v[156:159]
    ds_read_b64_tr_b16 v[234:235], v17 offset:512
    s_waitcnt lgkmcnt(4)
    s_nop 0
    v_mfma_f32_16x16x32_bf16 v[144:147], v[208:211], v[220:223], v[144:147]
    buffer_load_dwordx4 v[80:83], v253, s[60:63], s79 offen offset:2048 sc1
    ds_read_b64_tr_b16 v[236:237], v16 offset:2048
    v_mfma_f32_16x16x32_bf16 v[160:163], v[208:211], v[224:227], v[160:163]
    ds_read_b64_tr_b16 v[238:239], v16 offset:2560
    v_mfma_f32_16x16x32_bf16 v[148:151], v[212:215], v[220:223], v[148:151]
    ds_read_b64_tr_b16 v[240:241], v17 offset:2048
    v_mfma_f32_16x16x32_bf16 v[164:167], v[212:215], v[224:227], v[164:167]
    ds_read_b64_tr_b16 v[242:243], v17 offset:2560
    v_mfma_f32_16x16x32_bf16 v[152:155], v[216:219], v[220:223], v[152:155]
    s_mov_b32 s79, 4096
    buffer_load_dwordx4 v[84:87], v253, s[60:63], s79 offen offset:0 sc1
    v_mfma_f32_16x16x32_bf16 v[168:171], v[216:219], v[224:227], v[168:171]
    ds_read_b128 v[180:183], v54 offset:0
    ds_read_b128 v[184:187], v54 offset:64
    ds_read_b128 v[188:191], v54 offset:128
    ds_read_b128 v[192:195], v54 offset:192
    ds_read_b128 v[212:215], v54 offset:512
    ds_read_b128 v[216:219], v54 offset:576
    ds_read_b128 v[220:223], v54 offset:640
    ds_read_b128 v[224:227], v54 offset:704
    ds_read_b128 v[196:199], v54 offset:256
    ds_read_b128 v[200:203], v54 offset:320
    ds_read_b128 v[204:207], v54 offset:384
    ds_read_b128 v[208:211], v54 offset:448
    s_waitcnt lgkmcnt(4)
    s_nop 0
    v_pk_fma_f32 v[140:141], v[180:181], v[172:173], v[140:141] op_sel_hi:[1,0,1]
    v_pk_fma_f32 v[142:143], v[182:183], v[172:173], v[142:143] op_sel_hi:[1,0,1]
    v_pk_fma_f32 v[144:145], v[184:185], v[172:173], v[144:145] op_sel_hi:[1,0,1]
    v_pk_fma_f32 v[146:147], v[186:187], v[172:173], v[146:147] op_sel_hi:[1,0,1]
    v_pk_fma_f32 v[148:149], v[188:189], v[172:173], v[148:149] op_sel_hi:[1,0,1]
    v_pk_fma_f32 v[150:151], v[190:191], v[172:173], v[150:151] op_sel_hi:[1,0,1]
    v_pk_fma_f32 v[152:153], v[192:193], v[172:173], v[152:153] op_sel_hi:[1,0,1]
    v_pk_fma_f32 v[154:155], v[194:195], v[172:173], v[154:155] op_sel_hi:[1,0,1]
    v_pk_fma_f32 v[156:157], v[180:181], v[176:177], v[156:157] op_sel_hi:[1,0,1]
    v_pk_fma_f32 v[158:159], v[182:183], v[176:177], v[158:159] op_sel_hi:[1,0,1]
    v_pk_fma_f32 v[160:161], v[184:185], v[176:177], v[160:161] op_sel_hi:[1,0,1]
    v_pk_fma_f32 v[162:163], v[186:187], v[176:177], v[162:163] op_sel_hi:[1,0,1]
    buffer_load_dwordx4 v[88:91], v253, s[60:63], s79 offen offset:2048 sc1
    v_pk_fma_f32 v[164:165], v[188:189], v[176:177], v[164:165] op_sel_hi:[1,0,1]
    v_pk_fma_f32 v[166:167], v[190:191], v[176:177], v[166:167] op_sel_hi:[1,0,1]
    v_pk_fma_f32 v[168:169], v[192:193], v[176:177], v[168:169] op_sel_hi:[1,0,1]
    v_pk_fma_f32 v[170:171], v[194:195], v[176:177], v[170:171] op_sel_hi:[1,0,1]
    v_pk_mul_f32 v[212:213], v[212:213], v[140:141]
    v_pk_mul_f32 v[214:215], v[214:215], v[142:143]
    v_pk_mul_f32 v[216:217], v[216:217], v[144:145]
    v_pk_mul_f32 v[218:219], v[218:219], v[146:147]
    v_pk_mul_f32 v[220:221], v[220:221], v[148:149]
    v_pk_mul_f32 v[222:223], v[222:223], v[150:151]
    v_pk_mul_f32 v[224:225], v[224:225], v[152:153]
    v_pk_mul_f32 v[226:227], v[226:227], v[154:155]
    s_waitcnt lgkmcnt(0)
    ds_read_b128 v[40:43], v1 offset:1024
    ds_read_b128 v[44:47], v1 offset:1280
    ds_read_b128 v[48:51], v1 offset:1536
    ds_read_b128 v[52:55], v1 offset:1792
    v_pk_fma_f32 v[140:141], v[140:141], v[196:197], s[80:81]
    v_pk_fma_f32 v[142:143], v[142:143], v[198:199], s[80:81]
    v_pk_fma_f32 v[144:145], v[144:145], v[200:201], s[80:81]
    v_pk_fma_f32 v[146:147], v[146:147], v[202:203], s[80:81]
    s_mov_b32 s79, 0
    buffer_load_dwordx4 v[92:95], v254, s[60:63], s79 offen offset:0 sc1
    v_pk_fma_f32 v[148:149], v[148:149], v[204:205], s[80:81]
    v_pk_fma_f32 v[150:151], v[150:151], v[206:207], s[80:81]
    v_pk_fma_f32 v[152:153], v[152:153], v[208:209], s[80:81]
    v_pk_fma_f32 v[154:155], v[154:155], v[210:211], s[80:81]
    v_pk_mul_f32 v[156:157], v[156:157], v[196:197]
    v_pk_mul_f32 v[158:159], v[158:159], v[198:199]
    v_pk_mul_f32 v[160:161], v[160:161], v[200:201]
    v_pk_mul_f32 v[162:163], v[162:163], v[202:203]
    v_pk_mul_f32 v[164:165], v[164:165], v[204:205]
    v_pk_mul_f32 v[166:167], v[166:167], v[206:207]
    v_pk_mul_f32 v[168:169], v[168:169], v[208:209]
    v_pk_mul_f32 v[170:171], v[170:171], v[210:211]
    v_cvt_pk_bf16_f32 v188, v156, v157
    v_cvt_pk_bf16_f32 v189, v158, v159
    v_cvt_pk_bf16_f32 v190, v160, v161
    v_cvt_pk_bf16_f32 v191, v162, v163
    buffer_load_dwordx4 v[96:99], v254, s[60:63], s79 offen offset:2048 sc1
    v_cvt_pk_bf16_f32 v192, v164, v165
    v_cvt_pk_bf16_f32 v193, v166, v167
    v_cvt_pk_bf16_f32 v194, v168, v169
    v_cvt_pk_bf16_f32 v195, v170, v171
    v_exp_f32_e64 v212, v212 clamp
    v_exp_f32_e64 v213, v213 clamp
    v_exp_f32_e64 v214, v214 clamp
    v_exp_f32_e64 v215, v215 clamp
    v_exp_f32_e64 v216, v216 clamp
    v_exp_f32_e64 v217, v217 clamp
    s_mov_b32 s79, 4096
    buffer_load_dwordx4 v[100:103], v254, s[60:63], s79 offen offset:0 sc1
    v_exp_f32_e64 v218, v218 clamp
    v_exp_f32_e64 v219, v219 clamp
    v_exp_f32_e64 v220, v220 clamp
    v_exp_f32_e64 v221, v221 clamp
    v_exp_f32_e64 v222, v222 clamp
    v_exp_f32_e64 v223, v223 clamp
    v_exp_f32_e64 v224, v224 clamp
    v_exp_f32_e64 v225, v225 clamp
    buffer_load_dwordx4 v[104:107], v254, s[60:63], s79 offen offset:2048 sc1
    v_exp_f32_e64 v226, v226 clamp
    v_exp_f32_e64 v227, v227 clamp
    v_max_f32_e64 v140, v140, s80
    v_max_f32_e64 v141, v141, s80
    v_max_f32_e64 v142, v142, s80
    v_max_f32_e64 v143, v143, s80
    v_max_f32_e64 v144, v144, s80
    v_max_f32_e64 v145, v145, s80
    v_max_f32_e64 v146, v146, s80
    v_max_f32_e64 v147, v147, s80
    v_max_f32_e64 v148, v148, s80
    v_max_f32_e64 v149, v149, s80
    v_max_f32_e64 v150, v150, s80
    v_max_f32_e64 v151, v151, s80
    s_mov_b32 s79, 0
    s_nop 0
    buffer_load_dwordx4 v[108:111], v255, s[60:63], s79 offen offset:0 sc1
    v_max_f32_e64 v152, v152, s80
    v_max_f32_e64 v153, v153, s80
    v_max_f32_e64 v154, v154, s80
    v_max_f32_e64 v155, v155, s80
    v_pk_add_f32 v[140:141], v[140:141], v[212:213]
    v_pk_add_f32 v[142:143], v[142:143], v[214:215]
    v_pk_add_f32 v[144:145], v[144:145], v[216:217]
    v_pk_add_f32 v[146:147], v[146:147], v[218:219]
    v_pk_add_f32 v[148:149], v[148:149], v[220:221]
    v_pk_add_f32 v[150:151], v[150:151], v[222:223]
    v_pk_add_f32 v[152:153], v[152:153], v[224:225]
    v_pk_add_f32 v[154:155], v[154:155], v[226:227]
    v_cvt_pk_bf16_f32 v180, v140, v141
    v_cvt_pk_bf16_f32 v181, v142, v143
    v_cvt_pk_bf16_f32 v182, v144, v145
    v_cvt_pk_bf16_f32 v183, v146, v147
    buffer_load_dwordx4 v[112:115], v255, s[60:63], s79 offen offset:2048 sc1
    v_cvt_pk_bf16_f32 v184, v148, v149
    v_cvt_pk_bf16_f32 v185, v150, v151
    v_cvt_pk_bf16_f32 v186, v152, v153
    v_cvt_pk_bf16_f32 v187, v154, v155
    v_and_b32 v199, 15, v0
    v_lshrrev_b32 v200, 4, v0
    v_mfma_f32_16x16x32_bf16 v[176:179], v[180:183], v[56:59], 0
    v_mfma_f32_16x16x32_bf16 v[172:175], v[188:191], v[180:183], 0
    v_mfma_f32_16x16x32_bf16 v[176:179], v[184:187], v[56:59], v[176:179]
    s_mov_b32 s79, 4096
    buffer_load_dwordx4 v[116:119], v255, s[60:63], s79 offen offset:0 sc1
    v_mfma_f32_16x16x32_bf16 v[172:175], v[192:195], v[184:187], v[172:175]
    v_lshlrev_b32 v198, 8, v200
    v_lshl_add_u32 v198, v199, 2, v198
    v_lshl_add_u32 v200, v200, 2, v199
    v_lshlrev_b32 v200, 2, v200
    v_mov_b32 v201, 2147483648
    v_cmp_gt_u32 vcc, 4, v199
    s_nop 1
    v_cndmask_b32 v200, v201, v200, vcc
    v_cmp_eq_u32 vcc, 1, v199
    s_nop 1
    v_cndmask_b32 v176, v176, v177, vcc
    v_cmp_eq_u32 vcc, 2, v199
    s_nop 1
    v_cndmask_b32 v176, v176, v178, vcc
    v_cmp_eq_u32 vcc, 3, v199
    buffer_load_dwordx4 v[120:123], v255, s[60:63], s79 offen offset:2048 sc1
    s_nop 0
    v_cndmask_b32 v176, v176, v179, vcc
    s_lshl_b32 s76, s70, 10
    s_add_u32 s76, s76, s87
    s_lshl_b32 s77, s70, 6
    s_add_u32 s77, s77, s87
    s_add_u32 s77, s77, 4096
    buffer_atomic_add_f32 v172, v198, s[60:63], s76 offen offset:0
    buffer_atomic_add_f32 v173, v198, s[60:63], s76 offen offset:64
    buffer_atomic_add_f32 v174, v198, s[60:63], s76 offen offset:128
    buffer_atomic_add_f32 v175, v198, s[60:63], s76 offen offset:192
    buffer_atomic_add_f32 v176, v200, s[60:63], s77 offen
    s_waitcnt vmcnt(20)
    v_mfma_f32_32x32x16_bf16 v[140:155], v[228:231], v[60:63], v[124:139]
    ds_read_b64_tr_b16 v[244:245], v16 offset:4096
    ds_read_b64_tr_b16 v[246:247], v16 offset:4608
    v_mfma_f32_32x32x16_bf16 v[156:171], v[232:235], v[60:63], 0
    ds_read_b64_tr_b16 v[248:249], v17 offset:4096
    ds_read_b64_tr_b16 v[250:251], v17 offset:4608
    s_waitcnt vmcnt(19)
    v_mfma_f32_32x32x16_bf16 v[140:155], v[236:239], v[64:67], v[140:155]
    ds_read_b64_tr_b16 v[228:229], v16 offset:6144
    ds_read_b64_tr_b16 v[230:231], v16 offset:6656
    v_mfma_f32_32x32x16_bf16 v[156:171], v[240:243], v[64:67], v[156:171]
    ds_read_b64_tr_b16 v[232:233], v17 offset:6144
    ds_read_b64_tr_b16 v[234:235], v17 offset:6656
    s_waitcnt vmcnt(18) lgkmcnt(4)
    v_mfma_f32_32x32x16_bf16 v[140:155], v[244:247], v[68:71], v[140:155]
    v_add_u32 v16, 114688, v8
    v_add_u32 v17, 114688, v9
    s_barrier
    ds_read_b64_tr_b16 v[236:237], v16 offset:0
    ds_read_b64_tr_b16 v[238:239], v16 offset:512
    v_mfma_f32_32x32x16_bf16 v[156:171], v[248:251], v[68:71], v[156:171]
    ds_read_b64_tr_b16 v[240:241], v17 offset:0
    ds_read_b64_tr_b16 v[242:243], v17 offset:512
    s_waitcnt vmcnt(17) lgkmcnt(4)
    v_mfma_f32_32x32x16_bf16 v[140:155], v[228:231], v[72:75], v[140:155]
    ds_read_b64_tr_b16 v[244:245], v16 offset:2048
    ds_read_b64_tr_b16 v[246:247], v16 offset:2560
    v_mfma_f32_32x32x16_bf16 v[156:171], v[232:235], v[72:75], v[156:171]
    ds_read_b64_tr_b16 v[248:249], v17 offset:2048
    ds_read_b64_tr_b16 v[250:251], v17 offset:2560
    s_waitcnt vmcnt(16) lgkmcnt(4)
    v_mfma_f32_32x32x16_bf16 v[140:155], v[236:239], v[76:79], v[140:155]
    ds_read_b64_tr_b16 v[228:229], v16 offset:4096
    ds_read_b64_tr_b16 v[230:231], v16 offset:4608
    v_mfma_f32_32x32x16_bf16 v[156:171], v[240:243], v[76:79], v[156:171]
    ds_read_b64_tr_b16 v[232:233], v17 offset:4096
    ds_read_b64_tr_b16 v[234:235], v17 offset:4608
    s_waitcnt vmcnt(15) lgkmcnt(4)
    v_mfma_f32_32x32x16_bf16 v[140:155], v[244:247], v[80:83], v[140:155]
    ds_read_b64_tr_b16 v[236:237], v16 offset:6144
    ds_read_b64_tr_b16 v[238:239], v16 offset:6656
    v_mfma_f32_32x32x16_bf16 v[156:171], v[248:251], v[80:83], v[156:171]
    ds_read_b64_tr_b16 v[240:241], v17 offset:6144
    ds_read_b64_tr_b16 v[242:243], v17 offset:6656
    s_waitcnt vmcnt(14) lgkmcnt(4)
    v_mfma_f32_32x32x16_bf16 v[140:155], v[228:231], v[84:87], v[140:155]
    v_add_u32 v16, 131072, v8
    v_add_u32 v17, 131072, v9
    s_barrier
    ds_read_b64_tr_b16 v[244:245], v16 offset:0
    ds_read_b64_tr_b16 v[246:247], v16 offset:512
    v_mfma_f32_32x32x16_bf16 v[156:171], v[232:235], v[84:87], v[156:171]
    ds_read_b64_tr_b16 v[248:249], v17 offset:0
    ds_read_b64_tr_b16 v[250:251], v17 offset:512
    s_waitcnt vmcnt(13) lgkmcnt(4)
    v_mfma_f32_32x32x16_bf16 v[140:155], v[236:239], v[88:91], v[140:155]
    ds_read_b64_tr_b16 v[228:229], v16 offset:2048
    ds_read_b64_tr_b16 v[230:231], v16 offset:2560
    v_mfma_f32_32x32x16_bf16 v[156:171], v[240:243], v[88:91], v[156:171]
    ds_read_b64_tr_b16 v[232:233], v17 offset:2048
    ds_read_b64_tr_b16 v[234:235], v17 offset:2560
    s_waitcnt vmcnt(12) lgkmcnt(4)
    v_mfma_f32_32x32x16_bf16 v[140:155], v[244:247], v[92:95], v[140:155]
    ds_read_b64_tr_b16 v[236:237], v16 offset:4096
    ds_read_b64_tr_b16 v[238:239], v16 offset:4608
    v_mfma_f32_32x32x16_bf16 v[156:171], v[248:251], v[92:95], v[156:171]
    ds_read_b64_tr_b16 v[240:241], v17 offset:4096
    ds_read_b64_tr_b16 v[242:243], v17 offset:4608
    s_waitcnt vmcnt(11) lgkmcnt(4)
    v_mfma_f32_32x32x16_bf16 v[140:155], v[228:231], v[96:99], v[140:155]
    ds_read_b64_tr_b16 v[244:245], v16 offset:6144
    ds_read_b64_tr_b16 v[246:247], v16 offset:6656
    v_mfma_f32_32x32x16_bf16 v[156:171], v[232:235], v[96:99], v[156:171]
    ds_read_b64_tr_b16 v[248:249], v17 offset:6144
    ds_read_b64_tr_b16 v[250:251], v17 offset:6656
    s_waitcnt vmcnt(10) lgkmcnt(4)
    v_mfma_f32_32x32x16_bf16 v[140:155], v[236:239], v[100:103], v[140:155]
    v_add_u32 v16, 65536, v8
    v_add_u32 v17, 65536, v9
    s_barrier
    ds_read_b64_tr_b16 v[228:229], v16 offset:0
    ds_read_b64_tr_b16 v[230:231], v16 offset:512
    v_mfma_f32_32x32x16_bf16 v[156:171], v[240:243], v[100:103], v[156:171]
    ds_read_b64_tr_b16 v[232:233], v17 offset:0
    ds_read_b64_tr_b16 v[234:235], v17 offset:512
    s_waitcnt vmcnt(9) lgkmcnt(4)
    v_mfma_f32_32x32x16_bf16 v[140:155], v[244:247], v[104:107], v[140:155]
    ds_read_b64_tr_b16 v[236:237], v16 offset:2048
    ds_read_b64_tr_b16 v[238:239], v16 offset:2560
    v_mfma_f32_32x32x16_bf16 v[156:171], v[248:251], v[104:107], v[156:171]
    ds_read_b64_tr_b16 v[240:241], v17 offset:2048
    ds_read_b64_tr_b16 v[242:243], v17 offset:2560
    s_waitcnt vmcnt(8) lgkmcnt(4)
    v_mfma_f32_32x32x16_bf16 v[140:155], v[228:231], v[108:111], v[140:155]
    ds_read_b64_tr_b16 v[244:245], v16 offset:4096
    ds_read_b64_tr_b16 v[246:247], v16 offset:4608
    v_mfma_f32_32x32x16_bf16 v[156:171], v[232:235], v[108:111], v[156:171]
    ds_read_b64_tr_b16 v[248:249], v17 offset:4096
    ds_read_b64_tr_b16 v[250:251], v17 offset:4608
    s_waitcnt vmcnt(7) lgkmcnt(4)
    v_mfma_f32_32x32x16_bf16 v[140:155], v[236:239], v[112:115], v[140:155]
    ds_read_b64_tr_b16 v[228:229], v16 offset:6144
    ds_read_b64_tr_b16 v[230:231], v16 offset:6656
    v_mfma_f32_32x32x16_bf16 v[156:171], v[240:243], v[112:115], v[156:171]
    ds_read_b64_tr_b16 v[232:233], v17 offset:6144
    ds_read_b64_tr_b16 v[234:235], v17 offset:6656
    s_waitcnt vmcnt(6) lgkmcnt(4)
    v_mfma_f32_32x32x16_bf16 v[140:155], v[244:247], v[116:119], v[140:155]
    v_mfma_f32_32x32x16_bf16 v[156:171], v[248:251], v[116:119], v[156:171]
    s_waitcnt vmcnt(5) lgkmcnt(0)
    v_mfma_f32_32x32x16_bf16 v[140:155], v[228:231], v[120:123], v[140:155]
    v_mfma_f32_32x32x16_bf16 v[156:171], v[232:235], v[120:123], v[156:171]
    v_xor_b32 v180, 8192, v23
    s_nop 10
    ds_write_b128 v180, v[156:159] offset:0
    ds_write_b128 v180, v[160:163] offset:1024
    ds_write_b128 v180, v[164:167] offset:2048
    ds_write_b128 v180, v[168:171] offset:3072
    s_lshl_b32 s75, s69, 1
    s_add_u32 s75, s75, s72
    s_lshl_b32 s73, s75, 12
    s_add_u32 s73, s73, s85
    s_add_u32 s73, s73, 2097152
    s_lshl_b32 s75, s75, 9
    s_lshl_b32 s76, s68, 13
    s_add_u32 s75, s75, s76
    s_lshl_b32 s76, s71, 8
    s_add_u32 s75, s75, s76
    s_add_u32 s75, s75, 13762560
    v_add_u32 v7, 81920, v6
    v_and_b32 v212, 31, v0
    v_lshrrev_b32 v213, 5, v0
    v_lshlrev_b32 v213, 2, v213
    v_lshl_add_u32 v212, v212, 3, v213
    s_waitcnt lgkmcnt(0)
    s_barrier
    ds_read_b128 v[180:183], v23 offset:0
    ds_read_b128 v[184:187], v23 offset:1024
    ds_read_b128 v[188:191], v23 offset:2048
    ds_read_b128 v[192:195], v23 offset:3072
    s_waitcnt lgkmcnt(2)
    v_pk_add_f32 v[140:141], v[140:141], v[180:181]
    v_pk_add_f32 v[142:143], v[142:143], v[182:183]
    v_pk_add_f32 v[144:145], v[144:145], v[184:185]
    v_pk_add_f32 v[146:147], v[146:147], v[186:187]
    v_cvt_pk_bf16_f32 v196, v140, v141
    v_cvt_pk_bf16_f32 v197, v142, v143
    v_cvt_pk_bf16_f32 v198, v144, v145
    v_cvt_pk_bf16_f32 v199, v146, v147
    buffer_store_dwordx4 v[196:199], v21, s[60:63], s73 offen offset:0 sc1
    s_waitcnt lgkmcnt(0)
    v_pk_add_f32 v[148:149], v[148:149], v[188:189]
    v_pk_add_f32 v[150:151], v[150:151], v[190:191]
    v_pk_add_f32 v[152:153], v[152:153], v[192:193]
    v_pk_add_f32 v[154:155], v[154:155], v[194:195]
    v_cvt_pk_bf16_f32 v200, v148, v149
    v_cvt_pk_bf16_f32 v201, v150, v151
    v_cvt_pk_bf16_f32 v202, v152, v153
    v_cvt_pk_bf16_f32 v203, v154, v155
    buffer_store_dwordx4 v[200:203], v21, s[60:63], s73 offen offset:2048 sc1
    v_pk_add_f32 v[204:205], v[140:141], v[142:143]
    v_pk_mul_f32 v[206:207], v[140:141], v[140:141]
    v_pk_add_f32 v[208:209], v[144:145], v[146:147]
    v_pk_mul_f32 v[210:211], v[142:143], v[142:143]
    v_pk_fma_f32 v[206:207], v[144:145], v[144:145], v[206:207]
    v_pk_fma_f32 v[210:211], v[146:147], v[146:147], v[210:211]
    v_pk_fma_f32 v[206:207], v[148:149], v[148:149], v[206:207]
    v_pk_add_f32 v[204:205], v[204:205], v[148:149]
    v_pk_fma_f32 v[210:211], v[150:151], v[150:151], v[210:211]
    v_pk_add_f32 v[208:209], v[208:209], v[150:151]
    v_pk_fma_f32 v[206:207], v[152:153], v[152:153], v[206:207]
    v_pk_add_f32 v[204:205], v[204:205], v[152:153]
    v_pk_fma_f32 v[210:211], v[154:155], v[154:155], v[210:211]
    v_pk_add_f32 v[208:209], v[208:209], v[154:155]
    v_pk_add_f32 v[204:205], v[204:205], v[208:209]
    v_pk_add_f32 v[206:207], v[206:207], v[210:211]
    v_add_f32 v204, v204, v205
    v_add_f32 v206, v206, v207
    s_nop 1
    v_permlane32_swap_b32 v204, v206
    v_add_f32 v204, v204, v206
    buffer_store_dword v204, v212, s[60:63], s75 offen sc1
    v_pk_add_f32 v[24:25], v[24:25], v[140:141]
    v_pk_add_f32 v[26:27], v[26:27], v[142:143]
    v_pk_add_f32 v[28:29], v[28:29], v[144:145]
    v_pk_add_f32 v[30:31], v[30:31], v[146:147]
    v_pk_add_f32 v[32:33], v[32:33], v[148:149]
    v_pk_add_f32 v[34:35], v[34:35], v[150:151]
    v_pk_add_f32 v[36:37], v[36:37], v[152:153]
    v_pk_add_f32 v[38:39], v[38:39], v[154:155]
    s_barrier
    ds_read_b64_tr_b16 v[96:97], v7 offset:0
    ds_read_b64_tr_b16 v[98:99], v7 offset:512
    ds_read_b128 v[80:83], v2 offset:0
    ds_read_b128 v[84:87], v2 offset:4096
    ds_read_b128 v[88:91], v2 offset:8192
    ds_read_b128 v[92:95], v2 offset:12288
    ds_read_b64_tr_b16 v[116:117], v7 offset:4096
    ds_read_b64_tr_b16 v[118:119], v7 offset:4608
    ds_read_b128 v[100:103], v3 offset:0
    ds_read_b128 v[104:107], v3 offset:4096
    ds_read_b128 v[108:111], v3 offset:8192
    ds_read_b128 v[112:115], v3 offset:12288
    s_waitcnt lgkmcnt(6)
    v_mfma_f32_16x16x32_bf16 v[76:79], v[96:99], v[56:59], 0
    ds_read_b64_tr_b16 v[136:137], v7 offset:8192
    ds_read_b64_tr_b16 v[138:139], v7 offset:8704
    v_mfma_f32_16x16x32_bf16 v[60:63], v[96:99], v[80:83], 0
    ds_read_b128 v[120:123], v4 offset:0
    ds_read_b128 v[124:127], v4 offset:4096
    v_mfma_f32_16x16x32_bf16 v[64:67], v[96:99], v[84:87], 0
    ds_read_b128 v[128:131], v4 offset:8192
    ds_read_b128 v[132:135], v4 offset:12288
    v_mfma_f32_16x16x32_bf16 v[68:71], v[96:99], v[88:91], 0
    v_mfma_f32_16x16x32_bf16 v[72:75], v[96:99], v[92:95], 0
    s_waitcnt lgkmcnt(6)
    v_mfma_f32_16x16x32_bf16 v[76:79], v[116:119], v[56:59], v[76:79]
    ds_read_b64_tr_b16 v[96:97], v7 offset:12288
    ds_read_b64_tr_b16 v[98:99], v7 offset:12800
    v_mfma_f32_16x16x32_bf16 v[60:63], v[116:119], v[100:103], v[60:63]
    ds_read_b128 v[80:83], v5 offset:0
    ds_read_b128 v[84:87], v5 offset:4096
    v_mfma_f32_16x16x32_bf16 v[64:67], v[116:119], v[104:107], v[64:67]
    ds_read_b128 v[88:91], v5 offset:8192
    ds_read_b128 v[92:95], v5 offset:12288
    v_mfma_f32_16x16x32_bf16 v[68:71], v[116:119], v[108:111], v[68:71]
    v_mfma_f32_16x16x32_bf16 v[72:75], v[116:119], v[112:115], v[72:75]
    s_waitcnt lgkmcnt(6)
    v_mfma_f32_16x16x32_bf16 v[76:79], v[136:139], v[56:59], v[76:79]
    v_add_u32 v7, 98304, v6
    s_waitcnt vmcnt(0)
    s_barrier
    ds_read_b64_tr_b16 v[116:117], v7 offset:0
    ds_read_b64_tr_b16 v[118:119], v7 offset:512
    v_mfma_f32_16x16x32_bf16 v[60:63], v[136:139], v[120:123], v[60:63]
    ds_read_b128 v[100:103], v2 offset:16384
    ds_read_b128 v[104:107], v2 offset:20480
    v_mfma_f32_16x16x32_bf16 v[64:67], v[136:139], v[124:127], v[64:67]
    ds_read_b128 v[108:111], v2 offset:24576
    ds_read_b128 v[112:115], v2 offset:28672
    v_mfma_f32_16x16x32_bf16 v[68:71], v[136:139], v[128:131], v[68:71]
    v_mfma_f32_16x16x32_bf16 v[72:75], v[136:139], v[132:135], v[72:75]
    s_waitcnt lgkmcnt(6)
    v_mfma_f32_16x16x32_bf16 v[76:79], v[96:99], v[56:59], v[76:79]
    ds_read_b64_tr_b16 v[136:137], v7 offset:4096
    ds_read_b64_tr_b16 v[138:139], v7 offset:4608
    v_mfma_f32_16x16x32_bf16 v[60:63], v[96:99], v[80:83], v[60:63]
    ds_read_b128 v[120:123], v3 offset:16384
    ds_read_b128 v[124:127], v3 offset:20480
    v_mfma_f32_16x16x32_bf16 v[64:67], v[96:99], v[84:87], v[64:67]
    ds_read_b128 v[128:131], v3 offset:24576
    ds_read_b128 v[132:135], v3 offset:28672
    v_mfma_f32_16x16x32_bf16 v[68:71], v[96:99], v[88:91], v[68:71]
    v_mfma_f32_16x16x32_bf16 v[72:75], v[96:99], v[92:95], v[72:75]
    s_waitcnt lgkmcnt(6)
    v_mfma_f32_16x16x32_bf16 v[76:79], v[116:119], v[56:59], v[76:79]
    ds_read_b64_tr_b16 v[96:97], v7 offset:8192
    ds_read_b64_tr_b16 v[98:99], v7 offset:8704
    v_mfma_f32_16x16x32_bf16 v[60:63], v[116:119], v[100:103], v[60:63]
    ds_read_b128 v[80:83], v4 offset:16384
    ds_read_b128 v[84:87], v4 offset:20480
    v_mfma_f32_16x16x32_bf16 v[64:67], v[116:119], v[104:107], v[64:67]
    ds_read_b128 v[88:91], v4 offset:24576
    ds_read_b128 v[92:95], v4 offset:28672
    v_mfma_f32_16x16x32_bf16 v[68:71], v[116:119], v[108:111], v[68:71]
    v_mfma_f32_16x16x32_bf16 v[72:75], v[116:119], v[112:115], v[72:75]
    s_waitcnt lgkmcnt(6)
    v_mfma_f32_16x16x32_bf16 v[76:79], v[136:139], v[56:59], v[76:79]
    ds_read_b64_tr_b16 v[116:117], v7 offset:12288
    ds_read_b64_tr_b16 v[118:119], v7 offset:12800
    v_mfma_f32_16x16x32_bf16 v[60:63], v[136:139], v[120:123], v[60:63]
    ds_read_b128 v[100:103], v5 offset:16384
    ds_read_b128 v[104:107], v5 offset:20480
    v_mfma_f32_16x16x32_bf16 v[64:67], v[136:139], v[124:127], v[64:67]
    ds_read_b128 v[108:111], v5 offset:24576
    ds_read_b128 v[112:115], v5 offset:28672
    v_mfma_f32_16x16x32_bf16 v[68:71], v[136:139], v[128:131], v[68:71]
    v_mfma_f32_16x16x32_bf16 v[72:75], v[136:139], v[132:135], v[72:75]
    s_waitcnt lgkmcnt(6)
    v_mfma_f32_16x16x32_bf16 v[76:79], v[96:99], v[56:59], v[76:79]
    v_add_u32 v7, 114688, v6
    s_barrier
    ds_read_b64_tr_b16 v[136:137], v7 offset:0
    ds_read_b64_tr_b16 v[138:139], v7 offset:512
    v_mfma_f32_16x16x32_bf16 v[60:63], v[96:99], v[80:83], v[60:63]
    ds_read_b128 v[120:123], v2 offset:32768
    ds_read_b128 v[124:127], v2 offset:36864
    v_mfma_f32_16x16x32_bf16 v[64:67], v[96:99], v[84:87], v[64:67]
    ds_read_b128 v[128:131], v2 offset:40960
    ds_read_b128 v[132:135], v2 offset:45056
    v_mfma_f32_16x16x32_bf16 v[68:71], v[96:99], v[88:91], v[68:71]
    v_mfma_f32_16x16x32_bf16 v[72:75], v[96:99], v[92:95], v[72:75]
    s_waitcnt lgkmcnt(6)
    v_mfma_f32_16x16x32_bf16 v[76:79], v[116:119], v[56:59], v[76:79]
    ds_read_b64_tr_b16 v[96:97], v7 offset:4096
    ds_read_b64_tr_b16 v[98:99], v7 offset:4608
    v_mfma_f32_16x16x32_bf16 v[60:63], v[116:119], v[100:103], v[60:63]
    ds_read_b128 v[80:83], v3 offset:32768
    ds_read_b128 v[84:87], v3 offset:36864
    v_mfma_f32_16x16x32_bf16 v[64:67], v[116:119], v[104:107], v[64:67]
    ds_read_b128 v[88:91], v3 offset:40960
    ds_read_b128 v[92:95], v3 offset:45056
    v_mfma_f32_16x16x32_bf16 v[68:71], v[116:119], v[108:111], v[68:71]
    v_mfma_f32_16x16x32_bf16 v[72:75], v[116:119], v[112:115], v[72:75]
    s_waitcnt lgkmcnt(6)
    v_mfma_f32_16x16x32_bf16 v[76:79], v[136:139], v[56:59], v[76:79]
    ds_read_b64_tr_b16 v[116:117], v7 offset:8192
    ds_read_b64_tr_b16 v[118:119], v7 offset:8704
    v_mfma_f32_16x16x32_bf16 v[60:63], v[136:139], v[120:123], v[60:63]
    ds_read_b128 v[100:103], v4 offset:32768
    ds_read_b128 v[104:107], v4 offset:36864
    v_mfma_f32_16x16x32_bf16 v[64:67], v[136:139], v[124:127], v[64:67]
    ds_read_b128 v[108:111], v4 offset:40960
    ds_read_b128 v[112:115], v4 offset:45056
    v_mfma_f32_16x16x32_bf16 v[68:71], v[136:139], v[128:131], v[68:71]
    v_mfma_f32_16x16x32_bf16 v[72:75], v[136:139], v[132:135], v[72:75]
    s_waitcnt lgkmcnt(6)
    v_mfma_f32_16x16x32_bf16 v[76:79], v[96:99], v[56:59], v[76:79]
    ds_read_b64_tr_b16 v[136:137], v7 offset:12288
    ds_read_b64_tr_b16 v[138:139], v7 offset:12800
    v_mfma_f32_16x16x32_bf16 v[60:63], v[96:99], v[80:83], v[60:63]
    ds_read_b128 v[120:123], v5 offset:32768
    ds_read_b128 v[124:127], v5 offset:36864
    v_mfma_f32_16x16x32_bf16 v[64:67], v[96:99], v[84:87], v[64:67]
    ds_read_b128 v[128:131], v5 offset:40960
    ds_read_b128 v[132:135], v5 offset:45056
    v_mfma_f32_16x16x32_bf16 v[68:71], v[96:99], v[88:91], v[68:71]
    v_mfma_f32_16x16x32_bf16 v[72:75], v[96:99], v[92:95], v[72:75]
    s_waitcnt lgkmcnt(6)
    v_mfma_f32_16x16x32_bf16 v[76:79], v[116:119], v[56:59], v[76:79]
    v_add_u32 v7, 131072, v6
    s_barrier
    ds_read_b64_tr_b16 v[96:97], v7 offset:0
    ds_read_b64_tr_b16 v[98:99], v7 offset:512
    v_mfma_f32_16x16x32_bf16 v[60:63], v[116:119], v[100:103], v[60:63]
    ds_read_b128 v[80:83], v2 offset:49152
    ds_read_b128 v[84:87], v2 offset:53248
    v_mfma_f32_16x16x32_bf16 v[64:67], v[116:119], v[104:107], v[64:67]
    ds_read_b128 v[88:91], v2 offset:57344
    ds_read_b128 v[92:95], v2 offset:61440
    v_mfma_f32_16x16x32_bf16 v[68:71], v[116:119], v[108:111], v[68:71]
    v_mfma_f32_16x16x32_bf16 v[72:75], v[116:119], v[112:115], v[72:75]
    s_waitcnt lgkmcnt(6)
    v_mfma_f32_16x16x32_bf16 v[76:79], v[136:139], v[56:59], v[76:79]
    ds_read_b64_tr_b16 v[116:117], v7 offset:4096
    ds_read_b64_tr_b16 v[118:119], v7 offset:4608
    v_mfma_f32_16x16x32_bf16 v[60:63], v[136:139], v[120:123], v[60:63]
    ds_read_b128 v[100:103], v3 offset:49152
    ds_read_b128 v[104:107], v3 offset:53248
    v_mfma_f32_16x16x32_bf16 v[64:67], v[136:139], v[124:127], v[64:67]
    ds_read_b128 v[108:111], v3 offset:57344
    ds_read_b128 v[112:115], v3 offset:61440
    v_mfma_f32_16x16x32_bf16 v[68:71], v[136:139], v[128:131], v[68:71]
    v_mfma_f32_16x16x32_bf16 v[72:75], v[136:139], v[132:135], v[72:75]
    s_waitcnt lgkmcnt(6)
    v_mfma_f32_16x16x32_bf16 v[76:79], v[96:99], v[56:59], v[76:79]
    ds_read_b64_tr_b16 v[136:137], v7 offset:8192
    ds_read_b64_tr_b16 v[138:139], v7 offset:8704
    v_mfma_f32_16x16x32_bf16 v[60:63], v[96:99], v[80:83], v[60:63]
    ds_read_b128 v[120:123], v4 offset:49152
    ds_read_b128 v[124:127], v4 offset:53248
    v_mfma_f32_16x16x32_bf16 v[64:67], v[96:99], v[84:87], v[64:67]
    ds_read_b128 v[128:131], v4 offset:57344
    ds_read_b128 v[132:135], v4 offset:61440
    v_mfma_f32_16x16x32_bf16 v[68:71], v[96:99], v[88:91], v[68:71]
    v_mfma_f32_16x16x32_bf16 v[72:75], v[96:99], v[92:95], v[72:75]
    s_waitcnt lgkmcnt(6)
    v_mfma_f32_16x16x32_bf16 v[76:79], v[116:119], v[56:59], v[76:79]
    ds_read_b64_tr_b16 v[96:97], v7 offset:12288
    ds_read_b64_tr_b16 v[98:99], v7 offset:12800
    v_mfma_f32_16x16x32_bf16 v[60:63], v[116:119], v[100:103], v[60:63]
    ds_read_b128 v[80:83], v5 offset:49152
    ds_read_b128 v[84:87], v5 offset:53248
    v_mfma_f32_16x16x32_bf16 v[64:67], v[116:119], v[104:107], v[64:67]
    ds_read_b128 v[88:91], v5 offset:57344
    ds_read_b128 v[92:95], v5 offset:61440
    v_mfma_f32_16x16x32_bf16 v[68:71], v[116:119], v[108:111], v[68:71]
    v_mfma_f32_16x16x32_bf16 v[72:75], v[116:119], v[112:115], v[72:75]
    s_waitcnt lgkmcnt(6)
    v_mfma_f32_16x16x32_bf16 v[76:79], v[136:139], v[56:59], v[76:79]
    v_mfma_f32_16x16x32_bf16 v[60:63], v[136:139], v[120:123], v[60:63]
    v_mfma_f32_16x16x32_bf16 v[64:67], v[136:139], v[124:127], v[64:67]
    v_mfma_f32_16x16x32_bf16 v[68:71], v[136:139], v[128:131], v[68:71]
    v_mfma_f32_16x16x32_bf16 v[72:75], v[136:139], v[132:135], v[72:75]
    s_waitcnt lgkmcnt(0)
    v_mfma_f32_16x16x32_bf16 v[76:79], v[96:99], v[56:59], v[76:79]
    v_mfma_f32_16x16x32_bf16 v[60:63], v[96:99], v[80:83], v[60:63]
    v_mfma_f32_16x16x32_bf16 v[64:67], v[96:99], v[84:87], v[64:67]
    v_mfma_f32_16x16x32_bf16 v[68:71], v[96:99], v[88:91], v[68:71]
    v_mfma_f32_16x16x32_bf16 v[72:75], v[96:99], v[92:95], v[72:75]
    s_barrier
    s_nop 3
    v_pk_fma_f32 v[60:61], v[76:77], v[40:41], v[60:61] op_sel_hi:[1,0,1]
    v_pk_fma_f32 v[62:63], v[78:79], v[40:41], v[62:63] op_sel_hi:[1,0,1]
    v_pk_fma_f32 v[64:65], v[76:77], v[44:45], v[64:65] op_sel_hi:[1,0,1]
    v_pk_fma_f32 v[66:67], v[78:79], v[44:45], v[66:67] op_sel_hi:[1,0,1]
    v_pk_fma_f32 v[68:69], v[76:77], v[48:49], v[68:69] op_sel_hi:[1,0,1]
    v_pk_fma_f32 v[70:71], v[78:79], v[48:49], v[70:71] op_sel_hi:[1,0,1]
    v_pk_fma_f32 v[72:73], v[76:77], v[52:53], v[72:73] op_sel_hi:[1,0,1]
    v_pk_fma_f32 v[74:75], v[78:79], v[52:53], v[74:75] op_sel_hi:[1,0,1]
    v_pk_mul_f32 v[100:101], v[60:61], v[42:43] op_sel_hi:[1,0]
    v_pk_mul_f32 v[102:103], v[62:63], v[42:43] op_sel_hi:[1,0]
    v_pk_mul_f32 v[104:105], v[64:65], v[46:47] op_sel_hi:[1,0]
    v_pk_mul_f32 v[106:107], v[66:67], v[46:47] op_sel_hi:[1,0]
    v_pk_mul_f32 v[108:109], v[68:69], v[50:51] op_sel_hi:[1,0]
    v_pk_mul_f32 v[110:111], v[70:71], v[50:51] op_sel_hi:[1,0]
    v_pk_mul_f32 v[112:113], v[72:73], v[54:55] op_sel_hi:[1,0]
    v_pk_mul_f32 v[114:115], v[74:75], v[54:55] op_sel_hi:[1,0]
    v_pk_fma_f32 v[60:61], v[60:61], v[40:41], s[80:81] op_sel:[0,1,0] op_sel_hi:[1,1,1]
    v_pk_fma_f32 v[62:63], v[62:63], v[40:41], s[80:81] op_sel:[0,1,0] op_sel_hi:[1,1,1]
    v_pk_fma_f32 v[64:65], v[64:65], v[44:45], s[80:81] op_sel:[0,1,0] op_sel_hi:[1,1,1]
    v_pk_fma_f32 v[66:67], v[66:67], v[44:45], s[80:81] op_sel:[0,1,0] op_sel_hi:[1,1,1]
    v_pk_fma_f32 v[68:69], v[68:69], v[48:49], s[80:81] op_sel:[0,1,0] op_sel_hi:[1,1,1]
    v_pk_fma_f32 v[70:71], v[70:71], v[48:49], s[80:81] op_sel:[0,1,0] op_sel_hi:[1,1,1]
    v_pk_fma_f32 v[72:73], v[72:73], v[52:53], s[80:81] op_sel:[0,1,0] op_sel_hi:[1,1,1]
    v_pk_fma_f32 v[74:75], v[74:75], v[52:53], s[80:81] op_sel:[0,1,0] op_sel_hi:[1,1,1]
    v_exp_f32_e64 v100, v100 clamp
    v_exp_f32_e64 v101, v101 clamp
    v_exp_f32_e64 v102, v102 clamp
    v_exp_f32_e64 v103, v103 clamp
    v_exp_f32_e64 v104, v104 clamp
    v_exp_f32_e64 v105, v105 clamp
    v_exp_f32_e64 v106, v106 clamp
    v_exp_f32_e64 v107, v107 clamp
    v_exp_f32_e64 v108, v108 clamp
    v_exp_f32_e64 v109, v109 clamp
    v_exp_f32_e64 v110, v110 clamp
    v_exp_f32_e64 v111, v111 clamp
    v_exp_f32_e64 v112, v112 clamp
    v_exp_f32_e64 v113, v113 clamp
    v_exp_f32_e64 v114, v114 clamp
    v_exp_f32_e64 v115, v115 clamp
    v_max_f32_e64 v60, v60, s80
    v_max_f32_e64 v61, v61, s80
    v_max_f32_e64 v62, v62, s80
    v_max_f32_e64 v63, v63, s80
    v_max_f32_e64 v64, v64, s80
    v_max_f32_e64 v65, v65, s80
    v_max_f32_e64 v66, v66, s80
    v_max_f32_e64 v67, v67, s80
    v_max_f32_e64 v68, v68, s80
    v_max_f32_e64 v69, v69, s80
    v_max_f32_e64 v70, v70, s80
    v_max_f32_e64 v71, v71, s80
    v_max_f32_e64 v72, v72, s80
    v_max_f32_e64 v73, v73, s80
    v_max_f32_e64 v74, v74, s80
    v_max_f32_e64 v75, v75, s80
    v_pk_add_f32 v[60:61], v[60:61], v[100:101]
    v_pk_add_f32 v[62:63], v[62:63], v[102:103]
    v_pk_add_f32 v[64:65], v[64:65], v[104:105]
    v_pk_add_f32 v[66:67], v[66:67], v[106:107]
    v_pk_add_f32 v[68:69], v[68:69], v[108:109]
    v_pk_add_f32 v[70:71], v[70:71], v[110:111]
    v_pk_add_f32 v[72:73], v[72:73], v[112:113]
    v_pk_add_f32 v[74:75], v[74:75], v[114:115]
    v_cvt_pk_bf16_f32 v116, v60, v61
    v_cvt_pk_bf16_f32 v117, v62, v63
    v_cvt_pk_bf16_f32 v118, v64, v65
    v_cvt_pk_bf16_f32 v119, v66, v67
    v_cvt_pk_bf16_f32 v120, v68, v69
    v_cvt_pk_bf16_f32 v121, v70, v71
    v_cvt_pk_bf16_f32 v122, v72, v73
    v_cvt_pk_bf16_f32 v123, v74, v75
    s_lshl_b32 s73, s70, 11
    s_add_u32 s73, s73, 147456
    v_lshlrev_b32 v80, 3, v0
    v_add_u32 v80, s73, v80
    ds_write_b64 v80, v[116:117] offset:0
    ds_write_b64 v80, v[118:119] offset:512
    ds_write_b64 v80, v[120:121] offset:1024
    ds_write_b64 v80, v[122:123] offset:1536
    s_lshl_b32 s73, s71, 10
    v_add_u32 v2, s73, v22
    s_lshl_b32 s75, s72, 15
    v_add_u32 v5, s75, v2
    s_and_b32 s76, s69, 1
    s_lshl_b32 s77, s76, 5
    s_lshl_b32 s73, s72, 5
    s_add_u32 s73, s73, s77
    s_lshl_b32 s73, s73, 2
    s_add_u32 s73, s73, 157696
    v_lshrrev_b32 v81, 5, v0
    v_lshlrev_b32 v81, 4, v81
    v_add_u32 v3, s73, v81
    s_cmp_eq_u32 s76, 0
    s_cselect_b32 s78, 192, 0
    s_lshl_b32 s73, s72, 4
    s_add_u32 s73, s73, s78
    s_lshl_b32 s73, s73, 2
    s_add_u32 s73, s73, 157696
    v_add_u32 v4, s73, v81
    s_lshl_b32 s73, s72, 5
    v_xor_b32 v6, s73, v14
    v_xor_b32 v7, s73, v15
    v_and_b32 v1, 31, v0
    v_lshlrev_b32 v1, 4, v1
    s_lshl_b32 s73, s71, 9
    s_add_u32 s73, s73, 156672
    v_add_u32 v1, s73, v1
    s_mul_i32 s73, s69, 14
    s_lshr_b32 s77, s77, 4
    s_lshl_b32 s75, s72, 1
    s_add_u32 s86, s73, s77
    s_add_u32 s86, s86, s75
    s_lshl_b32 s86, s86, 11
    s_add_u32 s86, s86, s88
    s_lshr_b32 s78, s78, 4
    s_add_u32 s87, s73, s78
    s_add_u32 s87, s87, s72
    s_lshl_b32 s87, s87, 11
    s_add_u32 s87, s87, s88
    s_waitcnt lgkmcnt(0)
    s_barrier
    v_add_u32 v16, 65536, v14
    v_add_u32 v17, 65536, v15
    s_barrier
    ds_read_b64_tr_b16 v[60:61], v16 offset:0
    ds_read_b64_tr_b16 v[62:63], v17 offset:0
    ds_read_b128 v[128:131], v2 offset:0
    ds_read_b64_tr_b16 v[64:65], v16 offset:2048
    ds_read_b64_tr_b16 v[66:67], v17 offset:2048
    ds_read_b128 v[132:135], v2 offset:2048
    s_waitcnt lgkmcnt(0)
    v_mfma_f32_32x32x16_bf16 v[84:99], v[60:63], v[128:131], 0
    ds_read_b64_tr_b16 v[68:69], v16 offset:4096
    ds_read_b64_tr_b16 v[70:71], v17 offset:4096
    ds_read_b128 v[136:139], v2 offset:4096
    ds_read_b64_tr_b16 v[72:73], v16 offset:6144
    ds_read_b64_tr_b16 v[74:75], v17 offset:6144
    ds_read_b128 v[140:143], v2 offset:6144
    v_mfma_f32_32x32x16_bf16 v[84:99], v[64:67], v[132:135], v[84:99]
    ds_read_b64_tr_b16 v[76:77], v16 offset:8192
    ds_read_b64_tr_b16 v[78:79], v17 offset:8192
    ds_read_b128 v[144:147], v2 offset:8192
    ds_read_b64_tr_b16 v[80:81], v16 offset:10240
    ds_read_b64_tr_b16 v[82:83], v17 offset:10240
    ds_read_b128 v[148:151], v2 offset:10240
    s_waitcnt lgkmcnt(6)
    v_mfma_f32_32x32x16_bf16 v[84:99], v[68:71], v[136:139], v[84:99]
    ds_read_b64_tr_b16 v[60:61], v16 offset:12288
    ds_read_b64_tr_b16 v[62:63], v17 offset:12288
    ds_read_b128 v[152:155], v2 offset:12288
    v_mfma_f32_32x32x16_bf16 v[84:99], v[72:75], v[140:143], v[84:99]
    ds_read_b64_tr_b16 v[64:65], v16 offset:14336
    ds_read_b64_tr_b16 v[66:67], v17 offset:14336
    ds_read_b128 v[156:159], v2 offset:14336
    s_waitcnt lgkmcnt(6)
    v_mfma_f32_32x32x16_bf16 v[84:99], v[76:79], v[144:147], v[84:99]
    v_add_u32 v16, 81920, v14
    v_add_u32 v17, 81920, v15
    s_barrier
    ds_read_b64_tr_b16 v[68:69], v16 offset:0
    ds_read_b64_tr_b16 v[70:71], v17 offset:0
    ds_read_b128 v[160:163], v2 offset:16384
    v_mfma_f32_32x32x16_bf16 v[84:99], v[80:83], v[148:151], v[84:99]
    ds_read_b64_tr_b16 v[72:73], v16 offset:2048
    ds_read_b64_tr_b16 v[74:75], v17 offset:2048
    ds_read_b128 v[164:167], v2 offset:18432
    s_waitcnt lgkmcnt(6)
    v_mfma_f32_32x32x16_bf16 v[84:99], v[60:63], v[152:155], v[84:99]
    ds_read_b64_tr_b16 v[76:77], v16 offset:4096
    ds_read_b64_tr_b16 v[78:79], v17 offset:4096
    ds_read_b128 v[168:171], v2 offset:20480
    v_mfma_f32_32x32x16_bf16 v[84:99], v[64:67], v[156:159], v[84:99]
    ds_read_b64_tr_b16 v[80:81], v16 offset:6144
    ds_read_b64_tr_b16 v[82:83], v17 offset:6144
    ds_read_b128 v[172:175], v2 offset:22528
    s_waitcnt lgkmcnt(6)
    v_mfma_f32_32x32x16_bf16 v[84:99], v[68:71], v[160:163], v[84:99]
    ds_read_b64_tr_b16 v[60:61], v16 offset:8192
    ds_read_b64_tr_b16 v[62:63], v17 offset:8192
    ds_read_b128 v[176:179], v2 offset:24576
    v_mfma_f32_32x32x16_bf16 v[84:99], v[72:75], v[164:167], v[84:99]
    ds_read_b64_tr_b16 v[64:65], v16 offset:10240
    ds_read_b64_tr_b16 v[66:67], v17 offset:10240
    ds_read_b128 v[180:183], v2 offset:26624
    s_waitcnt lgkmcnt(6)
    v_mfma_f32_32x32x16_bf16 v[84:99], v[76:79], v[168:171], v[84:99]
    ds_read_b64_tr_b16 v[68:69], v16 offset:12288
    ds_read_b64_tr_b16 v[70:71], v17 offset:12288
    ds_read_b128 v[184:187], v2 offset:28672
    v_mfma_f32_32x32x16_bf16 v[84:99], v[80:83], v[172:175], v[84:99]
    ds_read_b64_tr_b16 v[72:73], v16 offset:14336
    ds_read_b64_tr_b16 v[74:75], v17 offset:14336
    ds_read_b128 v[188:191], v2 offset:30720
    s_waitcnt lgkmcnt(6)
    v_mfma_f32_32x32x16_bf16 v[84:99], v[60:63], v[176:179], v[84:99]
    v_add_u32 v16, 98304, v14
    v_add_u32 v17, 98304, v15
    s_barrier
    ds_read_b64_tr_b16 v[76:77], v16 offset:0
    ds_read_b64_tr_b16 v[78:79], v17 offset:0
    ds_read_b128 v[192:195], v2 offset:32768
    v_mfma_f32_32x32x16_bf16 v[84:99], v[64:67], v[180:183], v[84:99]
    ds_read_b64_tr_b16 v[80:81], v16 offset:2048
    ds_read_b64_tr_b16 v[82:83], v17 offset:2048
    ds_read_b128 v[196:199], v2 offset:34816
    s_waitcnt lgkmcnt(6)
    v_mfma_f32_32x32x16_bf16 v[84:99], v[68:71], v[184:187], v[84:99]
    ds_read_b64_tr_b16 v[60:61], v16 offset:4096
    ds_read_b64_tr_b16 v[62:63], v17 offset:4096
    ds_read_b128 v[200:203], v2 offset:36864
    v_mfma_f32_32x32x16_bf16 v[84:99], v[72:75], v[188:191], v[84:99]
    ds_read_b64_tr_b16 v[64:65], v16 offset:6144
    ds_read_b64_tr_b16 v[66:67], v17 offset:6144
    ds_read_b128 v[204:207], v2 offset:38912
    s_waitcnt lgkmcnt(6)
    v_mfma_f32_32x32x16_bf16 v[84:99], v[76:79], v[192:195], v[84:99]
    ds_read_b64_tr_b16 v[68:69], v16 offset:8192
    ds_read_b64_tr_b16 v[70:71], v17 offset:8192
    ds_read_b128 v[208:211], v2 offset:40960
    v_mfma_f32_32x32x16_bf16 v[84:99], v[80:83], v[196:199], v[84:99]
    ds_read_b64_tr_b16 v[72:73], v16 offset:10240
    ds_read_b64_tr_b16 v[74:75], v17 offset:10240
    ds_read_b128 v[212:215], v2 offset:43008
    s_waitcnt lgkmcnt(6)
    v_mfma_f32_32x32x16_bf16 v[84:99], v[60:63], v[200:203], v[84:99]
    ds_read_b64_tr_b16 v[76:77], v16 offset:12288
    ds_read_b64_tr_b16 v[78:79], v17 offset:12288
    ds_read_b128 v[216:219], v2 offset:45056
    v_mfma_f32_32x32x16_bf16 v[84:99], v[64:67], v[204:207], v[84:99]
    ds_read_b64_tr_b16 v[80:81], v16 offset:14336
    ds_read_b64_tr_b16 v[82:83], v17 offset:14336
    ds_read_b128 v[220:223], v2 offset:47104
    s_waitcnt lgkmcnt(6)
    v_mfma_f32_32x32x16_bf16 v[84:99], v[68:71], v[208:211], v[84:99]
    v_add_u32 v16, 114688, v14
    v_add_u32 v17, 114688, v15
    s_barrier
    ds_read_b64_tr_b16 v[60:61], v16 offset:0
    ds_read_b64_tr_b16 v[62:63], v17 offset:0
    ds_read_b128 v[224:227], v2 offset:49152
    v_mfma_f32_32x32x16_bf16 v[84:99], v[72:75], v[212:215], v[84:99]
    ds_read_b64_tr_b16 v[64:65], v16 offset:2048
    ds_read_b64_tr_b16 v[66:67], v17 offset:2048
    ds_read_b128 v[228:231], v2 offset:51200
    s_waitcnt lgkmcnt(6)
    v_mfma_f32_32x32x16_bf16 v[84:99], v[76:79], v[216:219], v[84:99]
    ds_read_b64_tr_b16 v[68:69], v16 offset:4096
    ds_read_b64_tr_b16 v[70:71], v17 offset:4096
    ds_read_b128 v[232:235], v2 offset:53248
    v_mfma_f32_32x32x16_bf16 v[84:99], v[80:83], v[220:223], v[84:99]
    ds_read_b64_tr_b16 v[72:73], v16 offset:6144
    ds_read_b64_tr_b16 v[74:75], v17 offset:6144
    ds_read_b128 v[236:239], v2 offset:55296
    s_waitcnt lgkmcnt(6)
    v_mfma_f32_32x32x16_bf16 v[84:99], v[60:63], v[224:227], v[84:99]
    ds_read_b64_tr_b16 v[76:77], v16 offset:8192
    ds_read_b64_tr_b16 v[78:79], v17 offset:8192
    ds_read_b128 v[240:243], v2 offset:57344
    v_mfma_f32_32x32x16_bf16 v[84:99], v[64:67], v[228:231], v[84:99]
    ds_read_b64_tr_b16 v[80:81], v16 offset:10240
    ds_read_b64_tr_b16 v[82:83], v17 offset:10240
    ds_read_b128 v[244:247], v2 offset:59392
    s_waitcnt lgkmcnt(6)
    v_mfma_f32_32x32x16_bf16 v[84:99], v[68:71], v[232:235], v[84:99]
    ds_read_b64_tr_b16 v[60:61], v16 offset:12288
    ds_read_b64_tr_b16 v[62:63], v17 offset:12288
    ds_read_b128 v[248:251], v2 offset:61440
    v_mfma_f32_32x32x16_bf16 v[84:99], v[72:75], v[236:239], v[84:99]
    ds_read_b64_tr_b16 v[64:65], v16 offset:14336
    ds_read_b64_tr_b16 v[66:67], v17 offset:14336
    ds_read_b128 v[252:255], v2 offset:63488
    s_waitcnt lgkmcnt(6)
    v_mfma_f32_32x32x16_bf16 v[84:99], v[76:79], v[240:243], v[84:99]
    s_waitcnt lgkmcnt(0)
    v_add_u32 v16, 131072, v6
    v_add_u32 v17, 131072, v7
    s_barrier
    ds_read_b64_tr_b16 v[68:69], v16 offset:0
    ds_read_b64_tr_b16 v[70:71], v17 offset:0
    v_mfma_f32_32x32x16_bf16 v[84:99], v[80:83], v[244:247], v[84:99]
    ds_read_b64_tr_b16 v[72:73], v16 offset:2048
    ds_read_b64_tr_b16 v[74:75], v17 offset:2048
    v_mfma_f32_32x32x16_bf16 v[84:99], v[60:63], v[248:251], v[84:99]
    ds_read_b64_tr_b16 v[76:77], v16 offset:4096
    ds_read_b64_tr_b16 v[78:79], v17 offset:4096
    ds_read_b64_tr_b16 v[80:81], v16 offset:6144
    ds_read_b64_tr_b16 v[82:83], v17 offset:6144
    ds_read_b128 v[40:43], v1
    v_mfma_f32_32x32x16_bf16 v[84:99], v[64:67], v[252:255], v[84:99]
    ds_read_b128 v[112:115], v3 offset:0
    ds_read_b128 v[116:119], v3 offset:32
    ds_read_b128 v[120:123], v3 offset:64
    ds_read_b128 v[124:127], v3 offset:96
    s_waitcnt lgkmcnt(0)
    s_nop 6
    v_pk_fma_f32 v[84:85], v[112:113], v[40:41], v[84:85] op_sel:[0,0,0] op_sel_hi:[1,0,1]
    v_pk_fma_f32 v[86:87], v[114:115], v[40:41], v[86:87] op_sel:[0,0,0] op_sel_hi:[1,0,1]
    v_pk_fma_f32 v[88:89], v[116:117], v[40:41], v[88:89] op_sel:[0,0,0] op_sel_hi:[1,0,1]
    v_pk_fma_f32 v[90:91], v[118:119], v[40:41], v[90:91] op_sel:[0,0,0] op_sel_hi:[1,0,1]
    v_pk_fma_f32 v[92:93], v[120:121], v[40:41], v[92:93] op_sel:[0,0,0] op_sel_hi:[1,0,1]
    v_pk_fma_f32 v[94:95], v[122:123], v[40:41], v[94:95] op_sel:[0,0,0] op_sel_hi:[1,0,1]
    v_pk_fma_f32 v[96:97], v[124:125], v[40:41], v[96:97] op_sel:[0,0,0] op_sel_hi:[1,0,1]
    v_pk_fma_f32 v[98:99], v[126:127], v[40:41], v[98:99] op_sel:[0,0,0] op_sel_hi:[1,0,1]
    v_pk_mul_f32 v[44:45], v[84:85], v[84:85]
    v_pk_mul_f32 v[46:47], v[86:87], v[86:87]
    v_pk_mul_f32 v[48:49], v[88:89], v[88:89]
    v_pk_mul_f32 v[50:51], v[90:91], v[90:91]
    v_pk_mul_f32 v[52:53], v[92:93], v[92:93]
    v_pk_mul_f32 v[54:55], v[94:95], v[94:95]
    v_pk_mul_f32 v[56:57], v[96:97], v[96:97]
    v_pk_mul_f32 v[58:59], v[98:99], v[98:99]
    v_pk_fma_f32 v[44:45], v[44:45], v[42:43], v[40:41] op_sel:[0,0,1] op_sel_hi:[1,0,1]
    v_pk_fma_f32 v[46:47], v[46:47], v[42:43], v[40:41] op_sel:[0,0,1] op_sel_hi:[1,0,1]
    v_pk_fma_f32 v[48:49], v[48:49], v[42:43], v[40:41] op_sel:[0,0,1] op_sel_hi:[1,0,1]
    v_pk_fma_f32 v[50:51], v[50:51], v[42:43], v[40:41] op_sel:[0,0,1] op_sel_hi:[1,0,1]
    v_pk_fma_f32 v[52:53], v[52:53], v[42:43], v[40:41] op_sel:[0,0,1] op_sel_hi:[1,0,1]
    v_pk_fma_f32 v[54:55], v[54:55], v[42:43], v[40:41] op_sel:[0,0,1] op_sel_hi:[1,0,1]
    v_pk_fma_f32 v[56:57], v[56:57], v[42:43], v[40:41] op_sel:[0,0,1] op_sel_hi:[1,0,1]
    v_pk_fma_f32 v[58:59], v[58:59], v[42:43], v[40:41] op_sel:[0,0,1] op_sel_hi:[1,0,1]
    v_pk_mul_f32 v[44:45], v[44:45], v[84:85]
    v_pk_mul_f32 v[46:47], v[46:47], v[86:87]
    v_pk_mul_f32 v[48:49], v[48:49], v[88:89]
    v_pk_mul_f32 v[50:51], v[50:51], v[90:91]
    v_pk_mul_f32 v[52:53], v[52:53], v[92:93]
    v_pk_mul_f32 v[54:55], v[54:55], v[94:95]
    v_pk_mul_f32 v[56:57], v[56:57], v[96:97]
    v_pk_mul_f32 v[58:59], v[58:59], v[98:99]
    v_exp_f32_e64 v44, v44
    v_exp_f32_e64 v45, v45
    v_exp_f32_e64 v46, v46
    v_exp_f32_e64 v47, v47
    v_exp_f32_e64 v48, v48
    v_exp_f32_e64 v49, v49
    v_exp_f32_e64 v50, v50
    v_exp_f32_e64 v51, v51
    v_exp_f32_e64 v52, v52
    v_exp_f32_e64 v53, v53
    v_exp_f32_e64 v54, v54
    v_exp_f32_e64 v55, v55
    v_exp_f32_e64 v56, v56
    v_exp_f32_e64 v57, v57
    v_exp_f32_e64 v58, v58
    v_exp_f32_e64 v59, v59
    v_pk_fma_f32 v[44:45], v[44:45], v[42:43], v[42:43] op_sel:[0,1,1] op_sel_hi:[1,1,1]
    v_pk_fma_f32 v[46:47], v[46:47], v[42:43], v[42:43] op_sel:[0,1,1] op_sel_hi:[1,1,1]
    v_pk_fma_f32 v[48:49], v[48:49], v[42:43], v[42:43] op_sel:[0,1,1] op_sel_hi:[1,1,1]
    v_pk_fma_f32 v[50:51], v[50:51], v[42:43], v[42:43] op_sel:[0,1,1] op_sel_hi:[1,1,1]
    v_pk_fma_f32 v[52:53], v[52:53], v[42:43], v[42:43] op_sel:[0,1,1] op_sel_hi:[1,1,1]
    v_pk_fma_f32 v[54:55], v[54:55], v[42:43], v[42:43] op_sel:[0,1,1] op_sel_hi:[1,1,1]
    v_pk_fma_f32 v[56:57], v[56:57], v[42:43], v[42:43] op_sel:[0,1,1] op_sel_hi:[1,1,1]
    v_pk_fma_f32 v[58:59], v[58:59], v[42:43], v[42:43] op_sel:[0,1,1] op_sel_hi:[1,1,1]
    v_rcp_f32_e64 v44, v44
    v_rcp_f32_e64 v45, v45
    v_rcp_f32_e64 v46, v46
    v_rcp_f32_e64 v47, v47
    v_rcp_f32_e64 v48, v48
    v_rcp_f32_e64 v49, v49
    v_rcp_f32_e64 v50, v50
    v_rcp_f32_e64 v51, v51
    v_rcp_f32_e64 v52, v52
    v_rcp_f32_e64 v53, v53
    v_rcp_f32_e64 v54, v54
    v_rcp_f32_e64 v55, v55
    v_rcp_f32_e64 v56, v56
    v_rcp_f32_e64 v57, v57
    v_rcp_f32_e64 v58, v58
    v_rcp_f32_e64 v59, v59
    v_pk_mul_f32 v[44:45], v[44:45], v[84:85]
    v_pk_mul_f32 v[46:47], v[46:47], v[86:87]
    v_pk_mul_f32 v[48:49], v[48:49], v[88:89]
    v_pk_mul_f32 v[50:51], v[50:51], v[90:91]
    v_pk_mul_f32 v[52:53], v[52:53], v[92:93]
    v_pk_mul_f32 v[54:55], v[54:55], v[94:95]
    v_pk_mul_f32 v[56:57], v[56:57], v[96:97]
    v_pk_mul_f32 v[58:59], v[58:59], v[98:99]
    v_cvt_pk_bf16_f32 v84, v44, v45
    v_cvt_pk_bf16_f32 v85, v46, v47
    v_cvt_pk_bf16_f32 v86, v48, v49
    v_cvt_pk_bf16_f32 v87, v50, v51
    v_cvt_pk_bf16_f32 v92, v52, v53
    v_cvt_pk_bf16_f32 v93, v54, v55
    v_cvt_pk_bf16_f32 v94, v56, v57
    v_cvt_pk_bf16_f32 v95, v58, v59
    s_cmp_lg_u32 s72, 0
    s_cbranch_scc1 L_hf1
    v_mfma_f32_32x32x16_bf16 v[100:115], v[68:71], v[128:131], 0
    buffer_store_dwordx4 v[84:87], v21, s[60:63], s86 offen offset:0 sc1
    ds_read_b64_tr_b16 v[60:61], v16 offset:8192
    ds_read_b64_tr_b16 v[62:63], v17 offset:8192
    v_mfma_f32_32x32x16_bf16 v[100:115], v[72:75], v[132:135], v[100:115]
    buffer_store_dwordx4 v[92:95], v21, s[60:63], s86 offen offset:2048 sc1
    s_add_u32 s86, s86, 8192
    ds_read_b64_tr_b16 v[64:65], v16 offset:10240
    ds_read_b64_tr_b16 v[66:67], v17 offset:10240
    v_mfma_f32_32x32x16_bf16 v[100:115], v[76:79], v[136:139], v[100:115]
    ds_read_b64_tr_b16 v[68:69], v16 offset:12288
    ds_read_b64_tr_b16 v[70:71], v17 offset:12288
    v_mfma_f32_32x32x16_bf16 v[100:115], v[80:83], v[140:143], v[100:115]
    ds_read_b64_tr_b16 v[72:73], v16 offset:14336
    ds_read_b64_tr_b16 v[74:75], v17 offset:14336
    s_waitcnt lgkmcnt(4)
    v_mfma_f32_32x32x16_bf16 v[100:115], v[60:63], v[144:147], v[100:115]
    v_add_u32 v16, 65536, v6
    v_add_u32 v17, 65536, v7
    s_barrier
    ds_read_b64_tr_b16 v[76:77], v16 offset:0
    ds_read_b64_tr_b16 v[78:79], v17 offset:0
    v_mfma_f32_32x32x16_bf16 v[100:115], v[64:67], v[148:151], v[100:115]
    ds_read_b64_tr_b16 v[80:81], v16 offset:2048
    ds_read_b64_tr_b16 v[82:83], v17 offset:2048
    s_waitcnt lgkmcnt(4)
    v_mfma_f32_32x32x16_bf16 v[100:115], v[68:71], v[152:155], v[100:115]
    ds_read_b64_tr_b16 v[60:61], v16 offset:4096
    ds_read_b64_tr_b16 v[62:63], v17 offset:4096
    v_mfma_f32_32x32x16_bf16 v[100:115], v[72:75], v[156:159], v[100:115]
    ds_read_b64_tr_b16 v[64:65], v16 offset:6144
    ds_read_b64_tr_b16 v[66:67], v17 offset:6144
    s_waitcnt lgkmcnt(4)
    v_mfma_f32_32x32x16_bf16 v[100:115], v[76:79], v[160:163], v[100:115]
    ds_read_b64_tr_b16 v[68:69], v16 offset:8192
    ds_read_b64_tr_b16 v[70:71], v17 offset:8192
    v_mfma_f32_32x32x16_bf16 v[100:115], v[80:83], v[164:167], v[100:115]
    ds_read_b64_tr_b16 v[72:73], v16 offset:10240
    ds_read_b64_tr_b16 v[74:75], v17 offset:10240
    s_waitcnt lgkmcnt(4)
    v_mfma_f32_32x32x16_bf16 v[100:115], v[60:63], v[168:171], v[100:115]
    ds_read_b64_tr_b16 v[76:77], v16 offset:12288
    ds_read_b64_tr_b16 v[78:79], v17 offset:12288
    v_mfma_f32_32x32x16_bf16 v[100:115], v[64:67], v[172:175], v[100:115]
    ds_read_b64_tr_b16 v[80:81], v16 offset:14336
    ds_read_b64_tr_b16 v[82:83], v17 offset:14336
    s_waitcnt lgkmcnt(4)
    v_mfma_f32_32x32x16_bf16 v[100:115], v[68:71], v[176:179], v[100:115]
    v_add_u32 v16, 81920, v14
    v_add_u32 v17, 81920, v15
    s_barrier
    ds_read_b64_tr_b16 v[60:61], v16 offset:0
    ds_read_b64_tr_b16 v[62:63], v17 offset:0
    v_mfma_f32_32x32x16_bf16 v[100:115], v[72:75], v[180:183], v[100:115]
    ds_read_b64_tr_b16 v[64:65], v16 offset:2048
    ds_read_b64_tr_b16 v[66:67], v17 offset:2048
    s_waitcnt lgkmcnt(4)
    v_mfma_f32_32x32x16_bf16 v[100:115], v[76:79], v[184:187], v[100:115]
    ds_read_b64_tr_b16 v[68:69], v16 offset:4096
    ds_read_b64_tr_b16 v[70:71], v17 offset:4096
    v_mfma_f32_32x32x16_bf16 v[100:115], v[80:83], v[188:191], v[100:115]
    ds_read_b64_tr_b16 v[72:73], v16 offset:6144
    ds_read_b64_tr_b16 v[74:75], v17 offset:6144
    s_branch L_hf2
L_hf1:
    v_mfma_f32_32x32x16_bf16 v[100:115], v[68:71], v[192:195], 0
    buffer_store_dwordx4 v[84:87], v21, s[60:63], s86 offen offset:0 sc1
    ds_read_b64_tr_b16 v[60:61], v16 offset:8192
    ds_read_b64_tr_b16 v[62:63], v17 offset:8192
    v_mfma_f32_32x32x16_bf16 v[100:115], v[72:75], v[196:199], v[100:115]
    buffer_store_dwordx4 v[92:95], v21, s[60:63], s86 offen offset:2048 sc1
    s_add_u32 s86, s86, 8192
    ds_read_b64_tr_b16 v[64:65], v16 offset:10240
    ds_read_b64_tr_b16 v[66:67], v17 offset:10240
    v_mfma_f32_32x32x16_bf16 v[100:115], v[76:79], v[200:203], v[100:115]
    ds_read_b64_tr_b16 v[68:69], v16 offset:12288
    ds_read_b64_tr_b16 v[70:71], v17 offset:12288
    v_mfma_f32_32x32x16_bf16 v[100:115], v[80:83], v[204:207], v[100:115]
    ds_read_b64_tr_b16 v[72:73], v16 offset:14336
    ds_read_b64_tr_b16 v[74:75], v17 offset:14336
    s_waitcnt lgkmcnt(4)
    v_mfma_f32_32x32x16_bf16 v[100:115], v[60:63], v[208:211], v[100:115]
    v_add_u32 v16, 65536, v6
    v_add_u32 v17, 65536, v7
    s_barrier
    ds_read_b64_tr_b16 v[76:77], v16 offset:0
    ds_read_b64_tr_b16 v[78:79], v17 offset:0
    v_mfma_f32_32x32x16_bf16 v[100:115], v[64:67], v[212:215], v[100:115]
    ds_read_b64_tr_b16 v[80:81], v16 offset:2048
    ds_read_b64_tr_b16 v[82:83], v17 offset:2048
    s_waitcnt lgkmcnt(4)
    v_mfma_f32_32x32x16_bf16 v[100:115], v[68:71], v[216:219], v[100:115]
    ds_read_b64_tr_b16 v[60:61], v16 offset:4096
    ds_read_b64_tr_b16 v[62:63], v17 offset:4096
    v_mfma_f32_32x32x16_bf16 v[100:115], v[72:75], v[220:223], v[100:115]
    ds_read_b64_tr_b16 v[64:65], v16 offset:6144
    ds_read_b64_tr_b16 v[66:67], v17 offset:6144
    s_waitcnt lgkmcnt(4)
    v_mfma_f32_32x32x16_bf16 v[100:115], v[76:79], v[224:227], v[100:115]
    ds_read_b64_tr_b16 v[68:69], v16 offset:8192
    ds_read_b64_tr_b16 v[70:71], v17 offset:8192
    v_mfma_f32_32x32x16_bf16 v[100:115], v[80:83], v[228:231], v[100:115]
    ds_read_b64_tr_b16 v[72:73], v16 offset:10240
    ds_read_b64_tr_b16 v[74:75], v17 offset:10240
    s_waitcnt lgkmcnt(4)
    v_mfma_f32_32x32x16_bf16 v[100:115], v[60:63], v[232:235], v[100:115]
    ds_read_b64_tr_b16 v[76:77], v16 offset:12288
    ds_read_b64_tr_b16 v[78:79], v17 offset:12288
    v_mfma_f32_32x32x16_bf16 v[100:115], v[64:67], v[236:239], v[100:115]
    ds_read_b64_tr_b16 v[80:81], v16 offset:14336
    ds_read_b64_tr_b16 v[82:83], v17 offset:14336
    s_waitcnt lgkmcnt(4)
    v_mfma_f32_32x32x16_bf16 v[100:115], v[68:71], v[240:243], v[100:115]
    v_add_u32 v16, 81920, v14
    v_add_u32 v17, 81920, v15
    s_barrier
    ds_read_b64_tr_b16 v[60:61], v16 offset:0
    ds_read_b64_tr_b16 v[62:63], v17 offset:0
    v_mfma_f32_32x32x16_bf16 v[100:115], v[72:75], v[244:247], v[100:115]
    ds_read_b64_tr_b16 v[64:65], v16 offset:2048
    ds_read_b64_tr_b16 v[66:67], v17 offset:2048
    s_waitcnt lgkmcnt(4)
    v_mfma_f32_32x32x16_bf16 v[100:115], v[76:79], v[248:251], v[100:115]
    ds_read_b64_tr_b16 v[68:69], v16 offset:4096
    ds_read_b64_tr_b16 v[70:71], v17 offset:4096
    v_mfma_f32_32x32x16_bf16 v[100:115], v[80:83], v[252:255], v[100:115]
    ds_read_b64_tr_b16 v[72:73], v16 offset:6144
    ds_read_b64_tr_b16 v[74:75], v17 offset:6144
L_hf2:
    s_lshl_b32 s73, s70, 11
    s_add_u32 s73, s73, 147456
    v_add_u32 v44, s73, v22
    s_nop 6
    ds_write_b128 v44, v[108:111]
    ds_write_b128 v44, v[112:115] offset:1024
    v_xor_b32 v5, 4096, v44
    s_waitcnt lgkmcnt(6)
    v_mfma_f32_32x32x16_bf16 v[84:99], v[60:63], v[128:131], 0
    ds_read_b64_tr_b16 v[76:77], v16 offset:8192
    ds_read_b64_tr_b16 v[78:79], v17 offset:8192
    v_mfma_f32_32x32x16_bf16 v[84:99], v[64:67], v[132:135], v[84:99]
    ds_read_b64_tr_b16 v[80:81], v16 offset:10240
    ds_read_b64_tr_b16 v[82:83], v17 offset:10240
    s_waitcnt lgkmcnt(6)
    v_mfma_f32_32x32x16_bf16 v[84:99], v[68:71], v[136:139], v[84:99]
    ds_read_b64_tr_b16 v[60:61], v16 offset:12288
    ds_read_b64_tr_b16 v[62:63], v17 offset:12288
    v_mfma_f32_32x32x16_bf16 v[84:99], v[72:75], v[140:143], v[84:99]
    ds_read_b64_tr_b16 v[64:65], v16 offset:14336
    ds_read_b64_tr_b16 v[66:67], v17 offset:14336
    s_waitcnt lgkmcnt(4)
    v_mfma_f32_32x32x16_bf16 v[84:99], v[76:79], v[144:147], v[84:99]
    s_waitcnt vmcnt(0)
    v_add_u32 v16, 98304, v14
    v_add_u32 v17, 98304, v15
    s_barrier
    ds_read_b64_tr_b16 v[68:69], v16 offset:0
    ds_read_b64_tr_b16 v[70:71], v17 offset:0
    v_mfma_f32_32x32x16_bf16 v[84:99], v[80:83], v[148:151], v[84:99]
    ds_read_b64_tr_b16 v[72:73], v16 offset:2048
    ds_read_b64_tr_b16 v[74:75], v17 offset:2048
    s_waitcnt lgkmcnt(4)
    v_mfma_f32_32x32x16_bf16 v[84:99], v[60:63], v[152:155], v[84:99]
    ds_read_b64_tr_b16 v[76:77], v16 offset:4096
    ds_read_b64_tr_b16 v[78:79], v17 offset:4096
    v_mfma_f32_32x32x16_bf16 v[84:99], v[64:67], v[156:159], v[84:99]
    ds_read_b64_tr_b16 v[80:81], v16 offset:6144
    ds_read_b64_tr_b16 v[82:83], v17 offset:6144
    s_waitcnt lgkmcnt(4)
    v_mfma_f32_32x32x16_bf16 v[84:99], v[68:71], v[160:163], v[84:99]
    ds_read_b64_tr_b16 v[60:61], v16 offset:8192
    ds_read_b64_tr_b16 v[62:63], v17 offset:8192
    v_mfma_f32_32x32x16_bf16 v[84:99], v[72:75], v[164:167], v[84:99]
    ds_read_b64_tr_b16 v[64:65], v16 offset:10240
    ds_read_b64_tr_b16 v[66:67], v17 offset:10240
    s_waitcnt lgkmcnt(4)
    v_mfma_f32_32x32x16_bf16 v[84:99], v[76:79], v[168:171], v[84:99]
    ds_read_b64_tr_b16 v[68:69], v16 offset:12288
    ds_read_b64_tr_b16 v[70:71], v17 offset:12288
    v_mfma_f32_32x32x16_bf16 v[84:99], v[80:83], v[172:175], v[84:99]
    ds_read_b64_tr_b16 v[72:73], v16 offset:14336
    ds_read_b64_tr_b16 v[74:75], v17 offset:14336
    s_waitcnt lgkmcnt(4)
    v_mfma_f32_32x32x16_bf16 v[84:99], v[60:63], v[176:179], v[84:99]
    v_add_u32 v16, 114688, v14
    v_add_u32 v17, 114688, v15
    s_barrier
    ds_read_b64_tr_b16 v[76:77], v16 offset:0
    ds_read_b64_tr_b16 v[78:79], v17 offset:0
    v_mfma_f32_32x32x16_bf16 v[84:99], v[64:67], v[180:183], v[84:99]
    ds_read_b64_tr_b16 v[80:81], v16 offset:2048
    ds_read_b64_tr_b16 v[82:83], v17 offset:2048
    s_waitcnt lgkmcnt(4)
    v_mfma_f32_32x32x16_bf16 v[84:99], v[68:71], v[184:187], v[84:99]
    ds_read_b64_tr_b16 v[60:61], v16 offset:4096
    ds_read_b64_tr_b16 v[62:63], v17 offset:4096
    v_mfma_f32_32x32x16_bf16 v[84:99], v[72:75], v[188:191], v[84:99]
    ds_read_b64_tr_b16 v[64:65], v16 offset:6144
    ds_read_b64_tr_b16 v[66:67], v17 offset:6144
    s_waitcnt lgkmcnt(4)
    v_mfma_f32_32x32x16_bf16 v[84:99], v[76:79], v[192:195], v[84:99]
    ds_read_b64_tr_b16 v[68:69], v16 offset:8192
    ds_read_b64_tr_b16 v[70:71], v17 offset:8192
    ds_read_b64_tr_b16 v[72:73], v16 offset:10240
    v_mfma_f32_32x32x16_bf16 v[84:99], v[80:83], v[196:199], v[84:99]
    ds_read_b64_tr_b16 v[74:75], v17 offset:10240
    ds_read_b128 v[108:111], v5
    ds_read_b128 v[112:115], v5 offset:1024
    s_waitcnt lgkmcnt(6)
    v_mfma_f32_32x32x16_bf16 v[84:99], v[60:63], v[200:203], v[84:99]
    ds_read_b64_tr_b16 v[76:77], v16 offset:12288
    ds_read_b64_tr_b16 v[78:79], v17 offset:12288
    v_mfma_f32_32x32x16_bf16 v[84:99], v[64:67], v[204:207], v[84:99]
    ds_read_b64_tr_b16 v[80:81], v16 offset:14336
    ds_read_b64_tr_b16 v[82:83], v17 offset:14336
    s_waitcnt lgkmcnt(6)
    v_mfma_f32_32x32x16_bf16 v[84:99], v[68:71], v[208:211], v[84:99]
    v_add_u32 v16, 0, v14
    v_add_u32 v17, 0, v15
    s_barrier
    ds_read_b64_tr_b16 v[60:61], v16 offset:0
    ds_read_b64_tr_b16 v[62:63], v17 offset:0
    v_mfma_f32_32x32x16_bf16 v[84:99], v[72:75], v[212:215], v[84:99]
    ds_read_b64_tr_b16 v[64:65], v16 offset:2048
    ds_read_b64_tr_b16 v[66:67], v17 offset:2048
    s_waitcnt lgkmcnt(4)
    v_mfma_f32_32x32x16_bf16 v[84:99], v[76:79], v[216:219], v[84:99]
    ds_read_b64_tr_b16 v[68:69], v16 offset:4096
    ds_read_b64_tr_b16 v[70:71], v17 offset:4096
    ds_read_b64_tr_b16 v[72:73], v16 offset:6144
    v_mfma_f32_32x32x16_bf16 v[84:99], v[80:83], v[220:223], v[84:99]
    ds_read_b64_tr_b16 v[74:75], v17 offset:6144
    v_add_f32_e64 v100, v100, v108
    v_add_f32_e64 v101, v101, v109
    v_add_f32_e64 v102, v102, v110
    v_add_f32_e64 v103, v103, v111
    s_waitcnt lgkmcnt(4)
    v_mfma_f32_32x32x16_bf16 v[84:99], v[60:63], v[224:227], v[84:99]
    ds_read_b64_tr_b16 v[76:77], v16 offset:8192
    ds_read_b64_tr_b16 v[78:79], v17 offset:8192
    ds_read_b64_tr_b16 v[80:81], v16 offset:10240
    v_mfma_f32_32x32x16_bf16 v[84:99], v[64:67], v[228:231], v[84:99]
    ds_read_b64_tr_b16 v[82:83], v17 offset:10240
    v_add_f32_e64 v104, v104, v112
    v_add_f32_e64 v105, v105, v113
    v_add_f32_e64 v106, v106, v114
    v_add_f32_e64 v107, v107, v115
    s_waitcnt lgkmcnt(4)
    v_mfma_f32_32x32x16_bf16 v[84:99], v[68:71], v[232:235], v[84:99]
    ds_read_b64_tr_b16 v[60:61], v16 offset:12288
    ds_read_b64_tr_b16 v[62:63], v17 offset:12288
    v_mfma_f32_32x32x16_bf16 v[84:99], v[72:75], v[236:239], v[84:99]
    ds_read_b64_tr_b16 v[64:65], v16 offset:14336
    ds_read_b64_tr_b16 v[66:67], v17 offset:14336
    s_waitcnt lgkmcnt(4)
    v_mfma_f32_32x32x16_bf16 v[84:99], v[76:79], v[240:243], v[84:99]
    s_waitcnt lgkmcnt(0)
    v_add_u32 v16, 16384, v14
    v_add_u32 v17, 16384, v15
    s_barrier
    ds_read_b64_tr_b16 v[68:69], v16 offset:0
    ds_read_b64_tr_b16 v[70:71], v17 offset:0
    v_mfma_f32_32x32x16_bf16 v[84:99], v[80:83], v[244:247], v[84:99]
    ds_read_b64_tr_b16 v[72:73], v16 offset:2048
    ds_read_b64_tr_b16 v[74:75], v17 offset:2048
    v_mfma_f32_32x32x16_bf16 v[84:99], v[60:63], v[248:251], v[84:99]
    ds_read_b64_tr_b16 v[76:77], v16 offset:4096
    ds_read_b64_tr_b16 v[78:79], v17 offset:4096
    ds_read_b64_tr_b16 v[80:81], v16 offset:6144
    ds_read_b64_tr_b16 v[82:83], v17 offset:6144
    v_mfma_f32_32x32x16_bf16 v[84:99], v[64:67], v[252:255], v[84:99]
    ds_read_b128 v[112:115], v3 offset:256
    ds_read_b128 v[116:119], v3 offset:288
    ds_read_b128 v[120:123], v3 offset:320
    ds_read_b128 v[124:127], v3 offset:352
    s_waitcnt lgkmcnt(0)
    s_nop 6
    s_nop 0
    v_pk_fma_f32 v[84:85], v[112:113], v[40:41], v[84:85] op_sel:[0,0,0] op_sel_hi:[1,0,1]
    v_pk_fma_f32 v[86:87], v[114:115], v[40:41], v[86:87] op_sel:[0,0,0] op_sel_hi:[1,0,1]
    v_pk_fma_f32 v[88:89], v[116:117], v[40:41], v[88:89] op_sel:[0,0,0] op_sel_hi:[1,0,1]
    v_pk_fma_f32 v[90:91], v[118:119], v[40:41], v[90:91] op_sel:[0,0,0] op_sel_hi:[1,0,1]
    v_pk_fma_f32 v[92:93], v[120:121], v[40:41], v[92:93] op_sel:[0,0,0] op_sel_hi:[1,0,1]
    v_pk_fma_f32 v[94:95], v[122:123], v[40:41], v[94:95] op_sel:[0,0,0] op_sel_hi:[1,0,1]
    v_pk_fma_f32 v[96:97], v[124:125], v[40:41], v[96:97] op_sel:[0,0,0] op_sel_hi:[1,0,1]
    v_pk_fma_f32 v[98:99], v[126:127], v[40:41], v[98:99] op_sel:[0,0,0] op_sel_hi:[1,0,1]
    ds_read_b128 v[112:115], v4 offset:0
    ds_read_b128 v[116:119], v4 offset:32
    v_pk_mul_f32 v[44:45], v[84:85], v[84:85]
    v_pk_mul_f32 v[46:47], v[86:87], v[86:87]
    v_pk_mul_f32 v[48:49], v[88:89], v[88:89]
    v_pk_mul_f32 v[50:51], v[90:91], v[90:91]
    v_pk_mul_f32 v[52:53], v[92:93], v[92:93]
    v_pk_mul_f32 v[54:55], v[94:95], v[94:95]
    v_pk_mul_f32 v[56:57], v[96:97], v[96:97]
    v_pk_mul_f32 v[58:59], v[98:99], v[98:99]
    v_pk_fma_f32 v[44:45], v[44:45], v[42:43], v[40:41] op_sel:[0,0,1] op_sel_hi:[1,0,1]
    v_pk_fma_f32 v[46:47], v[46:47], v[42:43], v[40:41] op_sel:[0,0,1] op_sel_hi:[1,0,1]
    v_pk_fma_f32 v[48:49], v[48:49], v[42:43], v[40:41] op_sel:[0,0,1] op_sel_hi:[1,0,1]
    v_pk_fma_f32 v[50:51], v[50:51], v[42:43], v[40:41] op_sel:[0,0,1] op_sel_hi:[1,0,1]
    v_pk_fma_f32 v[52:53], v[52:53], v[42:43], v[40:41] op_sel:[0,0,1] op_sel_hi:[1,0,1]
    v_pk_fma_f32 v[54:55], v[54:55], v[42:43], v[40:41] op_sel:[0,0,1] op_sel_hi:[1,0,1]
    v_pk_fma_f32 v[56:57], v[56:57], v[42:43], v[40:41] op_sel:[0,0,1] op_sel_hi:[1,0,1]
    v_pk_fma_f32 v[58:59], v[58:59], v[42:43], v[40:41] op_sel:[0,0,1] op_sel_hi:[1,0,1]
    v_pk_mul_f32 v[44:45], v[44:45], v[84:85]
    v_pk_mul_f32 v[46:47], v[46:47], v[86:87]
    v_pk_mul_f32 v[48:49], v[48:49], v[88:89]
    v_pk_mul_f32 v[50:51], v[50:51], v[90:91]
    v_pk_mul_f32 v[52:53], v[52:53], v[92:93]
    v_pk_mul_f32 v[54:55], v[54:55], v[94:95]
    v_pk_mul_f32 v[56:57], v[56:57], v[96:97]
    v_pk_mul_f32 v[58:59], v[58:59], v[98:99]
    v_exp_f32_e64 v44, v44
    v_exp_f32_e64 v45, v45
    v_exp_f32_e64 v46, v46
    v_exp_f32_e64 v47, v47
    v_exp_f32_e64 v48, v48
    v_exp_f32_e64 v49, v49
    v_exp_f32_e64 v50, v50
    v_exp_f32_e64 v51, v51
    v_exp_f32_e64 v52, v52
    v_exp_f32_e64 v53, v53
    v_exp_f32_e64 v54, v54
    v_exp_f32_e64 v55, v55
    v_exp_f32_e64 v56, v56
    v_exp_f32_e64 v57, v57
    v_exp_f32_e64 v58, v58
    v_exp_f32_e64 v59, v59
    v_pk_fma_f32 v[44:45], v[44:45], v[42:43], v[42:43] op_sel:[0,1,1] op_sel_hi:[1,1,1]
    v_pk_fma_f32 v[46:47], v[46:47], v[42:43], v[42:43] op_sel:[0,1,1] op_sel_hi:[1,1,1]
    v_pk_fma_f32 v[48:49], v[48:49], v[42:43], v[42:43] op_sel:[0,1,1] op_sel_hi:[1,1,1]
    v_pk_fma_f32 v[50:51], v[50:51], v[42:43], v[42:43] op_sel:[0,1,1] op_sel_hi:[1,1,1]
    v_pk_fma_f32 v[52:53], v[52:53], v[42:43], v[42:43] op_sel:[0,1,1] op_sel_hi:[1,1,1]
    v_pk_fma_f32 v[54:55], v[54:55], v[42:43], v[42:43] op_sel:[0,1,1] op_sel_hi:[1,1,1]
    v_pk_fma_f32 v[56:57], v[56:57], v[42:43], v[42:43] op_sel:[0,1,1] op_sel_hi:[1,1,1]
    v_pk_fma_f32 v[58:59], v[58:59], v[42:43], v[42:43] op_sel:[0,1,1] op_sel_hi:[1,1,1]
    v_rcp_f32_e64 v44, v44
    v_rcp_f32_e64 v45, v45
    v_rcp_f32_e64 v46, v46
    v_rcp_f32_e64 v47, v47
    v_rcp_f32_e64 v48, v48
    v_rcp_f32_e64 v49, v49
    v_rcp_f32_e64 v50, v50
    v_rcp_f32_e64 v51, v51
    v_rcp_f32_e64 v52, v52
    v_rcp_f32_e64 v53, v53
    v_rcp_f32_e64 v54, v54
    v_rcp_f32_e64 v55, v55
    v_rcp_f32_e64 v56, v56
    v_rcp_f32_e64 v57, v57
    v_rcp_f32_e64 v58, v58
    v_rcp_f32_e64 v59, v59
    v_pk_mul_f32 v[44:45], v[44:45], v[84:85]
    v_pk_mul_f32 v[46:47], v[46:47], v[86:87]
    v_pk_mul_f32 v[48:49], v[48:49], v[88:89]
    v_pk_mul_f32 v[50:51], v[50:51], v[90:91]
    v_pk_mul_f32 v[52:53], v[52:53], v[92:93]
    v_pk_mul_f32 v[54:55], v[54:55], v[94:95]
    v_pk_mul_f32 v[56:57], v[56:57], v[96:97]
    v_pk_mul_f32 v[58:59], v[58:59], v[98:99]
    v_cvt_pk_bf16_f32 v120, v44, v45
    v_cvt_pk_bf16_f32 v121, v46, v47
    v_cvt_pk_bf16_f32 v122, v48, v49
    v_cvt_pk_bf16_f32 v123, v50, v51
    v_cvt_pk_bf16_f32 v124, v52, v53
    v_cvt_pk_bf16_f32 v125, v54, v55
    v_cvt_pk_bf16_f32 v126, v56, v57
    v_cvt_pk_bf16_f32 v127, v58, v59
    s_waitcnt lgkmcnt(0)
    s_nop 0
    v_pk_fma_f32 v[100:101], v[112:113], v[40:41], v[100:101] op_sel:[0,0,0] op_sel_hi:[1,0,1]
    v_pk_fma_f32 v[102:103], v[114:115], v[40:41], v[102:103] op_sel:[0,0,0] op_sel_hi:[1,0,1]
    v_pk_fma_f32 v[104:105], v[116:117], v[40:41], v[104:105] op_sel:[0,0,0] op_sel_hi:[1,0,1]
    v_pk_fma_f32 v[106:107], v[118:119], v[40:41], v[106:107] op_sel:[0,0,0] op_sel_hi:[1,0,1]
    v_pk_mul_f32 v[44:45], v[100:101], v[100:101]
    v_pk_mul_f32 v[46:47], v[102:103], v[102:103]
    v_pk_mul_f32 v[48:49], v[104:105], v[104:105]
    v_pk_mul_f32 v[50:51], v[106:107], v[106:107]
    v_pk_fma_f32 v[44:45], v[44:45], v[42:43], v[40:41] op_sel:[0,0,1] op_sel_hi:[1,0,1]
    v_pk_fma_f32 v[46:47], v[46:47], v[42:43], v[40:41] op_sel:[0,0,1] op_sel_hi:[1,0,1]
    v_pk_fma_f32 v[48:49], v[48:49], v[42:43], v[40:41] op_sel:[0,0,1] op_sel_hi:[1,0,1]
    v_pk_fma_f32 v[50:51], v[50:51], v[42:43], v[40:41] op_sel:[0,0,1] op_sel_hi:[1,0,1]
    v_pk_mul_f32 v[44:45], v[44:45], v[100:101]
    v_pk_mul_f32 v[46:47], v[46:47], v[102:103]
    v_pk_mul_f32 v[48:49], v[48:49], v[104:105]
    v_pk_mul_f32 v[50:51], v[50:51], v[106:107]
    v_exp_f32_e64 v44, v44
    v_exp_f32_e64 v45, v45
    v_exp_f32_e64 v46, v46
    v_exp_f32_e64 v47, v47
    v_exp_f32_e64 v48, v48
    v_exp_f32_e64 v49, v49
    v_exp_f32_e64 v50, v50
    v_exp_f32_e64 v51, v51
    v_pk_fma_f32 v[44:45], v[44:45], v[42:43], v[42:43] op_sel:[0,1,1] op_sel_hi:[1,1,1]
    v_pk_fma_f32 v[46:47], v[46:47], v[42:43], v[42:43] op_sel:[0,1,1] op_sel_hi:[1,1,1]
    v_pk_fma_f32 v[48:49], v[48:49], v[42:43], v[42:43] op_sel:[0,1,1] op_sel_hi:[1,1,1]
    v_pk_fma_f32 v[50:51], v[50:51], v[42:43], v[42:43] op_sel:[0,1,1] op_sel_hi:[1,1,1]
    v_rcp_f32_e64 v44, v44
    v_rcp_f32_e64 v45, v45
    v_rcp_f32_e64 v46, v46
    v_rcp_f32_e64 v47, v47
    v_rcp_f32_e64 v48, v48
    v_rcp_f32_e64 v49, v49
    v_rcp_f32_e64 v50, v50
    v_rcp_f32_e64 v51, v51
    v_pk_mul_f32 v[44:45], v[44:45], v[100:101]
    v_pk_mul_f32 v[46:47], v[46:47], v[102:103]
    v_pk_mul_f32 v[48:49], v[48:49], v[104:105]
    v_pk_mul_f32 v[50:51], v[50:51], v[106:107]
    v_cvt_pk_bf16_f32 v100, v44, v45
    v_cvt_pk_bf16_f32 v101, v46, v47
    v_cvt_pk_bf16_f32 v102, v48, v49
    v_cvt_pk_bf16_f32 v103, v50, v51
    v_mfma_f32_32x32x16_bf16 v[84:99], v[68:71], v[128:131], 0
    buffer_store_dwordx4 v[120:123], v21, s[60:63], s86 offen offset:0 sc1
    ds_read_b64_tr_b16 v[60:61], v16 offset:8192
    ds_read_b64_tr_b16 v[62:63], v17 offset:8192
    v_mfma_f32_32x32x16_bf16 v[84:99], v[72:75], v[132:135], v[84:99]
    buffer_store_dwordx4 v[124:127], v21, s[60:63], s86 offen offset:2048 sc1
    s_add_u32 s86, s86, 8192
    ds_read_b64_tr_b16 v[64:65], v16 offset:10240
    ds_read_b64_tr_b16 v[66:67], v17 offset:10240
    v_mfma_f32_32x32x16_bf16 v[84:99], v[76:79], v[136:139], v[84:99]
    buffer_store_dwordx4 v[100:103], v21, s[60:63], s87 offen offset:0 sc1
    ds_read_b64_tr_b16 v[68:69], v16 offset:12288
    ds_read_b64_tr_b16 v[70:71], v17 offset:12288
    v_mfma_f32_32x32x16_bf16 v[84:99], v[80:83], v[140:143], v[84:99]
    ds_read_b64_tr_b16 v[72:73], v16 offset:14336
    ds_read_b64_tr_b16 v[74:75], v17 offset:14336
    s_waitcnt lgkmcnt(4)
    v_mfma_f32_32x32x16_bf16 v[84:99], v[60:63], v[144:147], v[84:99]
    v_add_u32 v16, 32768, v14
    v_add_u32 v17, 32768, v15
    s_barrier
    ds_read_b64_tr_b16 v[76:77], v16 offset:0
    ds_read_b64_tr_b16 v[78:79], v17 offset:0
    ds_read_b64_tr_b16 v[80:81], v16 offset:2048
    ds_read_b64_tr_b16 v[82:83], v17 offset:2048
    v_mfma_f32_32x32x16_bf16 v[84:99], v[64:67], v[148:151], v[84:99]
    ds_read_b128 v[112:115], v3 offset:512
    ds_read_b128 v[116:119], v3 offset:544
    ds_read_b128 v[120:123], v3 offset:576
    ds_read_b128 v[124:127], v3 offset:608
    s_waitcnt lgkmcnt(8)
    v_mfma_f32_32x32x16_bf16 v[84:99], v[68:71], v[152:155], v[84:99]
    ds_read_b64_tr_b16 v[60:61], v16 offset:4096
    ds_read_b64_tr_b16 v[62:63], v17 offset:4096
    v_mfma_f32_32x32x16_bf16 v[84:99], v[72:75], v[156:159], v[84:99]
    ds_read_b64_tr_b16 v[64:65], v16 offset:6144
    ds_read_b64_tr_b16 v[66:67], v17 offset:6144
    s_waitcnt lgkmcnt(8)
    v_mfma_f32_32x32x16_bf16 v[84:99], v[76:79], v[160:163], v[84:99]
    ds_read_b64_tr_b16 v[68:69], v16 offset:8192
    ds_read_b64_tr_b16 v[70:71], v17 offset:8192
    v_mfma_f32_32x32x16_bf16 v[84:99], v[80:83], v[164:167], v[84:99]
    ds_read_b64_tr_b16 v[72:73], v16 offset:10240
    ds_read_b64_tr_b16 v[74:75], v17 offset:10240
    s_waitcnt lgkmcnt(4)
    v_mfma_f32_32x32x16_bf16 v[84:99], v[60:63], v[168:171], v[84:99]
    ds_read_b64_tr_b16 v[76:77], v16 offset:12288
    ds_read_b64_tr_b16 v[78:79], v17 offset:12288
    v_mfma_f32_32x32x16_bf16 v[84:99], v[64:67], v[172:175], v[84:99]
    ds_read_b64_tr_b16 v[80:81], v16 offset:14336
    ds_read_b64_tr_b16 v[82:83], v17 offset:14336
    s_waitcnt lgkmcnt(4)
    v_mfma_f32_32x32x16_bf16 v[84:99], v[68:71], v[176:179], v[84:99]
    v_add_u32 v16, 49152, v14
    v_add_u32 v17, 49152, v15
    s_barrier
    ds_read_b64_tr_b16 v[60:61], v16 offset:0
    ds_read_b64_tr_b16 v[62:63], v17 offset:0
    v_mfma_f32_32x32x16_bf16 v[84:99], v[72:75], v[180:183], v[84:99]
    ds_read_b64_tr_b16 v[64:65], v16 offset:2048
    ds_read_b64_tr_b16 v[66:67], v17 offset:2048
    s_waitcnt lgkmcnt(4)
    v_mfma_f32_32x32x16_bf16 v[84:99], v[76:79], v[184:187], v[84:99]
    ds_read_b64_tr_b16 v[68:69], v16 offset:4096
    ds_read_b64_tr_b16 v[70:71], v17 offset:4096
    v_mfma_f32_32x32x16_bf16 v[84:99], v[80:83], v[188:191], v[84:99]
    ds_read_b64_tr_b16 v[72:73], v16 offset:6144
    ds_read_b64_tr_b16 v[74:75], v17 offset:6144
    s_waitcnt lgkmcnt(4)
    v_mfma_f32_32x32x16_bf16 v[84:99], v[60:63], v[192:195], v[84:99]
    ds_read_b64_tr_b16 v[76:77], v16 offset:8192
    ds_read_b64_tr_b16 v[78:79], v17 offset:8192
    v_mfma_f32_32x32x16_bf16 v[84:99], v[64:67], v[196:199], v[84:99]
    ds_read_b64_tr_b16 v[80:81], v16 offset:10240
    ds_read_b64_tr_b16 v[82:83], v17 offset:10240
    s_waitcnt lgkmcnt(4)
    v_mfma_f32_32x32x16_bf16 v[84:99], v[68:71], v[200:203], v[84:99]
    ds_read_b64_tr_b16 v[60:61], v16 offset:12288
    ds_read_b64_tr_b16 v[62:63], v17 offset:12288
    v_mfma_f32_32x32x16_bf16 v[84:99], v[72:75], v[204:207], v[84:99]
    ds_read_b64_tr_b16 v[64:65], v16 offset:14336
    ds_read_b64_tr_b16 v[66:67], v17 offset:14336
    s_waitcnt lgkmcnt(4)
    v_mfma_f32_32x32x16_bf16 v[84:99], v[76:79], v[208:211], v[84:99]
    v_add_u32 v16, 131072, v14
    v_add_u32 v17, 131072, v15
    s_barrier
    ds_read_b64_tr_b16 v[68:69], v16 offset:0
    ds_read_b64_tr_b16 v[70:71], v17 offset:0
    v_mfma_f32_32x32x16_bf16 v[84:99], v[80:83], v[212:215], v[84:99]
    ds_read_b64_tr_b16 v[72:73], v16 offset:2048
    ds_read_b64_tr_b16 v[74:75], v17 offset:2048
    s_waitcnt lgkmcnt(4)
    v_mfma_f32_32x32x16_bf16 v[84:99], v[60:63], v[216:219], v[84:99]
    ds_read_b64_tr_b16 v[76:77], v16 offset:4096
    ds_read_b64_tr_b16 v[78:79], v17 offset:4096
    v_mfma_f32_32x32x16_bf16 v[84:99], v[64:67], v[220:223], v[84:99]
    ds_read_b64_tr_b16 v[80:81], v16 offset:6144
    ds_read_b64_tr_b16 v[82:83], v17 offset:6144
    s_waitcnt lgkmcnt(4)
    v_mfma_f32_32x32x16_bf16 v[84:99], v[68:71], v[224:227], v[84:99]
    ds_read_b64_tr_b16 v[60:61], v16 offset:8192
    ds_read_b64_tr_b16 v[62:63], v17 offset:8192
    v_mfma_f32_32x32x16_bf16 v[84:99], v[72:75], v[228:231], v[84:99]
    ds_read_b64_tr_b16 v[64:65], v16 offset:10240
    ds_read_b64_tr_b16 v[66:67], v17 offset:10240
    s_waitcnt lgkmcnt(4)
    v_mfma_f32_32x32x16_bf16 v[84:99], v[76:79], v[232:235], v[84:99]
    ds_read_b64_tr_b16 v[68:69], v16 offset:12288
    ds_read_b64_tr_b16 v[70:71], v17 offset:12288
    v_mfma_f32_32x32x16_bf16 v[84:99], v[80:83], v[236:239], v[84:99]
    ds_read_b64_tr_b16 v[72:73], v16 offset:14336
    ds_read_b64_tr_b16 v[74:75], v17 offset:14336
    s_waitcnt lgkmcnt(4)
    v_mfma_f32_32x32x16_bf16 v[84:99], v[60:63], v[240:243], v[84:99]
    s_waitcnt vmcnt(0)
    s_waitcnt lgkmcnt(0)
    v_add_u32 v16, 65536, v10
    v_add_u32 v17, 65536, v11
    v_add_u32 v18, 65536, v12
    v_add_u32 v19, 65536, v13
    s_barrier
    ds_read_b64_tr_b16 v[76:77], v16 offset:0
    ds_read_b64_tr_b16 v[78:79], v17 offset:0
    v_mfma_f32_32x32x16_bf16 v[84:99], v[64:67], v[244:247], v[84:99]
    ds_read_b64_tr_b16 v[80:81], v18 offset:0
    ds_read_b64_tr_b16 v[82:83], v19 offset:0
    v_mfma_f32_32x32x16_bf16 v[84:99], v[68:71], v[248:251], v[84:99]
    ds_read_b64_tr_b16 v[60:61], v16 offset:2048
    ds_read_b64_tr_b16 v[62:63], v17 offset:2048
    v_mfma_f32_32x32x16_bf16 v[84:99], v[72:75], v[252:255], v[84:99]
    ds_read_b64_tr_b16 v[64:65], v18 offset:2048
    ds_read_b64_tr_b16 v[66:67], v19 offset:2048
    s_lshl_b32 s73, s72, 13
    s_add_u32 s78, s73, s85
    s_add_u32 s78, s78, 4194304
    s_mul_i32 s77, s72, 57344
    s_add_u32 s77, s77, s88
    s_add_u32 s77, s77, 24576
    s_lshl_b32 s73, s72, 15
    s_add_u32 s88, s88, s73
    s_add_u32 s73, s3, 0
    s_and_b32 s73, s73, 3
    s_mul_i32 s22, s73, 57344
    s_lshl_b32 s96, s73, 14
    s_add_u32 s73, s3, 1
    s_and_b32 s73, s73, 3
    s_mul_i32 s23, s73, 57344
    s_lshl_b32 s97, s73, 14
    s_add_u32 s73, s3, 2
    s_and_b32 s73, s73, 3
    s_mul_i32 s24, s73, 57344
    s_lshl_b32 s98, s73, 14
    s_add_u32 s73, s3, 3
    s_and_b32 s73, s73, 3
    s_mul_i32 s25, s73, 57344
    s_lshl_b32 s99, s73, 14
    v_pk_fma_f32 v[84:85], v[112:113], v[40:41], v[84:85] op_sel:[0,0,0] op_sel_hi:[1,0,1]
    v_pk_fma_f32 v[86:87], v[114:115], v[40:41], v[86:87] op_sel:[0,0,0] op_sel_hi:[1,0,1]
    v_pk_fma_f32 v[88:89], v[116:117], v[40:41], v[88:89] op_sel:[0,0,0] op_sel_hi:[1,0,1]
    v_pk_fma_f32 v[90:91], v[118:119], v[40:41], v[90:91] op_sel:[0,0,0] op_sel_hi:[1,0,1]
    v_pk_fma_f32 v[92:93], v[120:121], v[40:41], v[92:93] op_sel:[0,0,0] op_sel_hi:[1,0,1]
    v_pk_fma_f32 v[94:95], v[122:123], v[40:41], v[94:95] op_sel:[0,0,0] op_sel_hi:[1,0,1]
    v_pk_fma_f32 v[96:97], v[124:125], v[40:41], v[96:97] op_sel:[0,0,0] op_sel_hi:[1,0,1]
    v_pk_fma_f32 v[98:99], v[126:127], v[40:41], v[98:99] op_sel:[0,0,0] op_sel_hi:[1,0,1]
    v_pk_mul_f32 v[44:45], v[84:85], v[84:85]
    v_pk_mul_f32 v[46:47], v[86:87], v[86:87]
    v_pk_mul_f32 v[48:49], v[88:89], v[88:89]
    v_pk_mul_f32 v[50:51], v[90:91], v[90:91]
    s_add_u32 s79, s88, s22
    s_nop 0
    buffer_load_dwordx4 v[128:131], v21, s[60:63], s79 offen offset:0 sc1
    v_pk_mul_f32 v[52:53], v[92:93], v[92:93]
    v_pk_mul_f32 v[54:55], v[94:95], v[94:95]
    v_pk_mul_f32 v[56:57], v[96:97], v[96:97]
    v_pk_mul_f32 v[58:59], v[98:99], v[98:99]
    v_pk_fma_f32 v[44:45], v[44:45], v[42:43], v[40:41] op_sel:[0,0,1] op_sel_hi:[1,0,1]
    v_pk_fma_f32 v[46:47], v[46:47], v[42:43], v[40:41] op_sel:[0,0,1] op_sel_hi:[1,0,1]
    v_pk_fma_f32 v[48:49], v[48:49], v[42:43], v[40:41] op_sel:[0,0,1] op_sel_hi:[1,0,1]
    v_pk_fma_f32 v[50:51], v[50:51], v[42:43], v[40:41] op_sel:[0,0,1] op_sel_hi:[1,0,1]
    v_pk_fma_f32 v[52:53], v[52:53], v[42:43], v[40:41] op_sel:[0,0,1] op_sel_hi:[1,0,1]
    v_pk_fma_f32 v[54:55], v[54:55], v[42:43], v[40:41] op_sel:[0,0,1] op_sel_hi:[1,0,1]
    v_pk_fma_f32 v[56:57], v[56:57], v[42:43], v[40:41] op_sel:[0,0,1] op_sel_hi:[1,0,1]
    v_pk_fma_f32 v[58:59], v[58:59], v[42:43], v[40:41] op_sel:[0,0,1] op_sel_hi:[1,0,1]
    buffer_load_dwordx4 v[132:135], v21, s[60:63], s79 offen offset:2048 sc1
    v_pk_mul_f32 v[44:45], v[44:45], v[84:85]
    v_pk_mul_f32 v[46:47], v[46:47], v[86:87]
    v_pk_mul_f32 v[48:49], v[48:49], v[88:89]
    v_pk_mul_f32 v[50:51], v[50:51], v[90:91]
    v_pk_mul_f32 v[52:53], v[52:53], v[92:93]
    v_pk_mul_f32 v[54:55], v[54:55], v[94:95]
    v_pk_mul_f32 v[56:57], v[56:57], v[96:97]
    v_pk_mul_f32 v[58:59], v[58:59], v[98:99]
    v_exp_f32_e64 v44, v44
    v_exp_f32_e64 v45, v45
    s_add_u32 s79, s79, 4096
    buffer_load_dwordx4 v[136:139], v21, s[60:63], s79 offen offset:0 sc1
    v_exp_f32_e64 v46, v46
    v_exp_f32_e64 v47, v47
    v_exp_f32_e64 v48, v48
    v_exp_f32_e64 v49, v49
    v_exp_f32_e64 v50, v50
    v_exp_f32_e64 v51, v51
    buffer_load_dwordx4 v[140:143], v21, s[60:63], s79 offen offset:2048 sc1
    v_exp_f32_e64 v52, v52
    v_exp_f32_e64 v53, v53
    v_exp_f32_e64 v54, v54
    v_exp_f32_e64 v55, v55
    v_exp_f32_e64 v56, v56
    v_exp_f32_e64 v57, v57
    s_add_u32 s79, s88, s23
    s_nop 0
    buffer_load_dwordx4 v[144:147], v21, s[60:63], s79 offen offset:0 sc1
    v_exp_f32_e64 v58, v58
    v_exp_f32_e64 v59, v59
    v_pk_fma_f32 v[44:45], v[44:45], v[42:43], v[42:43] op_sel:[0,1,1] op_sel_hi:[1,1,1]
    v_pk_fma_f32 v[46:47], v[46:47], v[42:43], v[42:43] op_sel:[0,1,1] op_sel_hi:[1,1,1]
    v_pk_fma_f32 v[48:49], v[48:49], v[42:43], v[42:43] op_sel:[0,1,1] op_sel_hi:[1,1,1]
    v_pk_fma_f32 v[50:51], v[50:51], v[42:43], v[42:43] op_sel:[0,1,1] op_sel_hi:[1,1,1]
    v_pk_fma_f32 v[52:53], v[52:53], v[42:43], v[42:43] op_sel:[0,1,1] op_sel_hi:[1,1,1]
    v_pk_fma_f32 v[54:55], v[54:55], v[42:43], v[42:43] op_sel:[0,1,1] op_sel_hi:[1,1,1]
    v_pk_fma_f32 v[56:57], v[56:57], v[42:43], v[42:43] op_sel:[0,1,1] op_sel_hi:[1,1,1]
    v_pk_fma_f32 v[58:59], v[58:59], v[42:43], v[42:43] op_sel:[0,1,1] op_sel_hi:[1,1,1]
    buffer_load_dwordx4 v[148:151], v21, s[60:63], s79 offen offset:2048 sc1
    v_rcp_f32_e64 v44, v44
    v_rcp_f32_e64 v45, v45
    v_rcp_f32_e64 v46, v46
    v_rcp_f32_e64 v47, v47
    v_rcp_f32_e64 v48, v48
    v_rcp_f32_e64 v49, v49
    s_add_u32 s79, s79, 4096
    buffer_load_dwordx4 v[152:155], v21, s[60:63], s79 offen offset:0 sc1
    v_rcp_f32_e64 v50, v50
    v_rcp_f32_e64 v51, v51
    v_rcp_f32_e64 v52, v52
    v_rcp_f32_e64 v53, v53
    v_rcp_f32_e64 v54, v54
    v_rcp_f32_e64 v55, v55
    buffer_load_dwordx4 v[156:159], v21, s[60:63], s79 offen offset:2048 sc1
    v_rcp_f32_e64 v56, v56
    v_rcp_f32_e64 v57, v57
    v_rcp_f32_e64 v58, v58
    v_rcp_f32_e64 v59, v59
    v_pk_mul_f32 v[44:45], v[44:45], v[84:85]
    v_pk_mul_f32 v[46:47], v[46:47], v[86:87]
    v_pk_mul_f32 v[48:49], v[48:49], v[88:89]
    v_pk_mul_f32 v[50:51], v[50:51], v[90:91]
    v_pk_mul_f32 v[52:53], v[52:53], v[92:93]
    v_pk_mul_f32 v[54:55], v[54:55], v[94:95]
    v_pk_mul_f32 v[56:57], v[56:57], v[96:97]
    v_pk_mul_f32 v[58:59], v[58:59], v[98:99]
    v_cvt_pk_bf16_f32 v116, v44, v45
    v_cvt_pk_bf16_f32 v117, v46, v47
    v_cvt_pk_bf16_f32 v118, v48, v49
    v_cvt_pk_bf16_f32 v119, v50, v51
    v_cvt_pk_bf16_f32 v120, v52, v53
    v_cvt_pk_bf16_f32 v121, v54, v55
    v_cvt_pk_bf16_f32 v122, v56, v57
    v_cvt_pk_bf16_f32 v123, v58, v59
    s_waitcnt vmcnt(7) lgkmcnt(4)
    v_mfma_f32_32x32x16_bf16 v[84:99], v[76:79], v[128:131], v[24:39]
    buffer_store_dwordx4 v[116:119], v21, s[60:63], s86 offen offset:0 sc1
    ds_read_b64_tr_b16 v[68:69], v16 offset:4096
    ds_read_b64_tr_b16 v[70:71], v17 offset:4096
    ds_read_b64_tr_b16 v[72:73], v18 offset:4096
    v_mfma_f32_32x32x16_bf16 v[100:115], v[80:83], v[128:131], 0
    buffer_store_dwordx4 v[120:123], v21, s[60:63], s86 offen offset:2048 sc1
    ds_read_b64_tr_b16 v[74:75], v19 offset:4096
    s_add_u32 s79, s88, s24
    buffer_load_dwordx4 v[160:163], v21, s[60:63], s79 offen offset:0 sc1
    buffer_load_dwordx4 v[164:167], v21, s[60:63], s79 offen offset:2048 sc1
    s_waitcnt vmcnt(10) lgkmcnt(4)
    v_mfma_f32_32x32x16_bf16 v[84:99], v[60:63], v[132:135], v[84:99]
    ds_read_b64_tr_b16 v[76:77], v16 offset:6144
    ds_read_b64_tr_b16 v[78:79], v17 offset:6144
    ds_read_b64_tr_b16 v[80:81], v18 offset:6144
    v_mfma_f32_32x32x16_bf16 v[100:115], v[64:67], v[132:135], v[100:115]
    ds_read_b64_tr_b16 v[82:83], v19 offset:6144
    s_add_u32 s79, s79, 4096
    buffer_load_dwordx4 v[168:171], v21, s[60:63], s79 offen offset:0 sc1
    buffer_load_dwordx4 v[172:175], v21, s[60:63], s79 offen offset:2048 sc1
    s_waitcnt vmcnt(11) lgkmcnt(4)
    v_mfma_f32_32x32x16_bf16 v[84:99], v[68:71], v[136:139], v[84:99]
    v_add_u32 v16, 81920, v10
    v_add_u32 v17, 81920, v11
    v_add_u32 v18, 81920, v12
    v_add_u32 v19, 81920, v13
    s_barrier
    ds_read_b64_tr_b16 v[60:61], v16 offset:0
    ds_read_b64_tr_b16 v[62:63], v17 offset:0
    ds_read_b64_tr_b16 v[64:65], v18 offset:0
    v_mfma_f32_32x32x16_bf16 v[100:115], v[72:75], v[136:139], v[100:115]
    ds_read_b64_tr_b16 v[66:67], v19 offset:0
    s_add_u32 s79, s88, s25
    buffer_load_dwordx4 v[176:179], v21, s[60:63], s79 offen offset:0 sc1
    s_waitcnt vmcnt(11) lgkmcnt(4)
    v_mfma_f32_32x32x16_bf16 v[84:99], v[76:79], v[140:143], v[84:99]
    ds_read_b64_tr_b16 v[68:69], v16 offset:2048
    ds_read_b64_tr_b16 v[70:71], v17 offset:2048
    ds_read_b64_tr_b16 v[72:73], v18 offset:2048
    v_mfma_f32_32x32x16_bf16 v[100:115], v[80:83], v[140:143], v[100:115]
    ds_read_b64_tr_b16 v[74:75], v19 offset:2048
    buffer_load_dwordx4 v[180:183], v21, s[60:63], s79 offen offset:2048 sc1
    s_waitcnt vmcnt(11) lgkmcnt(4)
    v_mfma_f32_32x32x16_bf16 v[84:99], v[60:63], v[144:147], v[84:99]
    ds_read_b64_tr_b16 v[76:77], v16 offset:4096
    ds_read_b64_tr_b16 v[78:79], v17 offset:4096
    ds_read_b64_tr_b16 v[80:81], v18 offset:4096
    v_mfma_f32_32x32x16_bf16 v[100:115], v[64:67], v[144:147], v[100:115]
    ds_read_b64_tr_b16 v[82:83], v19 offset:4096
    s_add_u32 s79, s79, 4096
    buffer_load_dwordx4 v[184:187], v21, s[60:63], s79 offen offset:0 sc1
    s_waitcnt vmcnt(11) lgkmcnt(4)
    v_mfma_f32_32x32x16_bf16 v[84:99], v[68:71], v[148:151], v[84:99]
    ds_read_b64_tr_b16 v[60:61], v16 offset:6144
    ds_read_b64_tr_b16 v[62:63], v17 offset:6144
    ds_read_b64_tr_b16 v[64:65], v18 offset:6144
    v_mfma_f32_32x32x16_bf16 v[100:115], v[72:75], v[148:151], v[100:115]
    ds_read_b64_tr_b16 v[66:67], v19 offset:6144
    buffer_load_dwordx4 v[188:191], v21, s[60:63], s79 offen offset:2048 sc1
    s_waitcnt vmcnt(11) lgkmcnt(4)
    v_mfma_f32_32x32x16_bf16 v[84:99], v[76:79], v[152:155], v[84:99]
    v_add_u32 v16, 98304, v10
    v_add_u32 v17, 98304, v11
    v_add_u32 v18, 98304, v12
    v_add_u32 v19, 98304, v13
    s_barrier
    ds_read_b64_tr_b16 v[68:69], v16 offset:0
    ds_read_b64_tr_b16 v[70:71], v17 offset:0
    ds_read_b64_tr_b16 v[72:73], v18 offset:0
    v_mfma_f32_32x32x16_bf16 v[100:115], v[80:83], v[152:155], v[100:115]
    ds_read_b64_tr_b16 v[74:75], v19 offset:0
    s_add_u32 s79, s78, s96
    buffer_load_dwordx4 v[192:195], v21, s[60:63], s79 offen offset:0 sc1
    s_waitcnt vmcnt(11) lgkmcnt(4)
    v_mfma_f32_32x32x16_bf16 v[84:99], v[60:63], v[156:159], v[84:99]
    ds_read_b64_tr_b16 v[76:77], v16 offset:2048
    ds_read_b64_tr_b16 v[78:79], v17 offset:2048
    ds_read_b64_tr_b16 v[80:81], v18 offset:2048
    v_mfma_f32_32x32x16_bf16 v[100:115], v[64:67], v[156:159], v[100:115]
    ds_read_b64_tr_b16 v[82:83], v19 offset:2048
    buffer_load_dwordx4 v[196:199], v21, s[60:63], s79 offen offset:2048 sc1
    s_waitcnt vmcnt(9) lgkmcnt(4)
    v_mfma_f32_32x32x16_bf16 v[84:99], v[68:71], v[160:163], v[84:99]
    ds_read_b64_tr_b16 v[60:61], v16 offset:4096
    ds_read_b64_tr_b16 v[62:63], v17 offset:4096
    ds_read_b64_tr_b16 v[64:65], v18 offset:4096
    v_mfma_f32_32x32x16_bf16 v[100:115], v[72:75], v[160:163], v[100:115]
    ds_read_b64_tr_b16 v[66:67], v19 offset:4096
    s_add_u32 s79, s79, 4096
    buffer_load_dwordx4 v[200:203], v21, s[60:63], s79 offen offset:0 sc1
    s_waitcnt vmcnt(9) lgkmcnt(4)
    v_mfma_f32_32x32x16_bf16 v[84:99], v[76:79], v[164:167], v[84:99]
    ds_read_b64_tr_b16 v[68:69], v16 offset:6144
    ds_read_b64_tr_b16 v[70:71], v17 offset:6144
    ds_read_b64_tr_b16 v[72:73], v18 offset:6144
    v_mfma_f32_32x32x16_bf16 v[100:115], v[80:83], v[164:167], v[100:115]
    ds_read_b64_tr_b16 v[74:75], v19 offset:6144
    buffer_load_dwordx4 v[204:207], v21, s[60:63], s79 offen offset:2048 sc1
    s_waitcnt vmcnt(9) lgkmcnt(4)
    v_mfma_f32_32x32x16_bf16 v[84:99], v[60:63], v[168:171], v[84:99]
    v_add_u32 v16, 114688, v10
    v_add_u32 v17, 114688, v11
    v_add_u32 v18, 114688, v12
    v_add_u32 v19, 114688, v13
    s_barrier
    ds_read_b64_tr_b16 v[76:77], v16 offset:0
    ds_read_b64_tr_b16 v[78:79], v17 offset:0
    ds_read_b64_tr_b16 v[80:81], v18 offset:0
    v_mfma_f32_32x32x16_bf16 v[100:115], v[64:67], v[168:171], v[100:115]
    ds_read_b64_tr_b16 v[82:83], v19 offset:0
    s_add_u32 s79, s78, s97
    buffer_load_dwordx4 v[208:211], v21, s[60:63], s79 offen offset:0 sc1
    s_waitcnt vmcnt(9) lgkmcnt(4)
    v_mfma_f32_32x32x16_bf16 v[84:99], v[68:71], v[172:175], v[84:99]
    ds_read_b64_tr_b16 v[60:61], v16 offset:2048
    ds_read_b64_tr_b16 v[62:63], v17 offset:2048
    ds_read_b64_tr_b16 v[64:65], v18 offset:2048
    v_mfma_f32_32x32x16_bf16 v[100:115], v[72:75], v[172:175], v[100:115]
    ds_read_b64_tr_b16 v[66:67], v19 offset:2048
    buffer_load_dwordx4 v[212:215], v21, s[60:63], s79 offen offset:2048 sc1
    s_waitcnt vmcnt(9) lgkmcnt(4)
    v_mfma_f32_32x32x16_bf16 v[84:99], v[76:79], v[176:179], v[84:99]
    ds_read_b64_tr_b16 v[68:69], v16 offset:4096
    ds_read_b64_tr_b16 v[70:71], v17 offset:4096
    ds_read_b64_tr_b16 v[72:73], v18 offset:4096
    v_mfma_f32_32x32x16_bf16 v[100:115], v[80:83], v[176:179], v[100:115]
    ds_read_b64_tr_b16 v[74:75], v19 offset:4096
    s_add_u32 s79, s79, 4096
    buffer_load_dwordx4 v[216:219], v21, s[60:63], s79 offen offset:0 sc1
    s_waitcnt vmcnt(9) lgkmcnt(4)
    v_mfma_f32_32x32x16_bf16 v[84:99], v[60:63], v[180:183], v[84:99]
    ds_read_b64_tr_b16 v[76:77], v16 offset:6144
    ds_read_b64_tr_b16 v[78:79], v17 offset:6144
    ds_read_b64_tr_b16 v[80:81], v18 offset:6144
    v_mfma_f32_32x32x16_bf16 v[100:115], v[64:67], v[180:183], v[100:115]
    ds_read_b64_tr_b16 v[82:83], v19 offset:6144
    buffer_load_dwordx4 v[220:223], v21, s[60:63], s79 offen offset:2048 sc1
    s_waitcnt vmcnt(9) lgkmcnt(4)
    v_mfma_f32_32x32x16_bf16 v[84:99], v[68:71], v[184:187], v[84:99]
    v_add_u32 v16, 0, v8
    v_add_u32 v17, 0, v9
    s_barrier
    ds_read_b64_tr_b16 v[60:61], v16 offset:0
    ds_read_b64_tr_b16 v[62:63], v16 offset:512
    ds_read_b64_tr_b16 v[64:65], v17 offset:0
    v_mfma_f32_32x32x16_bf16 v[100:115], v[72:75], v[184:187], v[100:115]
    ds_read_b64_tr_b16 v[66:67], v17 offset:512
    s_add_u32 s79, s78, s98
    buffer_load_dwordx4 v[224:227], v21, s[60:63], s79 offen offset:0 sc1
    s_waitcnt vmcnt(9) lgkmcnt(4)
    v_mfma_f32_32x32x16_bf16 v[84:99], v[76:79], v[188:191], v[84:99]
    ds_read_b64_tr_b16 v[68:69], v16 offset:2048
    ds_read_b64_tr_b16 v[70:71], v16 offset:2560
    ds_read_b64_tr_b16 v[72:73], v17 offset:2048
    v_mfma_f32_32x32x16_bf16 v[100:115], v[80:83], v[188:191], v[100:115]
    ds_read_b64_tr_b16 v[74:75], v17 offset:2560
    buffer_load_dwordx4 v[228:231], v21, s[60:63], s79 offen offset:2048 sc1
    s_waitcnt vmcnt(9) lgkmcnt(4)
    v_mfma_f32_32x32x16_bf16 v[84:99], v[60:63], v[192:195], v[84:99]
    ds_read_b64_tr_b16 v[76:77], v16 offset:4096
    ds_read_b64_tr_b16 v[78:79], v16 offset:4608
    ds_read_b64_tr_b16 v[80:81], v17 offset:4096
    v_mfma_f32_32x32x16_bf16 v[100:115], v[64:67], v[192:195], v[100:115]
    ds_read_b64_tr_b16 v[82:83], v17 offset:4608
    s_add_u32 s79, s79, 4096
    buffer_load_dwordx4 v[232:235], v21, s[60:63], s79 offen offset:0 sc1
    s_waitcnt vmcnt(9) lgkmcnt(4)
    v_mfma_f32_32x32x16_bf16 v[84:99], v[68:71], v[196:199], v[84:99]
    ds_read_b64_tr_b16 v[60:61], v16 offset:6144
    ds_read_b64_tr_b16 v[62:63], v16 offset:6656
    ds_read_b64_tr_b16 v[64:65], v17 offset:6144
    v_mfma_f32_32x32x16_bf16 v[100:115], v[72:75], v[196:199], v[100:115]
    ds_read_b64_tr_b16 v[66:67], v17 offset:6656
    buffer_load_dwordx4 v[236:239], v21, s[60:63], s79 offen offset:2048 sc1
    s_waitcnt vmcnt(9) lgkmcnt(4)
    v_mfma_f32_32x32x16_bf16 v[84:99], v[76:79], v[200:203], v[84:99]
    v_add_u32 v16, 16384, v8
    v_add_u32 v17, 16384, v9
    s_barrier
    ds_read_b64_tr_b16 v[68:69], v16 offset:0
    ds_read_b64_tr_b16 v[70:71], v16 offset:512
    ds_read_b64_tr_b16 v[72:73], v17 offset:0
    v_mfma_f32_32x32x16_bf16 v[100:115], v[80:83], v[200:203], v[100:115]
    ds_read_b64_tr_b16 v[74:75], v17 offset:512
    s_add_u32 s79, s78, s99
    buffer_load_dwordx4 v[240:243], v21, s[60:63], s79 offen offset:0 sc1
    s_waitcnt vmcnt(9) lgkmcnt(4)
    v_mfma_f32_32x32x16_bf16 v[84:99], v[60:63], v[204:207], v[84:99]
    ds_read_b64_tr_b16 v[76:77], v16 offset:2048
    ds_read_b64_tr_b16 v[78:79], v16 offset:2560
    ds_read_b64_tr_b16 v[80:81], v17 offset:2048
    v_mfma_f32_32x32x16_bf16 v[100:115], v[64:67], v[204:207], v[100:115]
    ds_read_b64_tr_b16 v[82:83], v17 offset:2560
    buffer_load_dwordx4 v[244:247], v21, s[60:63], s79 offen offset:2048 sc1
    s_waitcnt vmcnt(9) lgkmcnt(4)
    v_mfma_f32_32x32x16_bf16 v[84:99], v[68:71], v[208:211], v[84:99]
    ds_read_b64_tr_b16 v[60:61], v16 offset:4096
    ds_read_b64_tr_b16 v[62:63], v16 offset:4608
    ds_read_b64_tr_b16 v[64:65], v17 offset:4096
    v_mfma_f32_32x32x16_bf16 v[100:115], v[72:75], v[208:211], v[100:115]
    ds_read_b64_tr_b16 v[66:67], v17 offset:4608
    s_add_u32 s79, s79, 4096
    buffer_load_dwordx4 v[248:251], v21, s[60:63], s79 offen offset:0 sc1
    s_waitcnt vmcnt(9) lgkmcnt(4)
    v_mfma_f32_32x32x16_bf16 v[84:99], v[76:79], v[212:215], v[84:99]
    ds_read_b64_tr_b16 v[68:69], v16 offset:6144
    ds_read_b64_tr_b16 v[70:71], v16 offset:6656
    ds_read_b64_tr_b16 v[72:73], v17 offset:6144
    v_mfma_f32_32x32x16_bf16 v[100:115], v[80:83], v[212:215], v[100:115]
    ds_read_b64_tr_b16 v[74:75], v17 offset:6656
    buffer_load_dwordx4 v[252:255], v21, s[60:63], s79 offen offset:2048 sc1
    s_waitcnt vmcnt(9) lgkmcnt(4)
    v_mfma_f32_32x32x16_bf16 v[84:99], v[60:63], v[216:219], v[84:99]
    v_add_u32 v16, 147456, v8
    v_add_u32 v17, 147456, v9
    s_barrier
    ds_read_b64_tr_b16 v[76:77], v16 offset:0
    ds_read_b64_tr_b16 v[78:79], v16 offset:512
    ds_read_b64_tr_b16 v[80:81], v17 offset:0
    v_mfma_f32_32x32x16_bf16 v[100:115], v[64:67], v[216:219], v[100:115]
    ds_read_b64_tr_b16 v[82:83], v17 offset:512
    s_add_u32 s79, s88, s22
    s_add_u32 s79, s79, 8192
    buffer_load_dwordx4 v[128:131], v21, s[60:63], s79 offen offset:0 sc1
    s_waitcnt vmcnt(9) lgkmcnt(4)
    v_mfma_f32_32x32x16_bf16 v[84:99], v[68:71], v[220:223], v[84:99]
    ds_read_b64_tr_b16 v[60:61], v16 offset:2048
    ds_read_b64_tr_b16 v[62:63], v16 offset:2560
    ds_read_b64_tr_b16 v[64:65], v17 offset:2048
    v_mfma_f32_32x32x16_bf16 v[100:115], v[72:75], v[220:223], v[100:115]
    ds_read_b64_tr_b16 v[66:67], v17 offset:2560
    buffer_load_dwordx4 v[132:135], v21, s[60:63], s79 offen offset:2048 sc1
    s_waitcnt vmcnt(9) lgkmcnt(4)
    v_mfma_f32_32x32x16_bf16 v[84:99], v[76:79], v[224:227], v[84:99]
    ds_read_b64_tr_b16 v[68:69], v16 offset:4096
    ds_read_b64_tr_b16 v[70:71], v16 offset:4608
    ds_read_b64_tr_b16 v[72:73], v17 offset:4096
    v_mfma_f32_32x32x16_bf16 v[100:115], v[80:83], v[224:227], v[100:115]
    ds_read_b64_tr_b16 v[74:75], v17 offset:4608
    s_add_u32 s79, s79, 4096
    buffer_load_dwordx4 v[136:139], v21, s[60:63], s79 offen offset:0 sc1
    s_waitcnt vmcnt(9) lgkmcnt(4)
    v_mfma_f32_32x32x16_bf16 v[84:99], v[60:63], v[228:231], v[84:99]
    ds_read_b64_tr_b16 v[76:77], v16 offset:6144
    ds_read_b64_tr_b16 v[78:79], v16 offset:6656
    ds_read_b64_tr_b16 v[80:81], v17 offset:6144
    v_mfma_f32_32x32x16_bf16 v[100:115], v[64:67], v[228:231], v[100:115]
    ds_read_b64_tr_b16 v[82:83], v17 offset:6656
    buffer_load_dwordx4 v[140:143], v21, s[60:63], s79 offen offset:2048 sc1
    s_waitcnt vmcnt(9) lgkmcnt(4)
    v_mfma_f32_32x32x16_bf16 v[84:99], v[68:71], v[232:235], v[84:99]
    v_add_u32 v16, 32768, v8
    v_add_u32 v17, 32768, v9
    s_barrier
    ds_read_b64_tr_b16 v[60:61], v16 offset:0
    ds_read_b64_tr_b16 v[62:63], v16 offset:512
    ds_read_b64_tr_b16 v[64:65], v17 offset:0
    v_mfma_f32_32x32x16_bf16 v[100:115], v[72:75], v[232:235], v[100:115]
    ds_read_b64_tr_b16 v[66:67], v17 offset:512
    s_add_u32 s79, s88, s23
    s_add_u32 s79, s79, 8192
    buffer_load_dwordx4 v[144:147], v21, s[60:63], s79 offen offset:0 sc1
    s_waitcnt vmcnt(9) lgkmcnt(4)
    v_mfma_f32_32x32x16_bf16 v[84:99], v[76:79], v[236:239], v[84:99]
    ds_read_b64_tr_b16 v[68:69], v16 offset:2048
    ds_read_b64_tr_b16 v[70:71], v16 offset:2560
    ds_read_b64_tr_b16 v[72:73], v17 offset:2048
    v_mfma_f32_32x32x16_bf16 v[100:115], v[80:83], v[236:239], v[100:115]
    ds_read_b64_tr_b16 v[74:75], v17 offset:2560
    buffer_load_dwordx4 v[148:151], v21, s[60:63], s79 offen offset:2048 sc1
    s_waitcnt vmcnt(9) lgkmcnt(4)
    v_mfma_f32_32x32x16_bf16 v[84:99], v[60:63], v[240:243], v[84:99]
    ds_read_b64_tr_b16 v[76:77], v16 offset:4096
    ds_read_b64_tr_b16 v[78:79], v16 offset:4608
    ds_read_b64_tr_b16 v[80:81], v17 offset:4096
    v_mfma_f32_32x32x16_bf16 v[100:115], v[64:67], v[240:243], v[100:115]
    ds_read_b64_tr_b16 v[82:83], v17 offset:4608
    s_add_u32 s79, s79, 4096
    buffer_load_dwordx4 v[152:155], v21, s[60:63], s79 offen offset:0 sc1
    s_waitcnt vmcnt(9) lgkmcnt(4)
    v_mfma_f32_32x32x16_bf16 v[84:99], v[68:71], v[244:247], v[84:99]
    ds_read_b64_tr_b16 v[60:61], v16 offset:6144
    ds_read_b64_tr_b16 v[62:63], v16 offset:6656
    ds_read_b64_tr_b16 v[64:65], v17 offset:6144
    v_mfma_f32_32x32x16_bf16 v[100:115], v[72:75], v[244:247], v[100:115]
    ds_read_b64_tr_b16 v[66:67], v17 offset:6656
    buffer_load_dwordx4 v[156:159], v21, s[60:63], s79 offen offset:2048 sc1
    s_waitcnt vmcnt(9) lgkmcnt(4)
    v_mfma_f32_32x32x16_bf16 v[84:99], v[76:79], v[248:251], v[84:99]
    v_add_u32 v16, 49152, v10
    v_add_u32 v17, 49152, v11
    v_add_u32 v18, 49152, v12
    v_add_u32 v19, 49152, v13
    s_barrier
    ds_read_b64_tr_b16 v[68:69], v16 offset:0
    ds_read_b64_tr_b16 v[70:71], v17 offset:0
    ds_read_b64_tr_b16 v[72:73], v18 offset:0
    v_mfma_f32_32x32x16_bf16 v[100:115], v[80:83], v[248:251], v[100:115]
    ds_read_b64_tr_b16 v[74:75], v19 offset:0
    s_add_u32 s79, s88, s24
    s_add_u32 s79, s79, 8192
    buffer_load_dwordx4 v[160:163], v21, s[60:63], s79 offen offset:0 sc1
    s_waitcnt vmcnt(9) lgkmcnt(4)
    v_mfma_f32_32x32x16_bf16 v[84:99], v[60:63], v[252:255], v[84:99]
    ds_read_b64_tr_b16 v[76:77], v16 offset:2048
    ds_read_b64_tr_b16 v[78:79], v17 offset:2048
    ds_read_b64_tr_b16 v[80:81], v18 offset:2048
    v_mfma_f32_32x32x16_bf16 v[100:115], v[64:67], v[252:255], v[100:115]
    ds_read_b64_tr_b16 v[82:83], v19 offset:2048
    buffer_load_dwordx4 v[164:167], v21, s[60:63], s79 offen offset:2048 sc1
    s_waitcnt vmcnt(9) lgkmcnt(4)
    v_mfma_f32_32x32x16_bf16 v[84:99], v[68:71], v[128:131], v[84:99]
    ds_read_b64_tr_b16 v[60:61], v16 offset:4096
    ds_read_b64_tr_b16 v[62:63], v17 offset:4096
    ds_read_b64_tr_b16 v[64:65], v18 offset:4096
    v_mfma_f32_32x32x16_bf16 v[100:115], v[72:75], v[128:131], v[100:115]
    ds_read_b64_tr_b16 v[66:67], v19 offset:4096
    s_add_u32 s79, s79, 4096
    buffer_load_dwordx4 v[168:171], v21, s[60:63], s79 offen offset:0 sc1
    s_waitcnt vmcnt(9) lgkmcnt(4)
    v_mfma_f32_32x32x16_bf16 v[84:99], v[76:79], v[132:135], v[84:99]
    ds_read_b64_tr_b16 v[68:69], v16 offset:6144
    ds_read_b64_tr_b16 v[70:71], v17 offset:6144
    ds_read_b64_tr_b16 v[72:73], v18 offset:6144
    v_mfma_f32_32x32x16_bf16 v[100:115], v[80:83], v[132:135], v[100:115]
    ds_read_b64_tr_b16 v[74:75], v19 offset:6144
    buffer_load_dwordx4 v[172:175], v21, s[60:63], s79 offen offset:2048 sc1
    s_waitcnt vmcnt(9) lgkmcnt(4)
    v_mfma_f32_32x32x16_bf16 v[84:99], v[60:63], v[136:139], v[84:99]
    v_add_u32 v16, 131072, v10
    v_add_u32 v17, 131072, v11
    v_add_u32 v18, 131072, v12
    v_add_u32 v19, 131072, v13
    s_barrier
    ds_read_b64_tr_b16 v[76:77], v16 offset:0
    ds_read_b64_tr_b16 v[78:79], v17 offset:0
    ds_read_b64_tr_b16 v[80:81], v18 offset:0
    v_mfma_f32_32x32x16_bf16 v[100:115], v[64:67], v[136:139], v[100:115]
    ds_read_b64_tr_b16 v[82:83], v19 offset:0
    s_add_u32 s79, s88, s25
    s_add_u32 s79, s79, 8192
    buffer_load_dwordx4 v[176:179], v21, s[60:63], s79 offen offset:0 sc1
    s_waitcnt vmcnt(9) lgkmcnt(4)
    v_mfma_f32_32x32x16_bf16 v[84:99], v[68:71], v[140:143], v[84:99]
    ds_read_b64_tr_b16 v[60:61], v16 offset:2048
    ds_read_b64_tr_b16 v[62:63], v17 offset:2048
    ds_read_b64_tr_b16 v[64:65], v18 offset:2048
    v_mfma_f32_32x32x16_bf16 v[100:115], v[72:75], v[140:143], v[100:115]
    ds_read_b64_tr_b16 v[66:67], v19 offset:2048
    buffer_load_dwordx4 v[180:183], v21, s[60:63], s79 offen offset:2048 sc1
    s_waitcnt vmcnt(9) lgkmcnt(4)
    v_mfma_f32_32x32x16_bf16 v[84:99], v[76:79], v[144:147], v[84:99]
    ds_read_b64_tr_b16 v[68:69], v16 offset:4096
    ds_read_b64_tr_b16 v[70:71], v17 offset:4096
    ds_read_b64_tr_b16 v[72:73], v18 offset:4096
    v_mfma_f32_32x32x16_bf16 v[100:115], v[80:83], v[144:147], v[100:115]
    ds_read_b64_tr_b16 v[74:75], v19 offset:4096
    s_add_u32 s79, s79, 4096
    buffer_load_dwordx4 v[184:187], v21, s[60:63], s79 offen offset:0 sc1
    s_waitcnt vmcnt(9) lgkmcnt(4)
    v_mfma_f32_32x32x16_bf16 v[84:99], v[60:63], v[148:151], v[84:99]
    ds_read_b64_tr_b16 v[76:77], v16 offset:6144
    ds_read_b64_tr_b16 v[78:79], v17 offset:6144
    ds_read_b64_tr_b16 v[80:81], v18 offset:6144
    v_mfma_f32_32x32x16_bf16 v[100:115], v[64:67], v[148:151], v[100:115]
    ds_read_b64_tr_b16 v[82:83], v19 offset:6144
    buffer_load_dwordx4 v[188:191], v21, s[60:63], s79 offen offset:2048 sc1
    s_waitcnt vmcnt(9) lgkmcnt(4)
    v_mfma_f32_32x32x16_bf16 v[84:99], v[68:71], v[152:155], v[84:99]
    v_add_u32 v16, 65536, v10
    v_add_u32 v17, 65536, v11
    v_add_u32 v18, 65536, v12
    v_add_u32 v19, 65536, v13
    s_barrier
    ds_read_b64_tr_b16 v[60:61], v16 offset:0
    ds_read_b64_tr_b16 v[62:63], v17 offset:0
    ds_read_b64_tr_b16 v[64:65], v18 offset:0
    v_mfma_f32_32x32x16_bf16 v[100:115], v[72:75], v[152:155], v[100:115]
    ds_read_b64_tr_b16 v[66:67], v19 offset:0
    s_add_u32 s79, s3, 0
    s_and_b32 s79, s79, 1
    s_mul_i32 s79, s79, 114688
    s_add_u32 s79, s79, s77
    buffer_load_dwordx4 v[192:195], v21, s[60:63], s79 offen offset:0 sc1
    s_waitcnt vmcnt(9) lgkmcnt(4)
    v_mfma_f32_32x32x16_bf16 v[84:99], v[76:79], v[156:159], v[84:99]
    ds_read_b64_tr_b16 v[68:69], v16 offset:2048
    ds_read_b64_tr_b16 v[70:71], v17 offset:2048
    ds_read_b64_tr_b16 v[72:73], v18 offset:2048
    v_mfma_f32_32x32x16_bf16 v[100:115], v[80:83], v[156:159], v[100:115]
    ds_read_b64_tr_b16 v[74:75], v19 offset:2048
    buffer_load_dwordx4 v[196:199], v21, s[60:63], s79 offen offset:2048 sc1
    s_waitcnt vmcnt(9) lgkmcnt(4)
    v_mfma_f32_32x32x16_bf16 v[84:99], v[60:63], v[160:163], v[84:99]
    ds_read_b64_tr_b16 v[76:77], v16 offset:4096
    ds_read_b64_tr_b16 v[78:79], v17 offset:4096
    ds_read_b64_tr_b16 v[80:81], v18 offset:4096
    v_mfma_f32_32x32x16_bf16 v[100:115], v[64:67], v[160:163], v[100:115]
    ds_read_b64_tr_b16 v[82:83], v19 offset:4096
    s_add_u32 s79, s79, 4096
    buffer_load_dwordx4 v[200:203], v21, s[60:63], s79 offen offset:0 sc1
    s_waitcnt vmcnt(9) lgkmcnt(4)
    v_mfma_f32_32x32x16_bf16 v[84:99], v[68:71], v[164:167], v[84:99]
    ds_read_b64_tr_b16 v[60:61], v16 offset:6144
    ds_read_b64_tr_b16 v[62:63], v17 offset:6144
    ds_read_b64_tr_b16 v[64:65], v18 offset:6144
    v_mfma_f32_32x32x16_bf16 v[100:115], v[72:75], v[164:167], v[100:115]
    ds_read_b64_tr_b16 v[66:67], v19 offset:6144
    buffer_load_dwordx4 v[204:207], v21, s[60:63], s79 offen offset:2048 sc1
    s_waitcnt vmcnt(9) lgkmcnt(4)
    v_mfma_f32_32x32x16_bf16 v[84:99], v[76:79], v[168:171], v[84:99]
    v_add_u32 v16, 81920, v10
    v_add_u32 v17, 81920, v11
    v_add_u32 v18, 81920, v12
    v_add_u32 v19, 81920, v13
    s_barrier
    ds_read_b64_tr_b16 v[68:69], v16 offset:0
    ds_read_b64_tr_b16 v[70:71], v17 offset:0
    ds_read_b64_tr_b16 v[72:73], v18 offset:0
    v_mfma_f32_32x32x16_bf16 v[100:115], v[80:83], v[168:171], v[100:115]
    ds_read_b64_tr_b16 v[74:75], v19 offset:0
    s_add_u32 s79, s3, 1
    s_and_b32 s79, s79, 1
    s_mul_i32 s79, s79, 114688
    s_add_u32 s79, s79, s77
    buffer_load_dwordx4 v[208:211], v21, s[60:63], s79 offen offset:0 sc1
    s_waitcnt vmcnt(9) lgkmcnt(4)
    v_mfma_f32_32x32x16_bf16 v[84:99], v[60:63], v[172:175], v[84:99]
    ds_read_b64_tr_b16 v[76:77], v16 offset:2048
    ds_read_b64_tr_b16 v[78:79], v17 offset:2048
    ds_read_b64_tr_b16 v[80:81], v18 offset:2048
    v_mfma_f32_32x32x16_bf16 v[100:115], v[64:67], v[172:175], v[100:115]
    ds_read_b64_tr_b16 v[82:83], v19 offset:2048
    buffer_load_dwordx4 v[212:215], v21, s[60:63], s79 offen offset:2048 sc1
    s_waitcnt vmcnt(9) lgkmcnt(4)
    v_mfma_f32_32x32x16_bf16 v[84:99], v[68:71], v[176:179], v[84:99]
    ds_read_b64_tr_b16 v[60:61], v16 offset:4096
    ds_read_b64_tr_b16 v[62:63], v17 offset:4096
    ds_read_b64_tr_b16 v[64:65], v18 offset:4096
    v_mfma_f32_32x32x16_bf16 v[100:115], v[72:75], v[176:179], v[100:115]
    ds_read_b64_tr_b16 v[66:67], v19 offset:4096
    s_add_u32 s79, s79, 4096
    buffer_load_dwordx4 v[216:219], v21, s[60:63], s79 offen offset:0 sc1
    s_waitcnt vmcnt(9) lgkmcnt(4)
    v_mfma_f32_32x32x16_bf16 v[84:99], v[76:79], v[180:183], v[84:99]
    ds_read_b64_tr_b16 v[68:69], v16 offset:6144
    ds_read_b64_tr_b16 v[70:71], v17 offset:6144
    ds_read_b64_tr_b16 v[72:73], v18 offset:6144
    v_mfma_f32_32x32x16_bf16 v[100:115], v[80:83], v[180:183], v[100:115]
    ds_read_b64_tr_b16 v[74:75], v19 offset:6144
    buffer_load_dwordx4 v[220:223], v21, s[60:63], s79 offen offset:2048 sc1
    s_waitcnt vmcnt(9) lgkmcnt(4)
    v_mfma_f32_32x32x16_bf16 v[84:99], v[60:63], v[184:187], v[84:99]
    v_add_u32 v16, 98304, v10
    v_add_u32 v17, 98304, v11
    v_add_u32 v18, 98304, v12
    v_add_u32 v19, 98304, v13
    s_barrier
    ds_read_b64_tr_b16 v[76:77], v16 offset:0
    ds_read_b64_tr_b16 v[78:79], v17 offset:0
    ds_read_b64_tr_b16 v[80:81], v18 offset:0
    v_mfma_f32_32x32x16_bf16 v[100:115], v[64:67], v[184:187], v[100:115]
    ds_read_b64_tr_b16 v[82:83], v19 offset:0
    s_add_u32 s79, s88, s22
    s_add_u32 s79, s79, 16384
    buffer_load_dwordx4 v[224:227], v21, s[60:63], s79 offen offset:0 sc1
    s_waitcnt vmcnt(9) lgkmcnt(4)
    v_mfma_f32_32x32x16_bf16 v[84:99], v[68:71], v[188:191], v[84:99]
    ds_read_b64_tr_b16 v[60:61], v16 offset:2048
    ds_read_b64_tr_b16 v[62:63], v17 offset:2048
    ds_read_b64_tr_b16 v[64:65], v18 offset:2048
    v_mfma_f32_32x32x16_bf16 v[100:115], v[72:75], v[188:191], v[100:115]
    ds_read_b64_tr_b16 v[66:67], v19 offset:2048
    buffer_load_dwordx4 v[228:231], v21, s[60:63], s79 offen offset:2048 sc1
    s_waitcnt vmcnt(9) lgkmcnt(4)
    v_mfma_f32_32x32x16_bf16 v[84:99], v[76:79], v[192:195], v[84:99]
    ds_read_b64_tr_b16 v[68:69], v16 offset:4096
    ds_read_b64_tr_b16 v[70:71], v17 offset:4096
    ds_read_b64_tr_b16 v[72:73], v18 offset:4096
    v_mfma_f32_32x32x16_bf16 v[100:115], v[80:83], v[192:195], v[100:115]
    ds_read_b64_tr_b16 v[74:75], v19 offset:4096
    s_add_u32 s79, s79, 4096
    buffer_load_dwordx4 v[232:235], v21, s[60:63], s79 offen offset:0 sc1
    s_waitcnt vmcnt(9) lgkmcnt(4)
    v_mfma_f32_32x32x16_bf16 v[84:99], v[60:63], v[196:199], v[84:99]
    ds_read_b64_tr_b16 v[76:77], v16 offset:6144
    ds_read_b64_tr_b16 v[78:79], v17 offset:6144
    ds_read_b64_tr_b16 v[80:81], v18 offset:6144
    v_mfma_f32_32x32x16_bf16 v[100:115], v[64:67], v[196:199], v[100:115]
    ds_read_b64_tr_b16 v[82:83], v19 offset:6144
    buffer_load_dwordx4 v[236:239], v21, s[60:63], s79 offen offset:2048 sc1
    s_waitcnt vmcnt(9) lgkmcnt(4)
    v_mfma_f32_32x32x16_bf16 v[84:99], v[68:71], v[200:203], v[84:99]
    v_add_u32 v16, 114688, v10
    v_add_u32 v17, 114688, v11
    v_add_u32 v18, 114688, v12
    v_add_u32 v19, 114688, v13
    s_barrier
    ds_read_b64_tr_b16 v[60:61], v16 offset:0
    ds_read_b64_tr_b16 v[62:63], v17 offset:0
    ds_read_b64_tr_b16 v[64:65], v18 offset:0
    v_mfma_f32_32x32x16_bf16 v[100:115], v[72:75], v[200:203], v[100:115]
    ds_read_b64_tr_b16 v[66:67], v19 offset:0
    s_add_u32 s79, s88, s23
    s_add_u32 s79, s79, 16384
    buffer_load_dwordx4 v[240:243], v21, s[60:63], s79 offen offset:0 sc1
    s_waitcnt vmcnt(9) lgkmcnt(4)
    v_mfma_f32_32x32x16_bf16 v[84:99], v[76:79], v[204:207], v[84:99]
    ds_read_b64_tr_b16 v[68:69], v16 offset:2048
    ds_read_b64_tr_b16 v[70:71], v17 offset:2048
    ds_read_b64_tr_b16 v[72:73], v18 offset:2048
    v_mfma_f32_32x32x16_bf16 v[100:115], v[80:83], v[204:207], v[100:115]
    ds_read_b64_tr_b16 v[74:75], v19 offset:2048
    buffer_load_dwordx4 v[244:247], v21, s[60:63], s79 offen offset:2048 sc1
    s_waitcnt vmcnt(9) lgkmcnt(4)
    v_mfma_f32_32x32x16_bf16 v[84:99], v[60:63], v[208:211], v[84:99]
    ds_read_b64_tr_b16 v[76:77], v16 offset:4096
    ds_read_b64_tr_b16 v[78:79], v17 offset:4096
    ds_read_b64_tr_b16 v[80:81], v18 offset:4096
    v_mfma_f32_32x32x16_bf16 v[100:115], v[64:67], v[208:211], v[100:115]
    ds_read_b64_tr_b16 v[82:83], v19 offset:4096
    s_add_u32 s79, s79, 4096
    buffer_load_dwordx4 v[248:251], v21, s[60:63], s79 offen offset:0 sc1
    s_waitcnt vmcnt(9) lgkmcnt(4)
    v_mfma_f32_32x32x16_bf16 v[84:99], v[68:71], v[212:215], v[84:99]
    ds_read_b64_tr_b16 v[60:61], v16 offset:6144
    ds_read_b64_tr_b16 v[62:63], v17 offset:6144
    ds_read_b64_tr_b16 v[64:65], v18 offset:6144
    v_mfma_f32_32x32x16_bf16 v[100:115], v[72:75], v[212:215], v[100:115]
    ds_read_b64_tr_b16 v[66:67], v19 offset:6144
    buffer_load_dwordx4 v[252:255], v21, s[60:63], s79 offen offset:2048 sc1
    s_waitcnt vmcnt(9) lgkmcnt(4)
    v_mfma_f32_32x32x16_bf16 v[84:99], v[76:79], v[216:219], v[84:99]
    v_add_u32 v16, 0, v10
    v_add_u32 v17, 0, v11
    v_add_u32 v18, 0, v12
    v_add_u32 v19, 0, v13
    s_barrier
    ds_read_b64_tr_b16 v[68:69], v16 offset:0
    ds_read_b64_tr_b16 v[70:71], v17 offset:0
    ds_read_b64_tr_b16 v[72:73], v18 offset:0
    v_mfma_f32_32x32x16_bf16 v[100:115], v[80:83], v[216:219], v[100:115]
    ds_read_b64_tr_b16 v[74:75], v19 offset:0
    s_add_u32 s79, s88, s24
    s_add_u32 s79, s79, 16384
    buffer_load_dwordx4 v[128:131], v21, s[60:63], s79 offen offset:0 sc1
    s_waitcnt vmcnt(9) lgkmcnt(4)
    v_mfma_f32_32x32x16_bf16 v[84:99], v[60:63], v[220:223], v[84:99]
    ds_read_b64_tr_b16 v[76:77], v16 offset:2048
    ds_read_b64_tr_b16 v[78:79], v17 offset:2048
    ds_read_b64_tr_b16 v[80:81], v18 offset:2048
    v_mfma_f32_32x32x16_bf16 v[100:115], v[64:67], v[220:223], v[100:115]
    ds_read_b64_tr_b16 v[82:83], v19 offset:2048
    buffer_load_dwordx4 v[132:135], v21, s[60:63], s79 offen offset:2048 sc1
    s_waitcnt vmcnt(9) lgkmcnt(4)
    v_mfma_f32_32x32x16_bf16 v[84:99], v[68:71], v[224:227], v[84:99]
    ds_read_b64_tr_b16 v[60:61], v16 offset:4096
    ds_read_b64_tr_b16 v[62:63], v17 offset:4096
    ds_read_b64_tr_b16 v[64:65], v18 offset:4096
    v_mfma_f32_32x32x16_bf16 v[100:115], v[72:75], v[224:227], v[100:115]
    ds_read_b64_tr_b16 v[66:67], v19 offset:4096
    s_add_u32 s79, s79, 4096
    buffer_load_dwordx4 v[136:139], v21, s[60:63], s79 offen offset:0 sc1
    s_waitcnt vmcnt(9) lgkmcnt(4)
    v_mfma_f32_32x32x16_bf16 v[84:99], v[76:79], v[228:231], v[84:99]
    ds_read_b64_tr_b16 v[68:69], v16 offset:6144
    ds_read_b64_tr_b16 v[70:71], v17 offset:6144
    ds_read_b64_tr_b16 v[72:73], v18 offset:6144
    v_mfma_f32_32x32x16_bf16 v[100:115], v[80:83], v[228:231], v[100:115]
    ds_read_b64_tr_b16 v[74:75], v19 offset:6144
    buffer_load_dwordx4 v[140:143], v21, s[60:63], s79 offen offset:2048 sc1
    s_waitcnt vmcnt(9) lgkmcnt(4)
    v_mfma_f32_32x32x16_bf16 v[84:99], v[60:63], v[232:235], v[84:99]
    v_add_u32 v16, 16384, v10
    v_add_u32 v17, 16384, v11
    v_add_u32 v18, 16384, v12
    v_add_u32 v19, 16384, v13
    s_barrier
    ds_read_b64_tr_b16 v[76:77], v16 offset:0
    ds_read_b64_tr_b16 v[78:79], v17 offset:0
    ds_read_b64_tr_b16 v[80:81], v18 offset:0
    v_mfma_f32_32x32x16_bf16 v[100:115], v[64:67], v[232:235], v[100:115]
    ds_read_b64_tr_b16 v[82:83], v19 offset:0
    s_add_u32 s79, s88, s25
    s_add_u32 s79, s79, 16384
    buffer_load_dwordx4 v[144:147], v21, s[60:63], s79 offen offset:0 sc1
    s_waitcnt vmcnt(9) lgkmcnt(4)
    v_mfma_f32_32x32x16_bf16 v[84:99], v[68:71], v[236:239], v[84:99]
    ds_read_b64_tr_b16 v[60:61], v16 offset:2048
    ds_read_b64_tr_b16 v[62:63], v17 offset:2048
    ds_read_b64_tr_b16 v[64:65], v18 offset:2048
    v_mfma_f32_32x32x16_bf16 v[100:115], v[72:75], v[236:239], v[100:115]
    ds_read_b64_tr_b16 v[66:67], v19 offset:2048
    buffer_load_dwordx4 v[148:151], v21, s[60:63], s79 offen offset:2048 sc1
    s_waitcnt vmcnt(9) lgkmcnt(4)
    v_mfma_f32_32x32x16_bf16 v[84:99], v[76:79], v[240:243], v[84:99]
    ds_read_b64_tr_b16 v[68:69], v16 offset:4096
    ds_read_b64_tr_b16 v[70:71], v17 offset:4096
    ds_read_b64_tr_b16 v[72:73], v18 offset:4096
    v_mfma_f32_32x32x16_bf16 v[100:115], v[80:83], v[240:243], v[100:115]
    ds_read_b64_tr_b16 v[74:75], v19 offset:4096
    s_add_u32 s79, s79, 4096
    buffer_load_dwordx4 v[152:155], v21, s[60:63], s79 offen offset:0 sc1
    s_waitcnt vmcnt(9) lgkmcnt(4)
    v_mfma_f32_32x32x16_bf16 v[84:99], v[60:63], v[244:247], v[84:99]
    ds_read_b64_tr_b16 v[76:77], v16 offset:6144
    ds_read_b64_tr_b16 v[78:79], v17 offset:6144
    ds_read_b64_tr_b16 v[80:81], v18 offset:6144
    v_mfma_f32_32x32x16_bf16 v[100:115], v[64:67], v[244:247], v[100:115]
    ds_read_b64_tr_b16 v[82:83], v19 offset:6144
    buffer_load_dwordx4 v[156:159], v21, s[60:63], s79 offen offset:2048 sc1
    s_lshl_b32 s73, s72, 1
    s_sub_u32 s73, 1, s73
    s_mul_i32 s73, s73, 32768
    s_add_u32 s79, s79, s73
    s_sub_u32 s79, s79, 4096
    buffer_load_dwordx4 v[160:163], v21, s[60:63], s79 offen offset:0 sc1
    s_waitcnt vmcnt(10) lgkmcnt(4)
    v_mfma_f32_32x32x16_bf16 v[84:99], v[68:71], v[248:251], v[84:99]
    v_add_u32 v16, 32768, v10
    v_add_u32 v17, 32768, v11
    v_add_u32 v18, 32768, v12
    v_add_u32 v19, 32768, v13
    s_barrier
    ds_read_b64_tr_b16 v[60:61], v16 offset:0
    ds_read_b64_tr_b16 v[62:63], v17 offset:0
    ds_read_b64_tr_b16 v[64:65], v18 offset:0
    v_mfma_f32_32x32x16_bf16 v[100:115], v[72:75], v[248:251], v[100:115]
    ds_read_b64_tr_b16 v[66:67], v19 offset:0
    buffer_load_dwordx4 v[164:167], v21, s[60:63], s79 offen offset:2048 sc1
    s_add_u32 s79, s79, 4096
    buffer_load_dwordx4 v[168:171], v21, s[60:63], s79 offen offset:0 sc1
    s_waitcnt vmcnt(11) lgkmcnt(4)
    v_mfma_f32_32x32x16_bf16 v[84:99], v[76:79], v[252:255], v[84:99]
    ds_read_b64_tr_b16 v[68:69], v16 offset:2048
    ds_read_b64_tr_b16 v[70:71], v17 offset:2048
    ds_read_b64_tr_b16 v[72:73], v18 offset:2048
    v_mfma_f32_32x32x16_bf16 v[100:115], v[80:83], v[252:255], v[100:115]
    ds_read_b64_tr_b16 v[74:75], v19 offset:2048
    buffer_load_dwordx4 v[172:175], v21, s[60:63], s79 offen offset:2048 sc1
    s_waitcnt vmcnt(11) lgkmcnt(4)
    v_mfma_f32_32x32x16_bf16 v[84:99], v[60:63], v[128:131], v[84:99]
    ds_read_b64_tr_b16 v[76:77], v16 offset:4096
    ds_read_b64_tr_b16 v[78:79], v17 offset:4096
    v_mfma_f32_32x32x16_bf16 v[100:115], v[64:67], v[128:131], v[100:115]
    ds_read_b64_tr_b16 v[80:81], v18 offset:4096
    ds_read_b64_tr_b16 v[82:83], v19 offset:4096
    s_waitcnt vmcnt(10) lgkmcnt(4)
    v_mfma_f32_32x32x16_bf16 v[84:99], v[68:71], v[132:135], v[84:99]
    ds_read_b64_tr_b16 v[60:61], v16 offset:6144
    ds_read_b64_tr_b16 v[62:63], v17 offset:6144
    v_mfma_f32_32x32x16_bf16 v[100:115], v[72:75], v[132:135], v[100:115]
    ds_read_b64_tr_b16 v[64:65], v18 offset:6144
    ds_read_b64_tr_b16 v[66:67], v19 offset:6144
    s_waitcnt vmcnt(9) lgkmcnt(4)
    v_mfma_f32_32x32x16_bf16 v[84:99], v[76:79], v[136:139], v[84:99]
    s_barrier
    v_add_u32 v16, 49152, v10
    v_xor_b32 v18, 8192, v16
    v_add_u32 v17, 49152, v11
    v_xor_b32 v19, 8192, v17
    ds_read_b64_tr_b16 v[68:69], v16 offset:0
    ds_read_b64_tr_b16 v[70:71], v17 offset:0
    v_mfma_f32_32x32x16_bf16 v[100:115], v[80:83], v[136:139], v[100:115]
    ds_read_b64_tr_b16 v[72:73], v18 offset:0
    ds_read_b64_tr_b16 v[74:75], v19 offset:0
    s_waitcnt vmcnt(8) lgkmcnt(4)
    v_mfma_f32_32x32x16_bf16 v[84:99], v[60:63], v[140:143], v[84:99]
    ds_read_b64_tr_b16 v[76:77], v16 offset:2048
    ds_read_b64_tr_b16 v[78:79], v17 offset:2048
    v_mfma_f32_32x32x16_bf16 v[100:115], v[64:67], v[140:143], v[100:115]
    ds_read_b64_tr_b16 v[80:81], v18 offset:2048
    ds_read_b64_tr_b16 v[82:83], v19 offset:2048
    s_waitcnt vmcnt(3) lgkmcnt(4)
    v_mfma_f32_32x32x16_bf16 v[84:99], v[68:71], v[144:147], v[84:99]
    ds_read_b64_tr_b16 v[60:61], v16 offset:4096
    ds_read_b64_tr_b16 v[62:63], v17 offset:4096
    v_mfma_f32_32x32x16_bf16 v[84:99], v[72:75], v[160:163], v[84:99]
    v_xor_b32 v40, 8192, v23
    s_nop 3
    ds_write_b128 v40, v[100:103] offset:0
    ds_write_b128 v40, v[104:107] offset:1024
    ds_read_b64_tr_b16 v[64:65], v18 offset:4096
    ds_read_b64_tr_b16 v[66:67], v19 offset:4096
    s_waitcnt vmcnt(2) lgkmcnt(6)
    v_mfma_f32_32x32x16_bf16 v[84:99], v[76:79], v[148:151], v[84:99]
    ds_write_b128 v40, v[108:111] offset:2048
    ds_read_b64_tr_b16 v[68:69], v16 offset:6144
    ds_read_b64_tr_b16 v[70:71], v17 offset:6144
    v_mfma_f32_32x32x16_bf16 v[84:99], v[80:83], v[164:167], v[84:99]
    ds_write_b128 v40, v[112:115] offset:3072
    ds_read_b64_tr_b16 v[72:73], v18 offset:6144
    ds_read_b64_tr_b16 v[74:75], v19 offset:6144
    s_waitcnt vmcnt(1) lgkmcnt(6)
    v_mfma_f32_32x32x16_bf16 v[84:99], v[60:63], v[152:155], v[84:99]
    v_mfma_f32_32x32x16_bf16 v[84:99], v[64:67], v[168:171], v[84:99]
    s_waitcnt vmcnt(0) lgkmcnt(0)
    v_mfma_f32_32x32x16_bf16 v[84:99], v[68:71], v[156:159], v[84:99]
    s_barrier
    ds_read_b128 v[40:43], v23 offset:0
    ds_read_b128 v[44:47], v23 offset:1024
    ds_read_b128 v[48:51], v23 offset:2048
    ds_read_b128 v[52:55], v23 offset:3072
    v_mfma_f32_32x32x16_bf16 v[84:99], v[72:75], v[172:175], v[84:99]
    s_lshl_b32 s73, s71, 5
    v_and_b32 v160, 31, v0
    v_add_u32 v160, s73, v160
    v_lshlrev_b32 v160, 10, v160
    v_lshrrev_b32 v161, 5, v0
    v_lshl_add_u32 v160, v161, 4, v160
    s_lshl_b32 s73, s69, 1
    s_add_u32 s73, s73, s72
    s_lshl_b32 s73, s73, 6
    s_add_u32 s73, s73, s85
    s_waitcnt lgkmcnt(2)
    s_nop 0
    v_pk_add_f32 v[84:85], v[84:85], v[40:41]
    v_pk_add_f32 v[86:87], v[86:87], v[42:43]
    v_pk_add_f32 v[88:89], v[88:89], v[44:45]
    v_pk_add_f32 v[90:91], v[90:91], v[46:47]
    v_cvt_pk_bf16_f32 v144, v84, v85
    v_cvt_pk_bf16_f32 v145, v86, v87
    v_cvt_pk_bf16_f32 v146, v88, v89
    v_cvt_pk_bf16_f32 v147, v90, v91
    s_nop 0
    v_permlane32_swap_b32 v144, v146
    v_permlane32_swap_b32 v145, v147
    buffer_store_dwordx4 v[144:147], v160, s[56:59], s73 offen offset:0
    s_waitcnt lgkmcnt(0)
    v_pk_add_f32 v[92:93], v[92:93], v[48:49]
    v_pk_add_f32 v[94:95], v[94:95], v[50:51]
    v_pk_add_f32 v[96:97], v[96:97], v[52:53]
    v_pk_add_f32 v[98:99], v[98:99], v[54:55]
    v_cvt_pk_bf16_f32 v148, v92, v93
    v_cvt_pk_bf16_f32 v149, v94, v95
    v_cvt_pk_bf16_f32 v150, v96, v97
    v_cvt_pk_bf16_f32 v151, v98, v99
    s_nop 0
    v_permlane32_swap_b32 v148, v150
    v_permlane32_swap_b32 v149, v151
    buffer_store_dwordx4 v[148:151], v160, s[56:59], s73 offen offset:32
    s_endpgm
L_end:
    s_endpgm
.section .rodata,"a"
.p2align 6
.amdhsa_kernel parallel_sum__linear_attn_block__mixer_s_mlp__prompt_kernel
  .amdhsa_next_free_vgpr 256
  .amdhsa_next_free_sgpr 102
  .amdhsa_accum_offset 256
  .amdhsa_group_segment_fixed_size 0
  .amdhsa_kernarg_size 88
  .amdhsa_user_sgpr_count 2
  .amdhsa_user_sgpr_kernarg_segment_ptr 1
  .amdhsa_system_sgpr_workgroup_id_x 1
.end_amdhsa_kernel
```
